```python
import torch

def _softmax(x, axis=-1):
    return torch.softmax(x, dim=axis)
def _gelu(x):
    return torch.nn.functional.gelu(x, approximate="tanh")
def _silu(x):
    return torch.nn.functional.silu(x)
def _sigmoid(x):
    return torch.sigmoid(x)
def _layernorm(x, axis=-1, eps=1e-5):
    m = x.mean(dim=axis, keepdim=True)
    v = x.var(dim=axis, keepdim=True, unbiased=False)
    return (x - m) / torch.sqrt(v + eps)
def _scatter_add(tgt, idx, src, axis=0):
    return tgt.clone().index_add_(axis, idx, src)
def _segment_sum(src, seg, n):
    out = torch.zeros((n,) + src.shape[1:], dtype=src.dtype)
    return out.index_add_(0, seg, src)
def _pad(x, pw):
    flat = tuple(v for pair in reversed(pw) for v in pair)
    return torch.nn.functional.pad(x, flat)

kernel_name = 'gated_mix__spectral_fnet__glu_gated_glu__prompt'

def setup_inputs():

    _w = (lambda a: (lambda t: t.to(torch.bfloat16) if t.is_floating_point() else t)(torch.as_tensor(a)))
    def _A_setup():
        B, S, D = 1, 2048, 640
        ns = torch.arange(S)[:, None] * torch.arange(S)[None, :]
        nd = torch.arange(D)[:, None] * torch.arange(D)[None, :]
        Ws_re = torch.cos(-2.0 * torch.pi * ns / S).to(float)
        Ws_im = torch.sin(-2.0 * torch.pi * ns / S).to(float)
        Wd_re = torch.cos(-2.0 * torch.pi * nd / D).to(float)
        Wd_im = torch.sin(-2.0 * torch.pi * nd / D).to(float)
        return {
            "x": _w((lambda *s: torch.randn(*s, dtype=torch.bfloat16) * 0.05)(B, S, D)),
            "dft_seq_re": _w(Ws_re),
            "dft_seq_im": _w(Ws_im),
            "dft_hid_re": _w(Wd_re),
            "dft_hid_im": _w(Wd_im),
        }
    _A_in = _A_setup()

    def _B_setup():
        B, S, D, F = 1, 2048, 640, 1536
        return {
            "x": _w((lambda *s: torch.randn(*s, dtype=torch.bfloat16) * 0.05)(B, S, D)),
            "w_gate": _w((lambda *s: torch.randn(*s, dtype=torch.bfloat16) * 1.6)(D, F)),
            "w_up": _w((lambda *s: torch.randn(*s, dtype=torch.bfloat16) * 0.8)(D, F)),
            "w_down": _w((lambda *s: torch.randn(*s, dtype=torch.bfloat16) * 0.8)(F, D)),
        }
    _B_in = _B_setup()

    return {
        "A_x": _A_in["x"],
        "A_dft_seq_re": _A_in["dft_seq_re"],
        "A_dft_seq_im": _A_in["dft_seq_im"],
        "A_dft_hid_re": _A_in["dft_hid_re"],
        "A_dft_hid_im": _A_in["dft_hid_im"],
        "B_x": _B_in["x"],
        "B_w_gate": _B_in["w_gate"],
        "B_w_up": _B_in["w_up"],
        "B_w_down": _B_in["w_down"],
        "gate_w": _w((lambda *s: torch.randn(*s, dtype=torch.bfloat16) * 0.05)(640) * 16.0),
    }

def reference(A_x, A_dft_seq_re, A_dft_seq_im, A_dft_hid_re, A_dft_hid_im, B_x, B_w_gate, B_w_up, B_w_down, gate_w):
    def _A_ref(x, dft_seq_re, dft_seq_im, dft_hid_re, dft_hid_im):
        a = torch.einsum("bsd,ed->bse", x, dft_hid_re)
        b = torch.einsum("bsd,ed->bse", x, dft_hid_im)
        y = torch.einsum("ts,bse->bte", dft_seq_re, a) - torch.einsum("ts,bse->bte", dft_seq_im, b)
        return y

    def _B_ref(x, w_gate, w_up, w_down):
        g = torch.einsum("bsd,df->bsf", x, w_gate)
        u = torch.einsum("bsd,df->bsf", x, w_up)
        h = _sigmoid(g) * u
        return torch.einsum("bsf,fd->bsd", h, w_down)

    x = A_x
    g = _sigmoid((x * gate_w).sum(-1, keepdims=True))
    a = _A_ref(x, A_dft_seq_re, A_dft_seq_im, A_dft_hid_re, A_dft_hid_im)
    b = _B_ref(x, B_w_gate, B_w_up, B_w_down)
    return g * a + (1 - g) * b
```

```asm
; @launch grid=(256,1,1) block=(256,1,1) lds=163840
.amdgcn_target "amdgcn-amd-amdhsa--gfx950"
.text
.globl gated_mix__spectral_fnet__glu_gated_glu__prompt_kernel
.p2align 8
.type gated_mix__spectral_fnet__glu_gated_glu__prompt_kernel,@function
gated_mix__spectral_fnet__glu_gated_glu__prompt_kernel:
  s_cmp_ge_u32 s2, 256
  s_cbranch_scc0 L_start
  s_endpgm
L_start:
  s_load_dwordx16 s[16:31], s[0:1], 0
  s_load_dwordx8 s[32:39], s[0:1], 64
  s_load_dwordx2 s[14:15], s[0:1], 96
  v_and_b32 v1, 63, v0
  v_lshrrev_b32 v2, 6, v0
  s_and_b32 s5, s2, 7
  v_readfirstlane_b32 s4, v2
  s_lshr_b32 s6, s2, 3
  s_nop 2
  s_lshl_b32 s68, s4, 10
  s_cmp_lt_u32 s6, 12
  s_cbranch_scc1 L_gu
L_pq:
  s_sub_u32 s72, s6, 12
  s_mul_i32 s73, s72, 205
  s_lshr_b32 s73, s73, 10
  s_mul_i32 s74, s73, 5
  s_sub_u32 s74, s72, s74
  s_mul_i32 s8, s5, 1
  s_and_b32 s8, s8, 7
  s_lshl_b32 s75, s74, 2
  s_mul_i32 s76, s73, 5
  s_add_u32 s75, s75, s76
  s_cmp_ge_u32 s75, 20
  s_cselect_b32 s76, 20, 0
  s_sub_u32 s75, s75, s76
  s_mul_i32 s75, s75, 3277
  v_subrev_u32 v174, 0, v1
  v_add_u32 v170, s8, v174
  v_lshrrev_b32 v170, 3, v170
  v_lshlrev_b32 v170, 3, v170
  v_subrev_u32 v170, s8, v170
  v_add_u32 v171, 8, v170
  v_min_i32 v171, 32, v171
  v_max_i32 v170, 0, v170
  v_sub_u32 v171, v171, v170
  v_mul_u32_u24 v172, s75, v171
  v_add_u32 v172, 32768, v172
  v_lshrrev_b32 v172, 16, v172
  v_sub_u32 v173, v174, v170
  v_add_u32 v173, v173, v172
  v_sub_u32 v172, v173, v171
  v_cmp_ge_u32 vcc, v173, v171
  s_mul_i32 s9, s5, 4
  s_nop 0
  v_cndmask_b32 v173, v173, v172, vcc
  v_add_u32 v173, v173, v170
  v_add_u32 v173, s9, v173
  v_and_b32 v173, 31, v173
  v_lshlrev_b32 v16, 7, v173
  s_lshr_b32 s75, s73, 1
  v_readlane_b32 s69, v16, 0
  s_and_b32 s73, s73, 1
  s_lshl_b32 s76, s5, 1
  s_add_u32 s76, s76, s73
  s_lshr_b32 s72, s4, 1
  s_and_b32 s73, s4, 1
  s_mul_i32 s70, s69, 640
  v_lshrrev_b32 v18, 3, v1
  s_lshl_b32 s77, s4, 3
  s_lshl_b32 s81, s76, 7
  s_add_u32 s77, s77, s81
  v_add_u32 v18, s77, v18
  v_lshlrev_b32 v18, 12, v18
  v_lshrrev_b32 v19, 4, v1
  s_lshl_b32 s77, s73, 2
  v_add_u32 v19, s77, v19
  v_and_b32 v2, 7, v1
  v_xor_b32 v19, v19, v2
  v_lshl_add_u32 v2, v19, 4, v18
  v_add_u32 v3, 131072, v2
  v_add_u32 v4, 262144, v2
  v_add_u32 v5, 393216, v2
  v_lshrrev_b32 v18, 4, v1
  s_lshl_b32 s77, s4, 2
  v_add_u32 v19, s77, v18
  v_mul_u32_u24 v6, 1280, v19
  s_lshl_b32 s77, s72, 2
  v_or_b32 v18, s77, v18
  v_bfe_u32 v19, v1, 1, 3
  v_xor_b32 v18, v18, v19
  v_lshl_add_u32 v6, v18, 5, v6
  v_and_b32 v18, 1, v1
  v_lshl_add_u32 v6, v18, 4, v6
  s_lshl_b32 s77, s74, 8
  v_add_u32 v6, s77, v6
  v_add_u32 v7, 20480, v6
  v_add_u32 v8, 40960, v6
  v_add_u32 v9, 61440, v6
  s_waitcnt lgkmcnt(0)
  s_cmp_eq_u32 s75, 1
  s_cselect_b32 s44, s20, s18
  s_cselect_b32 s45, s21, s19
  s_cselect_b32 s78, 0x80008000, 0
  s_mov_b32 s46, 8388608
  s_mov_b32 s47, 0x20000
  s_mov_b32 s40, s16
  s_mov_b32 s41, s17
  s_mov_b32 s42, 2621440
  s_mov_b32 s43, 0x20000
  s_add_u32 m0, s68, 0
  s_nop 0
  buffer_load_dwordx4 v2, s[44:47], s69 offen lds
  v_readlane_b32 s10, v16, 1
  s_add_u32 m0, s68, 4096
  s_nop 0
  buffer_load_dwordx4 v3, s[44:47], s69 offen lds
  s_add_u32 m0, s68, 8192
  s_nop 0
  buffer_load_dwordx4 v4, s[44:47], s69 offen lds
  s_add_u32 m0, s68, 12288
  s_nop 0
  buffer_load_dwordx4 v5, s[44:47], s69 offen lds
  s_mul_i32 s11, s10, 640
  s_add_u32 m0, s68, 16384
  s_nop 0
  buffer_load_dwordx4 v6, s[40:43], s70 offen lds
  s_add_u32 m0, s68, 20480
  s_nop 0
  buffer_load_dwordx4 v7, s[40:43], s70 offen lds
  s_add_u32 m0, s68, 24576
  s_nop 0
  buffer_load_dwordx4 v8, s[40:43], s70 offen lds
  s_add_u32 m0, s68, 28672
  s_nop 0
  buffer_load_dwordx4 v9, s[40:43], s70 offen lds
  s_mov_b32 s56, s14
  s_mov_b32 s57, s15
  s_mov_b32 s58, 21037056
  s_mov_b32 s59, 0x20000
  s_mov_b32 s96, s38
  s_mov_b32 s97, s39
  s_mov_b32 s98, 256
  s_mov_b32 s99, 0x20000
  s_mul_i32 s79, s76, 512
  s_mul_i32 s77, s75, 5
  s_add_u32 s77, s77, s74
  s_lshl_b32 s77, s77, 3
  s_add_u32 s79, s79, s77
  s_add_u32 s79, s79, 15745024
  s_mov_b32 s7, s76
  s_lshr_b32 s80, s77, 3
  s_lshl_b32 s76, s76, 1
  s_add_u32 s76, s76, s72
  s_lshl_b32 s76, s76, 2
  s_mul_i32 s76, s76, 88
  s_mul_i32 s75, s75, 20
  s_add_u32 s76, s76, s75
  s_lshl_b32 s74, s74, 2
  s_add_u32 s76, s76, s74
  s_lshl_b32 s74, s73, 1
  s_add_u32 s76, s76, s74
  s_lshl_b32 s81, s76, 10
  v_and_b32 v18, 15, v1
  s_lshl_b32 s74, s72, 6
  v_add_u32 v18, s74, v18
  v_lshlrev_b32 v18, 7, v18
  v_lshrrev_b32 v19, 4, v1
  v_bfe_u32 v10, v1, 1, 3
  v_xor_b32 v19, v19, v10
  v_lshl_add_u32 v10, v19, 4, v18
  v_xor_b32 v11, 64, v10
  v_add_u32 v12, 65536, v10
  v_add_u32 v13, 65536, v11
  v_lshrrev_b32 v18, 4, v1
  v_bfe_u32 v19, v1, 2, 2
  v_lshl_add_u32 v24, v18, 3, v19
  v_lshlrev_b32 v24, 8, v24
  v_and_b32 v18, 1, v18
  v_lshl_or_b32 v18, v18, 2, v19
  s_lshl_b32 s74, s73, 2
  v_xor_b32 v18, s74, v18
  v_lshl_add_u32 v24, v18, 5, v24
  v_and_b32 v18, 3, v1
  v_lshl_add_u32 v24, v18, 3, v24
  v_xor_b32 v25, 32, v24
  v_xor_b32 v26, 64, v24
  v_xor_b32 v27, 96, v24
  v_add_u32 v28, 65536, v24
  v_add_u32 v29, 65536, v25
  v_add_u32 v30, 65536, v26
  v_add_u32 v31, 65536, v27
  v_lshlrev_b32 v18, 7, v1
  v_add_u32 v0, s79, v18
  v_mov_b32 v18, 2147483632
  v_cmp_gt_u32 vcc, 4, v1
  s_nop 1
  v_cndmask_b32 v0, v18, v0, vcc
  s_mov_b32 s62, 819200
  s_mov_b32 s63, 0x20000
  s_lshl_b32 s72, s80, 1
  s_mul_i32 s73, s80, 2460
  s_lshr_b32 s73, s73, 10
  s_sub_u32 s73, s73, 20
  v_add_u32 v170, s72, v1
  v_subrev_u32 v171, 20, v170
  v_min_u32 v170, v170, v171
  v_add_u32 v171, s73, v1
  v_subrev_u32 v172, 24, v171
  v_min_u32 v171, v171, v172
  s_and_b32 s72, s4, 1
  v_add_u32 v172, 20, v171
  v_cmp_gt_u32 vcc, 20, v1
  s_lshl_b32 s72, s72, 10
  s_mul_i32 s73, s80, 81920
  v_cndmask_b32 v172, v172, v170, vcc
  v_lshlrev_b32 v172, 11, v172
  v_add_u32 v39, s72, v172
  v_subrev_u32 v172, 10, v170
  v_min_u32 v173, v170, v172
  v_lshlrev_b32 v173, 7, v173
  v_add_u32 v173, s73, v173
  v_not_b32 v172, v172
  v_and_b32 v172, 0x80000000, v172
  v_or_b32 v173, v173, v172
  s_mov_b32 s72, 81920
  s_lshl_b32 s73, s80, 7
  v_mul_lo_u32 v171, v171, s72
  v_add_u32 v171, s73, v171
  v_cndmask_b32 v38, v171, v173, vcc
  v_lshrrev_b32 v170, 3, v1
  s_lshl_b32 s72, s4, 3
  v_add_u32 v170, s72, v170
  v_mul_u32_u24 v170, 1280, v170
  v_lshrrev_b32 v171, 4, v1
  v_and_b32 v172, 7, v1
  s_and_b32 s72, s4, 1
  s_lshl_b32 s72, s72, 2
  v_add_u32 v173, s72, v171
  v_xor_b32 v173, v173, v172
  v_lshl_add_u32 v36, v173, 4, v170
  v_add_u32 v37, 40960, v36
  v_readlane_b32 s100, v38, 0
  s_add_u32 m0, s68, 32768
  s_nop 0
  buffer_load_dwordx4 v2, s[44:47], s10 offen lds
  v_readlane_b32 s69, v16, 2
  s_add_u32 m0, s68, 36864
  s_nop 0
  buffer_load_dwordx4 v3, s[44:47], s10 offen lds
  s_add_u32 m0, s68, 40960
  s_nop 0
  buffer_load_dwordx4 v4, s[44:47], s10 offen lds
  s_add_u32 m0, s68, 45056
  s_nop 0
  buffer_load_dwordx4 v5, s[44:47], s10 offen lds
  s_mul_i32 s70, s69, 640
  s_add_u32 m0, s68, 49152
  s_nop 0
  buffer_load_dwordx4 v6, s[40:43], s11 offen lds
  s_add_u32 m0, s68, 53248
  s_nop 0
  buffer_load_dwordx4 v7, s[40:43], s11 offen lds
  s_add_u32 m0, s68, 57344
  s_nop 0
  buffer_load_dwordx4 v8, s[40:43], s11 offen lds
  s_add_u32 m0, s68, 61440
  s_nop 0
  buffer_load_dwordx4 v9, s[40:43], s11 offen lds
  s_waitcnt vmcnt(8)
  s_barrier
  ds_read_b64_tr_b16 v[120:121], v24 offset:16384
  ds_read_b64_tr_b16 v[122:123], v24 offset:17408
  ds_read_b128 v[104:107], v10 offset:0
  ds_read_b64_tr_b16 v[124:125], v25 offset:16384
  ds_read_b64_tr_b16 v[126:127], v25 offset:17408
  ds_read_b128 v[108:111], v10 offset:2048
  ds_read_b64_tr_b16 v[128:129], v26 offset:16384
  ds_read_b64_tr_b16 v[130:131], v26 offset:17408
  ds_read_b128 v[112:115], v10 offset:4096
  ds_read_b64_tr_b16 v[132:133], v27 offset:16384
  ds_read_b64_tr_b16 v[134:135], v27 offset:17408
  ds_read_b128 v[116:119], v10 offset:6144
  s_waitcnt lgkmcnt(0)
  ds_read_b64_tr_b16 v[152:153], v24 offset:24576
  s_add_u32 m0, s68, 65536
  s_nop 0
  buffer_load_dwordx4 v2, s[44:47], s69 offen lds
  v_mfma_f32_16x16x32_bf16 v[40:43], v[120:123], v[104:107], 0
  ds_read_b64_tr_b16 v[154:155], v24 offset:25600
  v_readlane_b32 s10, v16, 3
  v_mfma_f32_16x16x32_bf16 v[44:47], v[124:127], v[104:107], 0
  ds_read_b128 v[136:139], v11 offset:0
  s_add_u32 m0, s68, 69632
  v_mfma_f32_16x16x32_bf16 v[48:51], v[128:131], v[104:107], 0
  ds_read_b64_tr_b16 v[156:157], v25 offset:24576
  buffer_load_dwordx4 v3, s[44:47], s69 offen lds
  v_mfma_f32_16x16x32_bf16 v[52:55], v[132:135], v[104:107], 0
  ds_read_b64_tr_b16 v[158:159], v25 offset:25600
  s_add_u32 m0, s68, 73728
  v_mfma_f32_16x16x32_bf16 v[68:71], v[132:135], v[108:111], 0
  ds_read_b128 v[140:143], v11 offset:2048
  buffer_load_dwordx4 v4, s[44:47], s69 offen lds
  v_mfma_f32_16x16x32_bf16 v[64:67], v[128:131], v[108:111], 0
  ds_read_b64_tr_b16 v[160:161], v26 offset:24576
  s_add_u32 m0, s68, 77824
  v_mfma_f32_16x16x32_bf16 v[60:63], v[124:127], v[108:111], 0
  ds_read_b64_tr_b16 v[162:163], v26 offset:25600
  buffer_load_dwordx4 v5, s[44:47], s69 offen lds
  v_mfma_f32_16x16x32_bf16 v[56:59], v[120:123], v[108:111], 0
  ds_read_b128 v[144:147], v11 offset:4096
  s_mul_i32 s11, s10, 640
  s_add_u32 m0, s68, 81920
  v_mfma_f32_16x16x32_bf16 v[72:75], v[120:123], v[112:115], 0
  ds_read_b64_tr_b16 v[164:165], v27 offset:24576
  buffer_load_dwordx4 v6, s[40:43], s70 offen lds
  v_mfma_f32_16x16x32_bf16 v[76:79], v[124:127], v[112:115], 0
  ds_read_b64_tr_b16 v[166:167], v27 offset:25600
  s_add_u32 m0, s68, 86016
  v_mfma_f32_16x16x32_bf16 v[80:83], v[128:131], v[112:115], 0
  ds_read_b128 v[148:151], v11 offset:6144
  buffer_load_dwordx4 v7, s[40:43], s70 offen lds
  v_mfma_f32_16x16x32_bf16 v[84:87], v[132:135], v[112:115], 0
  s_add_u32 m0, s68, 90112
  v_mfma_f32_16x16x32_bf16 v[100:103], v[132:135], v[116:119], 0
  buffer_load_dwordx4 v8, s[40:43], s70 offen lds
  v_mfma_f32_16x16x32_bf16 v[96:99], v[128:131], v[116:119], 0
  s_add_u32 m0, s68, 94208
  v_mfma_f32_16x16x32_bf16 v[92:95], v[124:127], v[116:119], 0
  buffer_load_dwordx4 v9, s[40:43], s70 offen lds
  v_mfma_f32_16x16x32_bf16 v[88:91], v[120:123], v[116:119], 0
  s_waitcnt lgkmcnt(0)
  v_mfma_f32_16x16x32_bf16 v[40:43], v[152:155], v[136:139], v[40:43]
  v_mfma_f32_16x16x32_bf16 v[44:47], v[156:159], v[136:139], v[44:47]
  v_mfma_f32_16x16x32_bf16 v[48:51], v[160:163], v[136:139], v[48:51]
  s_waitcnt vmcnt(8)
  s_barrier
  ds_read_b64_tr_b16 v[120:121], v24 offset:49152
  ds_read_b64_tr_b16 v[122:123], v24 offset:50176
  s_add_u32 m0, s68, 98304
  s_nop 0
  buffer_load_dwordx4 v2, s[44:47], s10 offen lds
  v_mfma_f32_16x16x32_bf16 v[52:55], v[164:167], v[136:139], v[52:55]
  ds_read_b128 v[104:107], v10 offset:32768
  v_readlane_b32 s69, v16, 4
  v_mfma_f32_16x16x32_bf16 v[68:71], v[164:167], v[140:143], v[68:71]
  ds_read_b64_tr_b16 v[124:125], v25 offset:49152
  s_add_u32 m0, s68, 102400
  s_nop 0
  buffer_load_dwordx4 v3, s[44:47], s10 offen lds
  v_mfma_f32_16x16x32_bf16 v[64:67], v[160:163], v[140:143], v[64:67]
  ds_read_b64_tr_b16 v[126:127], v25 offset:50176
  ds_read_b128 v[108:111], v10 offset:34816
  s_add_u32 m0, s68, 106496
  v_mfma_f32_16x16x32_bf16 v[60:63], v[156:159], v[140:143], v[60:63]
  ds_read_b64_tr_b16 v[128:129], v26 offset:49152
  buffer_load_dwordx4 v4, s[44:47], s10 offen lds
  v_mfma_f32_16x16x32_bf16 v[56:59], v[152:155], v[140:143], v[56:59]
  ds_read_b64_tr_b16 v[130:131], v26 offset:50176
  s_add_u32 m0, s68, 110592
  s_nop 0
  buffer_load_dwordx4 v5, s[44:47], s10 offen lds
  v_mfma_f32_16x16x32_bf16 v[72:75], v[152:155], v[144:147], v[72:75]
  ds_read_b128 v[112:115], v10 offset:36864
  ds_read_b64_tr_b16 v[132:133], v27 offset:49152
  s_mul_i32 s70, s69, 640
  v_mfma_f32_16x16x32_bf16 v[76:79], v[156:159], v[144:147], v[76:79]
  ds_read_b64_tr_b16 v[134:135], v27 offset:50176
  s_add_u32 m0, s68, 114688
  s_nop 0
  buffer_load_dwordx4 v6, s[40:43], s11 offen lds
  v_mfma_f32_16x16x32_bf16 v[80:83], v[160:163], v[144:147], v[80:83]
  ds_read_b128 v[116:119], v10 offset:38912
  s_add_u32 m0, s68, 118784
  v_mfma_f32_16x16x32_bf16 v[84:87], v[164:167], v[144:147], v[84:87]
  buffer_load_dwordx4 v7, s[40:43], s11 offen lds
  v_mfma_f32_16x16x32_bf16 v[100:103], v[164:167], v[148:151], v[100:103]
  s_add_u32 m0, s68, 122880
  s_nop 0
  buffer_load_dwordx4 v8, s[40:43], s11 offen lds
  v_mfma_f32_16x16x32_bf16 v[96:99], v[160:163], v[148:151], v[96:99]
  s_add_u32 m0, s68, 126976
  v_mfma_f32_16x16x32_bf16 v[92:95], v[156:159], v[148:151], v[92:95]
  buffer_load_dwordx4 v9, s[40:43], s11 offen lds
  v_mfma_f32_16x16x32_bf16 v[88:91], v[152:155], v[148:151], v[88:91]
  s_waitcnt lgkmcnt(0)
  ds_read_b64_tr_b16 v[152:153], v24 offset:57344
  s_add_u32 m0, s68, 0
  s_nop 0
  buffer_load_dwordx4 v2, s[44:47], s69 offen lds
  v_mfma_f32_16x16x32_bf16 v[40:43], v[120:123], v[104:107], v[40:43]
  ds_read_b64_tr_b16 v[154:155], v24 offset:58368
  v_readlane_b32 s10, v16, 5
  v_mfma_f32_16x16x32_bf16 v[44:47], v[124:127], v[104:107], v[44:47]
  ds_read_b128 v[136:139], v11 offset:32768
  s_add_u32 m0, s68, 4096
  v_mfma_f32_16x16x32_bf16 v[48:51], v[128:131], v[104:107], v[48:51]
  ds_read_b64_tr_b16 v[156:157], v25 offset:57344
  buffer_load_dwordx4 v3, s[44:47], s69 offen lds
  v_mfma_f32_16x16x32_bf16 v[52:55], v[132:135], v[104:107], v[52:55]
  ds_read_b64_tr_b16 v[158:159], v25 offset:58368
  s_add_u32 m0, s68, 8192
  v_mfma_f32_16x16x32_bf16 v[68:71], v[132:135], v[108:111], v[68:71]
  ds_read_b128 v[140:143], v11 offset:34816
  buffer_load_dwordx4 v4, s[44:47], s69 offen lds
  v_mfma_f32_16x16x32_bf16 v[64:67], v[128:131], v[108:111], v[64:67]
  ds_read_b64_tr_b16 v[160:161], v26 offset:57344
  s_add_u32 m0, s68, 12288
  v_mfma_f32_16x16x32_bf16 v[60:63], v[124:127], v[108:111], v[60:63]
  ds_read_b64_tr_b16 v[162:163], v26 offset:58368
  buffer_load_dwordx4 v5, s[44:47], s69 offen lds
  v_mfma_f32_16x16x32_bf16 v[56:59], v[120:123], v[108:111], v[56:59]
  ds_read_b128 v[144:147], v11 offset:36864
  s_mul_i32 s11, s10, 640
  s_add_u32 m0, s68, 16384
  v_mfma_f32_16x16x32_bf16 v[72:75], v[120:123], v[112:115], v[72:75]
  ds_read_b64_tr_b16 v[164:165], v27 offset:57344
  buffer_load_dwordx4 v6, s[40:43], s70 offen lds
  v_mfma_f32_16x16x32_bf16 v[76:79], v[124:127], v[112:115], v[76:79]
  ds_read_b64_tr_b16 v[166:167], v27 offset:58368
  s_add_u32 m0, s68, 20480
  v_mfma_f32_16x16x32_bf16 v[80:83], v[128:131], v[112:115], v[80:83]
  ds_read_b128 v[148:151], v11 offset:38912
  buffer_load_dwordx4 v7, s[40:43], s70 offen lds
  v_mfma_f32_16x16x32_bf16 v[84:87], v[132:135], v[112:115], v[84:87]
  s_add_u32 m0, s68, 24576
  v_mfma_f32_16x16x32_bf16 v[100:103], v[132:135], v[116:119], v[100:103]
  buffer_load_dwordx4 v8, s[40:43], s70 offen lds
  v_mfma_f32_16x16x32_bf16 v[96:99], v[128:131], v[116:119], v[96:99]
  s_add_u32 m0, s68, 28672
  v_mfma_f32_16x16x32_bf16 v[92:95], v[124:127], v[116:119], v[92:95]
  buffer_load_dwordx4 v9, s[40:43], s70 offen lds
  v_mfma_f32_16x16x32_bf16 v[88:91], v[120:123], v[116:119], v[88:91]
  s_waitcnt lgkmcnt(0)
  v_mfma_f32_16x16x32_bf16 v[40:43], v[152:155], v[136:139], v[40:43]
  v_mfma_f32_16x16x32_bf16 v[44:47], v[156:159], v[136:139], v[44:47]
  v_mfma_f32_16x16x32_bf16 v[48:51], v[160:163], v[136:139], v[48:51]
  s_waitcnt vmcnt(16)
  s_barrier
  ds_read_b64_tr_b16 v[120:121], v28 offset:16384
  ds_read_b64_tr_b16 v[122:123], v28 offset:17408
  s_add_u32 m0, s68, 32768
  s_nop 0
  buffer_load_dwordx4 v2, s[44:47], s10 offen lds
  v_mfma_f32_16x16x32_bf16 v[52:55], v[164:167], v[136:139], v[52:55]
  ds_read_b128 v[104:107], v12 offset:0
  v_readlane_b32 s69, v16, 6
  v_mfma_f32_16x16x32_bf16 v[68:71], v[164:167], v[140:143], v[68:71]
  ds_read_b64_tr_b16 v[124:125], v29 offset:16384
  s_add_u32 m0, s68, 36864
  s_nop 0
  buffer_load_dwordx4 v3, s[44:47], s10 offen lds
  v_mfma_f32_16x16x32_bf16 v[64:67], v[160:163], v[140:143], v[64:67]
  ds_read_b64_tr_b16 v[126:127], v29 offset:17408
  ds_read_b128 v[108:111], v12 offset:2048
  s_add_u32 m0, s68, 40960
  v_mfma_f32_16x16x32_bf16 v[60:63], v[156:159], v[140:143], v[60:63]
  ds_read_b64_tr_b16 v[128:129], v30 offset:16384
  buffer_load_dwordx4 v4, s[44:47], s10 offen lds
  v_mfma_f32_16x16x32_bf16 v[56:59], v[152:155], v[140:143], v[56:59]
  ds_read_b64_tr_b16 v[130:131], v30 offset:17408
  s_add_u32 m0, s68, 45056
  s_nop 0
  buffer_load_dwordx4 v5, s[44:47], s10 offen lds
  v_mfma_f32_16x16x32_bf16 v[72:75], v[152:155], v[144:147], v[72:75]
  ds_read_b128 v[112:115], v12 offset:4096
  ds_read_b64_tr_b16 v[132:133], v31 offset:16384
  s_mul_i32 s70, s69, 640
  v_mfma_f32_16x16x32_bf16 v[76:79], v[156:159], v[144:147], v[76:79]
  ds_read_b64_tr_b16 v[134:135], v31 offset:17408
  s_add_u32 m0, s68, 49152
  s_nop 0
  buffer_load_dwordx4 v6, s[40:43], s11 offen lds
  v_mfma_f32_16x16x32_bf16 v[80:83], v[160:163], v[144:147], v[80:83]
  ds_read_b128 v[116:119], v12 offset:6144
  s_add_u32 m0, s68, 53248
  v_mfma_f32_16x16x32_bf16 v[84:87], v[164:167], v[144:147], v[84:87]
  buffer_load_dwordx4 v7, s[40:43], s11 offen lds
  v_mfma_f32_16x16x32_bf16 v[100:103], v[164:167], v[148:151], v[100:103]
  s_add_u32 m0, s68, 57344
  s_nop 0
  buffer_load_dwordx4 v8, s[40:43], s11 offen lds
  v_mfma_f32_16x16x32_bf16 v[96:99], v[160:163], v[148:151], v[96:99]
  s_add_u32 m0, s68, 61440
  v_mfma_f32_16x16x32_bf16 v[92:95], v[156:159], v[148:151], v[92:95]
  buffer_load_dwordx4 v9, s[40:43], s11 offen lds
  v_mfma_f32_16x16x32_bf16 v[88:91], v[152:155], v[148:151], v[88:91]
  s_waitcnt lgkmcnt(0)
  ds_read_b64_tr_b16 v[152:153], v28 offset:24576
  v_mfma_f32_16x16x32_bf16 v[40:43], v[120:123], v[104:107], v[40:43]
  ds_read_b64_tr_b16 v[154:155], v28 offset:25600
  v_mfma_f32_16x16x32_bf16 v[44:47], v[124:127], v[104:107], v[44:47]
  ds_read_b128 v[136:139], v13 offset:0
  v_mfma_f32_16x16x32_bf16 v[48:51], v[128:131], v[104:107], v[48:51]
  ds_read_b64_tr_b16 v[156:157], v29 offset:24576
  v_mfma_f32_16x16x32_bf16 v[52:55], v[132:135], v[104:107], v[52:55]
  ds_read_b64_tr_b16 v[158:159], v29 offset:25600
  v_mfma_f32_16x16x32_bf16 v[68:71], v[132:135], v[108:111], v[68:71]
  ds_read_b128 v[140:143], v13 offset:2048
  v_mfma_f32_16x16x32_bf16 v[64:67], v[128:131], v[108:111], v[64:67]
  ds_read_b64_tr_b16 v[160:161], v30 offset:24576
  v_mfma_f32_16x16x32_bf16 v[60:63], v[124:127], v[108:111], v[60:63]
  ds_read_b64_tr_b16 v[162:163], v30 offset:25600
  v_mfma_f32_16x16x32_bf16 v[56:59], v[120:123], v[108:111], v[56:59]
  ds_read_b128 v[144:147], v13 offset:4096
  v_mfma_f32_16x16x32_bf16 v[72:75], v[120:123], v[112:115], v[72:75]
  ds_read_b64_tr_b16 v[164:165], v31 offset:24576
  v_mfma_f32_16x16x32_bf16 v[76:79], v[124:127], v[112:115], v[76:79]
  ds_read_b64_tr_b16 v[166:167], v31 offset:25600
  v_mfma_f32_16x16x32_bf16 v[80:83], v[128:131], v[112:115], v[80:83]
  ds_read_b128 v[148:151], v13 offset:6144
  v_mfma_f32_16x16x32_bf16 v[84:87], v[132:135], v[112:115], v[84:87]
  v_mfma_f32_16x16x32_bf16 v[100:103], v[132:135], v[116:119], v[100:103]
  v_mfma_f32_16x16x32_bf16 v[96:99], v[128:131], v[116:119], v[96:99]
  v_mfma_f32_16x16x32_bf16 v[92:95], v[124:127], v[116:119], v[92:95]
  v_mfma_f32_16x16x32_bf16 v[88:91], v[120:123], v[116:119], v[88:91]
  s_waitcnt lgkmcnt(0)
  v_mfma_f32_16x16x32_bf16 v[40:43], v[152:155], v[136:139], v[40:43]
  v_mfma_f32_16x16x32_bf16 v[44:47], v[156:159], v[136:139], v[44:47]
  v_mfma_f32_16x16x32_bf16 v[48:51], v[160:163], v[136:139], v[48:51]
  s_waitcnt vmcnt(16)
  s_barrier
  ds_read_b64_tr_b16 v[120:121], v28 offset:49152
  ds_read_b64_tr_b16 v[122:123], v28 offset:50176
  s_add_u32 m0, s68, 65536
  s_nop 0
  buffer_load_dwordx4 v2, s[44:47], s69 offen lds
  v_mfma_f32_16x16x32_bf16 v[52:55], v[164:167], v[136:139], v[52:55]
  ds_read_b128 v[104:107], v12 offset:32768
  v_readlane_b32 s10, v16, 7
  v_mfma_f32_16x16x32_bf16 v[68:71], v[164:167], v[140:143], v[68:71]
  ds_read_b64_tr_b16 v[124:125], v29 offset:49152
  s_add_u32 m0, s68, 69632
  s_nop 0
  buffer_load_dwordx4 v3, s[44:47], s69 offen lds
  v_mfma_f32_16x16x32_bf16 v[64:67], v[160:163], v[140:143], v[64:67]
  ds_read_b64_tr_b16 v[126:127], v29 offset:50176
  ds_read_b128 v[108:111], v12 offset:34816
  s_add_u32 m0, s68, 73728
  v_mfma_f32_16x16x32_bf16 v[60:63], v[156:159], v[140:143], v[60:63]
  ds_read_b64_tr_b16 v[128:129], v30 offset:49152
  buffer_load_dwordx4 v4, s[44:47], s69 offen lds
  v_mfma_f32_16x16x32_bf16 v[56:59], v[152:155], v[140:143], v[56:59]
  ds_read_b64_tr_b16 v[130:131], v30 offset:50176
  s_add_u32 m0, s68, 77824
  s_nop 0
  buffer_load_dwordx4 v5, s[44:47], s69 offen lds
  v_mfma_f32_16x16x32_bf16 v[72:75], v[152:155], v[144:147], v[72:75]
  ds_read_b128 v[112:115], v12 offset:36864
L_pad0:
  s_cbranch_execz L_pad48
  ds_read_b64_tr_b16 v[132:133], v31 offset:49152
  s_mul_i32 s11, s10, 640
  v_mfma_f32_16x16x32_bf16 v[76:79], v[156:159], v[144:147], v[76:79]
  ds_read_b64_tr_b16 v[134:135], v31 offset:50176
  s_add_u32 m0, s68, 81920
  s_nop 0
  buffer_load_dwordx4 v6, s[40:43], s70 offen lds
  v_mfma_f32_16x16x32_bf16 v[80:83], v[160:163], v[144:147], v[80:83]
  ds_read_b128 v[116:119], v12 offset:38912
  s_add_u32 m0, s68, 86016
  v_mfma_f32_16x16x32_bf16 v[84:87], v[164:167], v[144:147], v[84:87]
  buffer_load_dwordx4 v7, s[40:43], s70 offen lds
  v_mfma_f32_16x16x32_bf16 v[100:103], v[164:167], v[148:151], v[100:103]
  s_add_u32 m0, s68, 90112
  s_nop 0
  buffer_load_dwordx4 v8, s[40:43], s70 offen lds
  v_mfma_f32_16x16x32_bf16 v[96:99], v[160:163], v[148:151], v[96:99]
  s_add_u32 m0, s68, 94208
  v_mfma_f32_16x16x32_bf16 v[92:95], v[156:159], v[148:151], v[92:95]
  buffer_load_dwordx4 v9, s[40:43], s70 offen lds
  v_mfma_f32_16x16x32_bf16 v[88:91], v[152:155], v[148:151], v[88:91]
  s_waitcnt lgkmcnt(0)
  ds_read_b64_tr_b16 v[152:153], v28 offset:57344
  v_mfma_f32_16x16x32_bf16 v[40:43], v[120:123], v[104:107], v[40:43]
  ds_read_b64_tr_b16 v[154:155], v28 offset:58368
  v_mfma_f32_16x16x32_bf16 v[44:47], v[124:127], v[104:107], v[44:47]
  ds_read_b128 v[136:139], v13 offset:32768
  v_mfma_f32_16x16x32_bf16 v[48:51], v[128:131], v[104:107], v[48:51]
  ds_read_b64_tr_b16 v[156:157], v29 offset:57344
  v_mfma_f32_16x16x32_bf16 v[52:55], v[132:135], v[104:107], v[52:55]
  ds_read_b64_tr_b16 v[158:159], v29 offset:58368
  v_mfma_f32_16x16x32_bf16 v[68:71], v[132:135], v[108:111], v[68:71]
  ds_read_b128 v[140:143], v13 offset:34816
  v_mfma_f32_16x16x32_bf16 v[64:67], v[128:131], v[108:111], v[64:67]
  ds_read_b64_tr_b16 v[160:161], v30 offset:57344
  v_mfma_f32_16x16x32_bf16 v[60:63], v[124:127], v[108:111], v[60:63]
  ds_read_b64_tr_b16 v[162:163], v30 offset:58368
  v_mfma_f32_16x16x32_bf16 v[56:59], v[120:123], v[108:111], v[56:59]
  ds_read_b128 v[144:147], v13 offset:36864
  v_mfma_f32_16x16x32_bf16 v[72:75], v[120:123], v[112:115], v[72:75]
  ds_read_b64_tr_b16 v[164:165], v31 offset:57344
  v_mfma_f32_16x16x32_bf16 v[76:79], v[124:127], v[112:115], v[76:79]
  ds_read_b64_tr_b16 v[166:167], v31 offset:58368
  v_mfma_f32_16x16x32_bf16 v[80:83], v[128:131], v[112:115], v[80:83]
  ds_read_b128 v[148:151], v13 offset:38912
  v_mfma_f32_16x16x32_bf16 v[84:87], v[132:135], v[112:115], v[84:87]
  v_mfma_f32_16x16x32_bf16 v[100:103], v[132:135], v[116:119], v[100:103]
  v_mfma_f32_16x16x32_bf16 v[96:99], v[128:131], v[116:119], v[96:99]
  v_mfma_f32_16x16x32_bf16 v[92:95], v[124:127], v[116:119], v[92:95]
  v_mfma_f32_16x16x32_bf16 v[88:91], v[120:123], v[116:119], v[88:91]
  s_waitcnt lgkmcnt(0)
  v_mfma_f32_16x16x32_bf16 v[40:43], v[152:155], v[136:139], v[40:43]
  v_mfma_f32_16x16x32_bf16 v[44:47], v[156:159], v[136:139], v[44:47]
  v_mfma_f32_16x16x32_bf16 v[48:51], v[160:163], v[136:139], v[48:51]
  s_waitcnt vmcnt(16)
  s_barrier
  ds_read_b64_tr_b16 v[120:121], v24 offset:16384
  ds_read_b64_tr_b16 v[122:123], v24 offset:17408
  s_add_u32 m0, s68, 98304
  s_nop 0
  buffer_load_dwordx4 v2, s[44:47], s10 offen lds
  v_mfma_f32_16x16x32_bf16 v[52:55], v[164:167], v[136:139], v[52:55]
  ds_read_b128 v[104:107], v10 offset:0
  v_readlane_b32 s69, v16, 8
  v_mfma_f32_16x16x32_bf16 v[68:71], v[164:167], v[140:143], v[68:71]
  ds_read_b64_tr_b16 v[124:125], v25 offset:16384
  s_add_u32 m0, s68, 102400
  s_nop 0
  buffer_load_dwordx4 v3, s[44:47], s10 offen lds
  v_mfma_f32_16x16x32_bf16 v[64:67], v[160:163], v[140:143], v[64:67]
  ds_read_b64_tr_b16 v[126:127], v25 offset:17408
  ds_read_b128 v[108:111], v10 offset:2048
  s_add_u32 m0, s68, 106496
  v_mfma_f32_16x16x32_bf16 v[60:63], v[156:159], v[140:143], v[60:63]
  ds_read_b64_tr_b16 v[128:129], v26 offset:16384
  buffer_load_dwordx4 v4, s[44:47], s10 offen lds
  v_mfma_f32_16x16x32_bf16 v[56:59], v[152:155], v[140:143], v[56:59]
  ds_read_b64_tr_b16 v[130:131], v26 offset:17408
  s_add_u32 m0, s68, 110592
  s_nop 0
  buffer_load_dwordx4 v5, s[44:47], s10 offen lds
  v_mfma_f32_16x16x32_bf16 v[72:75], v[152:155], v[144:147], v[72:75]
  ds_read_b128 v[112:115], v10 offset:4096
  ds_read_b64_tr_b16 v[132:133], v27 offset:16384
  s_mul_i32 s70, s69, 640
  v_mfma_f32_16x16x32_bf16 v[76:79], v[156:159], v[144:147], v[76:79]
  ds_read_b64_tr_b16 v[134:135], v27 offset:17408
  s_add_u32 m0, s68, 114688
  s_nop 0
  buffer_load_dwordx4 v6, s[40:43], s11 offen lds
  v_mfma_f32_16x16x32_bf16 v[80:83], v[160:163], v[144:147], v[80:83]
  ds_read_b128 v[116:119], v10 offset:6144
  s_add_u32 m0, s68, 118784
  v_mfma_f32_16x16x32_bf16 v[84:87], v[164:167], v[144:147], v[84:87]
  buffer_load_dwordx4 v7, s[40:43], s11 offen lds
  v_mfma_f32_16x16x32_bf16 v[100:103], v[164:167], v[148:151], v[100:103]
  s_add_u32 m0, s68, 122880
  s_nop 0
  buffer_load_dwordx4 v8, s[40:43], s11 offen lds
  v_mfma_f32_16x16x32_bf16 v[96:99], v[160:163], v[148:151], v[96:99]
  s_add_u32 m0, s68, 126976
  v_mfma_f32_16x16x32_bf16 v[92:95], v[156:159], v[148:151], v[92:95]
  buffer_load_dwordx4 v9, s[40:43], s11 offen lds
  v_mfma_f32_16x16x32_bf16 v[88:91], v[152:155], v[148:151], v[88:91]
  s_waitcnt lgkmcnt(0)
  ds_read_b64_tr_b16 v[152:153], v24 offset:24576
  v_mfma_f32_16x16x32_bf16 v[40:43], v[120:123], v[104:107], v[40:43]
  ds_read_b64_tr_b16 v[154:155], v24 offset:25600
  v_mfma_f32_16x16x32_bf16 v[44:47], v[124:127], v[104:107], v[44:47]
  ds_read_b128 v[136:139], v11 offset:0
  v_mfma_f32_16x16x32_bf16 v[48:51], v[128:131], v[104:107], v[48:51]
  ds_read_b64_tr_b16 v[156:157], v25 offset:24576
  v_mfma_f32_16x16x32_bf16 v[52:55], v[132:135], v[104:107], v[52:55]
  ds_read_b64_tr_b16 v[158:159], v25 offset:25600
  v_mfma_f32_16x16x32_bf16 v[68:71], v[132:135], v[108:111], v[68:71]
  ds_read_b128 v[140:143], v11 offset:2048
  v_mfma_f32_16x16x32_bf16 v[64:67], v[128:131], v[108:111], v[64:67]
  ds_read_b64_tr_b16 v[160:161], v26 offset:24576
  v_mfma_f32_16x16x32_bf16 v[60:63], v[124:127], v[108:111], v[60:63]
  ds_read_b64_tr_b16 v[162:163], v26 offset:25600
  v_mfma_f32_16x16x32_bf16 v[56:59], v[120:123], v[108:111], v[56:59]
  ds_read_b128 v[144:147], v11 offset:4096
  v_mfma_f32_16x16x32_bf16 v[72:75], v[120:123], v[112:115], v[72:75]
  ds_read_b64_tr_b16 v[164:165], v27 offset:24576
  v_mfma_f32_16x16x32_bf16 v[76:79], v[124:127], v[112:115], v[76:79]
  ds_read_b64_tr_b16 v[166:167], v27 offset:25600
  v_mfma_f32_16x16x32_bf16 v[80:83], v[128:131], v[112:115], v[80:83]
  ds_read_b128 v[148:151], v11 offset:6144
  v_mfma_f32_16x16x32_bf16 v[84:87], v[132:135], v[112:115], v[84:87]
  v_mfma_f32_16x16x32_bf16 v[100:103], v[132:135], v[116:119], v[100:103]
  v_mfma_f32_16x16x32_bf16 v[96:99], v[128:131], v[116:119], v[96:99]
  v_mfma_f32_16x16x32_bf16 v[92:95], v[124:127], v[116:119], v[92:95]
  v_mfma_f32_16x16x32_bf16 v[88:91], v[120:123], v[116:119], v[88:91]
  s_waitcnt lgkmcnt(0)
  v_mfma_f32_16x16x32_bf16 v[40:43], v[152:155], v[136:139], v[40:43]
  v_mfma_f32_16x16x32_bf16 v[44:47], v[156:159], v[136:139], v[44:47]
  v_mfma_f32_16x16x32_bf16 v[48:51], v[160:163], v[136:139], v[48:51]
  s_waitcnt vmcnt(16)
  s_barrier
  ds_read_b64_tr_b16 v[120:121], v24 offset:49152
  ds_read_b64_tr_b16 v[122:123], v24 offset:50176
  s_add_u32 m0, s68, 0
  v_mfma_f32_16x16x32_bf16 v[52:55], v[164:167], v[136:139], v[52:55]
  ds_read_b128 v[104:107], v10 offset:32768
  buffer_load_dwordx4 v2, s[44:47], s69 offen lds
  v_mfma_f32_16x16x32_bf16 v[68:71], v[164:167], v[140:143], v[68:71]
  ds_read_b64_tr_b16 v[124:125], v25 offset:49152
  v_readlane_b32 s10, v16, 9
  v_mfma_f32_16x16x32_bf16 v[64:67], v[160:163], v[140:143], v[64:67]
  ds_read_b64_tr_b16 v[126:127], v25 offset:50176
  ds_read_b128 v[108:111], v10 offset:34816
  s_add_u32 m0, s68, 4096
  v_mfma_f32_16x16x32_bf16 v[60:63], v[156:159], v[140:143], v[60:63]
  ds_read_b64_tr_b16 v[128:129], v26 offset:49152
  v_mfma_f32_16x16x32_bf16 v[56:59], v[152:155], v[140:143], v[56:59]
  ds_read_b64_tr_b16 v[130:131], v26 offset:50176
  buffer_load_dwordx4 v3, s[44:47], s69 offen lds
  v_mfma_f32_16x16x32_bf16 v[72:75], v[152:155], v[144:147], v[72:75]
  ds_read_b128 v[112:115], v10 offset:36864
  ds_read_b64_tr_b16 v[132:133], v27 offset:49152
  s_add_u32 m0, s68, 8192
  v_mfma_f32_16x16x32_bf16 v[76:79], v[156:159], v[144:147], v[76:79]
  ds_read_b64_tr_b16 v[134:135], v27 offset:50176
  buffer_load_dwordx4 v4, s[44:47], s69 offen lds
  v_mfma_f32_16x16x32_bf16 v[80:83], v[160:163], v[144:147], v[80:83]
  ds_read_b128 v[116:119], v10 offset:38912
  v_mfma_f32_16x16x32_bf16 v[84:87], v[164:167], v[144:147], v[84:87]
  s_add_u32 m0, s68, 12288
  v_mfma_f32_16x16x32_bf16 v[100:103], v[164:167], v[148:151], v[100:103]
  buffer_load_dwordx4 v5, s[44:47], s69 offen lds
  v_mfma_f32_16x16x32_bf16 v[96:99], v[160:163], v[148:151], v[96:99]
  s_mul_i32 s11, s10, 640
  v_mfma_f32_16x16x32_bf16 v[92:95], v[156:159], v[148:151], v[92:95]
  v_mfma_f32_16x16x32_bf16 v[88:91], v[152:155], v[148:151], v[88:91]
  s_waitcnt lgkmcnt(0)
  ds_read_b64_tr_b16 v[152:153], v24 offset:57344
  s_add_u32 m0, s68, 16384
  v_mfma_f32_16x16x32_bf16 v[40:43], v[120:123], v[104:107], v[40:43]
  ds_read_b64_tr_b16 v[154:155], v24 offset:58368
  v_mfma_f32_16x16x32_bf16 v[44:47], v[124:127], v[104:107], v[44:47]
  ds_read_b128 v[136:139], v11 offset:32768
  buffer_load_dwordx4 v6, s[40:43], s70 offen lds
  v_mfma_f32_16x16x32_bf16 v[48:51], v[128:131], v[104:107], v[48:51]
  ds_read_b64_tr_b16 v[156:157], v25 offset:57344
  v_mfma_f32_16x16x32_bf16 v[52:55], v[132:135], v[104:107], v[52:55]
  ds_read_b64_tr_b16 v[158:159], v25 offset:58368
  s_add_u32 m0, s68, 20480
  v_mfma_f32_16x16x32_bf16 v[68:71], v[132:135], v[108:111], v[68:71]
  ds_read_b128 v[140:143], v11 offset:34816
  v_mfma_f32_16x16x32_bf16 v[64:67], v[128:131], v[108:111], v[64:67]
  ds_read_b64_tr_b16 v[160:161], v26 offset:57344
  buffer_load_dwordx4 v7, s[40:43], s70 offen lds
  v_mfma_f32_16x16x32_bf16 v[60:63], v[124:127], v[108:111], v[60:63]
  ds_read_b64_tr_b16 v[162:163], v26 offset:58368
  v_mfma_f32_16x16x32_bf16 v[56:59], v[120:123], v[108:111], v[56:59]
  ds_read_b128 v[144:147], v11 offset:36864
  s_add_u32 m0, s68, 24576
  v_mfma_f32_16x16x32_bf16 v[72:75], v[120:123], v[112:115], v[72:75]
  ds_read_b64_tr_b16 v[164:165], v27 offset:57344
  v_mfma_f32_16x16x32_bf16 v[76:79], v[124:127], v[112:115], v[76:79]
  ds_read_b64_tr_b16 v[166:167], v27 offset:58368
  buffer_load_dwordx4 v8, s[40:43], s70 offen lds
  v_mfma_f32_16x16x32_bf16 v[80:83], v[128:131], v[112:115], v[80:83]
  ds_read_b128 v[148:151], v11 offset:38912
  v_mfma_f32_16x16x32_bf16 v[84:87], v[132:135], v[112:115], v[84:87]
  s_add_u32 m0, s68, 28672
  v_mfma_f32_16x16x32_bf16 v[100:103], v[132:135], v[116:119], v[100:103]
  v_mfma_f32_16x16x32_bf16 v[96:99], v[128:131], v[116:119], v[96:99]
  buffer_load_dwordx4 v9, s[40:43], s70 offen lds
  v_mfma_f32_16x16x32_bf16 v[92:95], v[124:127], v[116:119], v[92:95]
  v_mfma_f32_16x16x32_bf16 v[88:91], v[120:123], v[116:119], v[88:91]
  s_waitcnt lgkmcnt(0)
  v_mfma_f32_16x16x32_bf16 v[40:43], v[152:155], v[136:139], v[40:43]
  v_mfma_f32_16x16x32_bf16 v[44:47], v[156:159], v[136:139], v[44:47]
  v_mfma_f32_16x16x32_bf16 v[48:51], v[160:163], v[136:139], v[48:51]
  s_waitcnt vmcnt(16)
  s_barrier
  ds_read_b64_tr_b16 v[120:121], v28 offset:16384
  ds_read_b64_tr_b16 v[122:123], v28 offset:17408
  s_add_u32 m0, s68, 32768
  v_mfma_f32_16x16x32_bf16 v[52:55], v[164:167], v[136:139], v[52:55]
  ds_read_b128 v[104:107], v12 offset:0
  buffer_load_dwordx4 v2, s[44:47], s10 offen lds
  v_mfma_f32_16x16x32_bf16 v[68:71], v[164:167], v[140:143], v[68:71]
  ds_read_b64_tr_b16 v[124:125], v29 offset:16384
  v_readlane_b32 s69, v16, 10
  v_mfma_f32_16x16x32_bf16 v[64:67], v[160:163], v[140:143], v[64:67]
  ds_read_b64_tr_b16 v[126:127], v29 offset:17408
  ds_read_b128 v[108:111], v12 offset:2048
  s_add_u32 m0, s68, 36864
  v_mfma_f32_16x16x32_bf16 v[60:63], v[156:159], v[140:143], v[60:63]
  ds_read_b64_tr_b16 v[128:129], v30 offset:16384
  v_mfma_f32_16x16x32_bf16 v[56:59], v[152:155], v[140:143], v[56:59]
  ds_read_b64_tr_b16 v[130:131], v30 offset:17408
  buffer_load_dwordx4 v3, s[44:47], s10 offen lds
  v_mfma_f32_16x16x32_bf16 v[72:75], v[152:155], v[144:147], v[72:75]
  ds_read_b128 v[112:115], v12 offset:4096
  ds_read_b64_tr_b16 v[132:133], v31 offset:16384
  s_add_u32 m0, s68, 40960
  v_mfma_f32_16x16x32_bf16 v[76:79], v[156:159], v[144:147], v[76:79]
  ds_read_b64_tr_b16 v[134:135], v31 offset:17408
  buffer_load_dwordx4 v4, s[44:47], s10 offen lds
  v_mfma_f32_16x16x32_bf16 v[80:83], v[160:163], v[144:147], v[80:83]
  ds_read_b128 v[116:119], v12 offset:6144
  v_mfma_f32_16x16x32_bf16 v[84:87], v[164:167], v[144:147], v[84:87]
  s_add_u32 m0, s68, 45056
  v_mfma_f32_16x16x32_bf16 v[100:103], v[164:167], v[148:151], v[100:103]
  buffer_load_dwordx4 v5, s[44:47], s10 offen lds
  v_mfma_f32_16x16x32_bf16 v[96:99], v[160:163], v[148:151], v[96:99]
  s_mul_i32 s70, s69, 640
  v_mfma_f32_16x16x32_bf16 v[92:95], v[156:159], v[148:151], v[92:95]
  v_mfma_f32_16x16x32_bf16 v[88:91], v[152:155], v[148:151], v[88:91]
  s_waitcnt lgkmcnt(0)
  ds_read_b64_tr_b16 v[152:153], v28 offset:24576
  s_add_u32 m0, s68, 49152
  v_mfma_f32_16x16x32_bf16 v[40:43], v[120:123], v[104:107], v[40:43]
  ds_read_b64_tr_b16 v[154:155], v28 offset:25600
  v_mfma_f32_16x16x32_bf16 v[44:47], v[124:127], v[104:107], v[44:47]
  ds_read_b128 v[136:139], v13 offset:0
  buffer_load_dwordx4 v6, s[40:43], s11 offen lds
  v_mfma_f32_16x16x32_bf16 v[48:51], v[128:131], v[104:107], v[48:51]
  ds_read_b64_tr_b16 v[156:157], v29 offset:24576
  v_mfma_f32_16x16x32_bf16 v[52:55], v[132:135], v[104:107], v[52:55]
  ds_read_b64_tr_b16 v[158:159], v29 offset:25600
  s_add_u32 m0, s68, 53248
  v_mfma_f32_16x16x32_bf16 v[68:71], v[132:135], v[108:111], v[68:71]
  ds_read_b128 v[140:143], v13 offset:2048
  v_mfma_f32_16x16x32_bf16 v[64:67], v[128:131], v[108:111], v[64:67]
  ds_read_b64_tr_b16 v[160:161], v30 offset:24576
  buffer_load_dwordx4 v7, s[40:43], s11 offen lds
L_pad1:
  s_cbranch_execz L_pad49
  v_mfma_f32_16x16x32_bf16 v[60:63], v[124:127], v[108:111], v[60:63]
  ds_read_b64_tr_b16 v[162:163], v30 offset:25600
  v_mfma_f32_16x16x32_bf16 v[56:59], v[120:123], v[108:111], v[56:59]
  ds_read_b128 v[144:147], v13 offset:4096
  s_add_u32 m0, s68, 57344
  v_mfma_f32_16x16x32_bf16 v[72:75], v[120:123], v[112:115], v[72:75]
  ds_read_b64_tr_b16 v[164:165], v31 offset:24576
  v_mfma_f32_16x16x32_bf16 v[76:79], v[124:127], v[112:115], v[76:79]
  ds_read_b64_tr_b16 v[166:167], v31 offset:25600
  buffer_load_dwordx4 v8, s[40:43], s11 offen lds
  v_mfma_f32_16x16x32_bf16 v[80:83], v[128:131], v[112:115], v[80:83]
  ds_read_b128 v[148:151], v13 offset:6144
  v_mfma_f32_16x16x32_bf16 v[84:87], v[132:135], v[112:115], v[84:87]
  s_add_u32 m0, s68, 61440
  v_mfma_f32_16x16x32_bf16 v[100:103], v[132:135], v[116:119], v[100:103]
  v_mfma_f32_16x16x32_bf16 v[96:99], v[128:131], v[116:119], v[96:99]
  buffer_load_dwordx4 v9, s[40:43], s11 offen lds
  v_mfma_f32_16x16x32_bf16 v[92:95], v[124:127], v[116:119], v[92:95]
  v_mfma_f32_16x16x32_bf16 v[88:91], v[120:123], v[116:119], v[88:91]
  s_waitcnt lgkmcnt(0)
  v_mfma_f32_16x16x32_bf16 v[40:43], v[152:155], v[136:139], v[40:43]
  v_mfma_f32_16x16x32_bf16 v[44:47], v[156:159], v[136:139], v[44:47]
  v_mfma_f32_16x16x32_bf16 v[48:51], v[160:163], v[136:139], v[48:51]
  s_waitcnt vmcnt(16)
  s_barrier
  ds_read_b64_tr_b16 v[120:121], v28 offset:49152
  ds_read_b64_tr_b16 v[122:123], v28 offset:50176
  s_add_u32 m0, s68, 65536
  v_mfma_f32_16x16x32_bf16 v[52:55], v[164:167], v[136:139], v[52:55]
  ds_read_b128 v[104:107], v12 offset:32768
  buffer_load_dwordx4 v2, s[44:47], s69 offen lds
  v_mfma_f32_16x16x32_bf16 v[68:71], v[164:167], v[140:143], v[68:71]
  ds_read_b64_tr_b16 v[124:125], v29 offset:49152
  v_readlane_b32 s10, v16, 11
  v_mfma_f32_16x16x32_bf16 v[64:67], v[160:163], v[140:143], v[64:67]
  ds_read_b64_tr_b16 v[126:127], v29 offset:50176
  ds_read_b128 v[108:111], v12 offset:34816
  s_add_u32 m0, s68, 69632
  v_mfma_f32_16x16x32_bf16 v[60:63], v[156:159], v[140:143], v[60:63]
  ds_read_b64_tr_b16 v[128:129], v30 offset:49152
  v_mfma_f32_16x16x32_bf16 v[56:59], v[152:155], v[140:143], v[56:59]
  ds_read_b64_tr_b16 v[130:131], v30 offset:50176
  buffer_load_dwordx4 v3, s[44:47], s69 offen lds
  v_mfma_f32_16x16x32_bf16 v[72:75], v[152:155], v[144:147], v[72:75]
  ds_read_b128 v[112:115], v12 offset:36864
  ds_read_b64_tr_b16 v[132:133], v31 offset:49152
  s_add_u32 m0, s68, 73728
  v_mfma_f32_16x16x32_bf16 v[76:79], v[156:159], v[144:147], v[76:79]
  ds_read_b64_tr_b16 v[134:135], v31 offset:50176
  buffer_load_dwordx4 v4, s[44:47], s69 offen lds
  v_mfma_f32_16x16x32_bf16 v[80:83], v[160:163], v[144:147], v[80:83]
  ds_read_b128 v[116:119], v12 offset:38912
  v_mfma_f32_16x16x32_bf16 v[84:87], v[164:167], v[144:147], v[84:87]
  s_add_u32 m0, s68, 77824
  v_mfma_f32_16x16x32_bf16 v[100:103], v[164:167], v[148:151], v[100:103]
  buffer_load_dwordx4 v5, s[44:47], s69 offen lds
  v_mfma_f32_16x16x32_bf16 v[96:99], v[160:163], v[148:151], v[96:99]
  s_mul_i32 s11, s10, 640
  v_mfma_f32_16x16x32_bf16 v[92:95], v[156:159], v[148:151], v[92:95]
  v_mfma_f32_16x16x32_bf16 v[88:91], v[152:155], v[148:151], v[88:91]
  s_waitcnt lgkmcnt(0)
  ds_read_b64_tr_b16 v[152:153], v28 offset:57344
  s_add_u32 m0, s68, 81920
  v_mfma_f32_16x16x32_bf16 v[40:43], v[120:123], v[104:107], v[40:43]
  ds_read_b64_tr_b16 v[154:155], v28 offset:58368
  v_mfma_f32_16x16x32_bf16 v[44:47], v[124:127], v[104:107], v[44:47]
  ds_read_b128 v[136:139], v13 offset:32768
  buffer_load_dwordx4 v6, s[40:43], s70 offen lds
  v_mfma_f32_16x16x32_bf16 v[48:51], v[128:131], v[104:107], v[48:51]
  ds_read_b64_tr_b16 v[156:157], v29 offset:57344
  v_mfma_f32_16x16x32_bf16 v[52:55], v[132:135], v[104:107], v[52:55]
  ds_read_b64_tr_b16 v[158:159], v29 offset:58368
  s_add_u32 m0, s68, 86016
  v_mfma_f32_16x16x32_bf16 v[68:71], v[132:135], v[108:111], v[68:71]
  ds_read_b128 v[140:143], v13 offset:34816
  v_mfma_f32_16x16x32_bf16 v[64:67], v[128:131], v[108:111], v[64:67]
  ds_read_b64_tr_b16 v[160:161], v30 offset:57344
  buffer_load_dwordx4 v7, s[40:43], s70 offen lds
  v_mfma_f32_16x16x32_bf16 v[60:63], v[124:127], v[108:111], v[60:63]
  ds_read_b64_tr_b16 v[162:163], v30 offset:58368
  v_mfma_f32_16x16x32_bf16 v[56:59], v[120:123], v[108:111], v[56:59]
  ds_read_b128 v[144:147], v13 offset:36864
  s_add_u32 m0, s68, 90112
  v_mfma_f32_16x16x32_bf16 v[72:75], v[120:123], v[112:115], v[72:75]
  ds_read_b64_tr_b16 v[164:165], v31 offset:57344
  v_mfma_f32_16x16x32_bf16 v[76:79], v[124:127], v[112:115], v[76:79]
  ds_read_b64_tr_b16 v[166:167], v31 offset:58368
  buffer_load_dwordx4 v8, s[40:43], s70 offen lds
  v_mfma_f32_16x16x32_bf16 v[80:83], v[128:131], v[112:115], v[80:83]
  ds_read_b128 v[148:151], v13 offset:38912
  v_mfma_f32_16x16x32_bf16 v[84:87], v[132:135], v[112:115], v[84:87]
  s_add_u32 m0, s68, 94208
  v_mfma_f32_16x16x32_bf16 v[100:103], v[132:135], v[116:119], v[100:103]
  v_mfma_f32_16x16x32_bf16 v[96:99], v[128:131], v[116:119], v[96:99]
  buffer_load_dwordx4 v9, s[40:43], s70 offen lds
  v_mfma_f32_16x16x32_bf16 v[92:95], v[124:127], v[116:119], v[92:95]
  v_mfma_f32_16x16x32_bf16 v[88:91], v[120:123], v[116:119], v[88:91]
  s_waitcnt lgkmcnt(0)
  v_mfma_f32_16x16x32_bf16 v[40:43], v[152:155], v[136:139], v[40:43]
  v_mfma_f32_16x16x32_bf16 v[44:47], v[156:159], v[136:139], v[44:47]
  v_mfma_f32_16x16x32_bf16 v[48:51], v[160:163], v[136:139], v[48:51]
  s_waitcnt vmcnt(16)
  s_barrier
  ds_read_b64_tr_b16 v[120:121], v24 offset:16384
  ds_read_b64_tr_b16 v[122:123], v24 offset:17408
  s_add_u32 m0, s68, 98304
  v_mfma_f32_16x16x32_bf16 v[52:55], v[164:167], v[136:139], v[52:55]
  ds_read_b128 v[104:107], v10 offset:0
  buffer_load_dwordx4 v2, s[44:47], s10 offen lds
  v_mfma_f32_16x16x32_bf16 v[68:71], v[164:167], v[140:143], v[68:71]
  ds_read_b64_tr_b16 v[124:125], v25 offset:16384
  v_readlane_b32 s69, v16, 12
  v_mfma_f32_16x16x32_bf16 v[64:67], v[160:163], v[140:143], v[64:67]
  ds_read_b64_tr_b16 v[126:127], v25 offset:17408
  ds_read_b128 v[108:111], v10 offset:2048
  s_add_u32 m0, s68, 102400
  v_mfma_f32_16x16x32_bf16 v[60:63], v[156:159], v[140:143], v[60:63]
  ds_read_b64_tr_b16 v[128:129], v26 offset:16384
  v_mfma_f32_16x16x32_bf16 v[56:59], v[152:155], v[140:143], v[56:59]
  ds_read_b64_tr_b16 v[130:131], v26 offset:17408
  buffer_load_dwordx4 v3, s[44:47], s10 offen lds
  v_mfma_f32_16x16x32_bf16 v[72:75], v[152:155], v[144:147], v[72:75]
  ds_read_b128 v[112:115], v10 offset:4096
  ds_read_b64_tr_b16 v[132:133], v27 offset:16384
  s_add_u32 m0, s68, 106496
  v_mfma_f32_16x16x32_bf16 v[76:79], v[156:159], v[144:147], v[76:79]
  ds_read_b64_tr_b16 v[134:135], v27 offset:17408
  buffer_load_dwordx4 v4, s[44:47], s10 offen lds
  v_mfma_f32_16x16x32_bf16 v[80:83], v[160:163], v[144:147], v[80:83]
  ds_read_b128 v[116:119], v10 offset:6144
  v_mfma_f32_16x16x32_bf16 v[84:87], v[164:167], v[144:147], v[84:87]
  s_add_u32 m0, s68, 110592
  v_mfma_f32_16x16x32_bf16 v[100:103], v[164:167], v[148:151], v[100:103]
  buffer_load_dwordx4 v5, s[44:47], s10 offen lds
  v_mfma_f32_16x16x32_bf16 v[96:99], v[160:163], v[148:151], v[96:99]
  s_mul_i32 s70, s69, 640
  v_mfma_f32_16x16x32_bf16 v[92:95], v[156:159], v[148:151], v[92:95]
  v_mfma_f32_16x16x32_bf16 v[88:91], v[152:155], v[148:151], v[88:91]
  s_waitcnt lgkmcnt(0)
  ds_read_b64_tr_b16 v[152:153], v24 offset:24576
  s_add_u32 m0, s68, 114688
  v_mfma_f32_16x16x32_bf16 v[40:43], v[120:123], v[104:107], v[40:43]
  ds_read_b64_tr_b16 v[154:155], v24 offset:25600
  v_mfma_f32_16x16x32_bf16 v[44:47], v[124:127], v[104:107], v[44:47]
  ds_read_b128 v[136:139], v11 offset:0
  buffer_load_dwordx4 v6, s[40:43], s11 offen lds
  v_mfma_f32_16x16x32_bf16 v[48:51], v[128:131], v[104:107], v[48:51]
  ds_read_b64_tr_b16 v[156:157], v25 offset:24576
  v_mfma_f32_16x16x32_bf16 v[52:55], v[132:135], v[104:107], v[52:55]
  ds_read_b64_tr_b16 v[158:159], v25 offset:25600
  s_add_u32 m0, s68, 118784
  v_mfma_f32_16x16x32_bf16 v[68:71], v[132:135], v[108:111], v[68:71]
  ds_read_b128 v[140:143], v11 offset:2048
  v_mfma_f32_16x16x32_bf16 v[64:67], v[128:131], v[108:111], v[64:67]
  ds_read_b64_tr_b16 v[160:161], v26 offset:24576
  buffer_load_dwordx4 v7, s[40:43], s11 offen lds
  v_mfma_f32_16x16x32_bf16 v[60:63], v[124:127], v[108:111], v[60:63]
  ds_read_b64_tr_b16 v[162:163], v26 offset:25600
  v_mfma_f32_16x16x32_bf16 v[56:59], v[120:123], v[108:111], v[56:59]
  ds_read_b128 v[144:147], v11 offset:4096
  s_add_u32 m0, s68, 122880
  v_mfma_f32_16x16x32_bf16 v[72:75], v[120:123], v[112:115], v[72:75]
  ds_read_b64_tr_b16 v[164:165], v27 offset:24576
  v_mfma_f32_16x16x32_bf16 v[76:79], v[124:127], v[112:115], v[76:79]
  ds_read_b64_tr_b16 v[166:167], v27 offset:25600
  buffer_load_dwordx4 v8, s[40:43], s11 offen lds
  v_mfma_f32_16x16x32_bf16 v[80:83], v[128:131], v[112:115], v[80:83]
  ds_read_b128 v[148:151], v11 offset:6144
  v_mfma_f32_16x16x32_bf16 v[84:87], v[132:135], v[112:115], v[84:87]
  s_add_u32 m0, s68, 126976
  v_mfma_f32_16x16x32_bf16 v[100:103], v[132:135], v[116:119], v[100:103]
  v_mfma_f32_16x16x32_bf16 v[96:99], v[128:131], v[116:119], v[96:99]
  buffer_load_dwordx4 v9, s[40:43], s11 offen lds
  v_mfma_f32_16x16x32_bf16 v[92:95], v[124:127], v[116:119], v[92:95]
  v_mfma_f32_16x16x32_bf16 v[88:91], v[120:123], v[116:119], v[88:91]
  s_waitcnt lgkmcnt(0)
  v_mfma_f32_16x16x32_bf16 v[40:43], v[152:155], v[136:139], v[40:43]
  v_mfma_f32_16x16x32_bf16 v[44:47], v[156:159], v[136:139], v[44:47]
  v_mfma_f32_16x16x32_bf16 v[48:51], v[160:163], v[136:139], v[48:51]
  s_waitcnt vmcnt(16)
  s_barrier
  ds_read_b64_tr_b16 v[120:121], v24 offset:49152
  ds_read_b64_tr_b16 v[122:123], v24 offset:50176
  s_add_u32 m0, s68, 0
  v_mfma_f32_16x16x32_bf16 v[52:55], v[164:167], v[136:139], v[52:55]
  ds_read_b128 v[104:107], v10 offset:32768
  buffer_load_dwordx4 v2, s[44:47], s69 offen lds
  v_mfma_f32_16x16x32_bf16 v[68:71], v[164:167], v[140:143], v[68:71]
  ds_read_b64_tr_b16 v[124:125], v25 offset:49152
  v_readlane_b32 s10, v16, 13
  v_mfma_f32_16x16x32_bf16 v[64:67], v[160:163], v[140:143], v[64:67]
  ds_read_b64_tr_b16 v[126:127], v25 offset:50176
  ds_read_b128 v[108:111], v10 offset:34816
  s_add_u32 m0, s68, 4096
  v_mfma_f32_16x16x32_bf16 v[60:63], v[156:159], v[140:143], v[60:63]
  ds_read_b64_tr_b16 v[128:129], v26 offset:49152
  v_mfma_f32_16x16x32_bf16 v[56:59], v[152:155], v[140:143], v[56:59]
  ds_read_b64_tr_b16 v[130:131], v26 offset:50176
  buffer_load_dwordx4 v3, s[44:47], s69 offen lds
  v_mfma_f32_16x16x32_bf16 v[72:75], v[152:155], v[144:147], v[72:75]
  ds_read_b128 v[112:115], v10 offset:36864
  ds_read_b64_tr_b16 v[132:133], v27 offset:49152
  s_add_u32 m0, s68, 8192
  v_mfma_f32_16x16x32_bf16 v[76:79], v[156:159], v[144:147], v[76:79]
  ds_read_b64_tr_b16 v[134:135], v27 offset:50176
  buffer_load_dwordx4 v4, s[44:47], s69 offen lds
  v_mfma_f32_16x16x32_bf16 v[80:83], v[160:163], v[144:147], v[80:83]
  ds_read_b128 v[116:119], v10 offset:38912
  v_mfma_f32_16x16x32_bf16 v[84:87], v[164:167], v[144:147], v[84:87]
  s_add_u32 m0, s68, 12288
  v_mfma_f32_16x16x32_bf16 v[100:103], v[164:167], v[148:151], v[100:103]
  buffer_load_dwordx4 v5, s[44:47], s69 offen lds
  v_mfma_f32_16x16x32_bf16 v[96:99], v[160:163], v[148:151], v[96:99]
  s_mul_i32 s11, s10, 640
  v_mfma_f32_16x16x32_bf16 v[92:95], v[156:159], v[148:151], v[92:95]
  v_mfma_f32_16x16x32_bf16 v[88:91], v[152:155], v[148:151], v[88:91]
  s_waitcnt lgkmcnt(0)
  ds_read_b64_tr_b16 v[152:153], v24 offset:57344
  s_add_u32 m0, s68, 16384
  v_mfma_f32_16x16x32_bf16 v[40:43], v[120:123], v[104:107], v[40:43]
  ds_read_b64_tr_b16 v[154:155], v24 offset:58368
  v_mfma_f32_16x16x32_bf16 v[44:47], v[124:127], v[104:107], v[44:47]
  ds_read_b128 v[136:139], v11 offset:32768
  buffer_load_dwordx4 v6, s[40:43], s70 offen lds
  v_mfma_f32_16x16x32_bf16 v[48:51], v[128:131], v[104:107], v[48:51]
  ds_read_b64_tr_b16 v[156:157], v25 offset:57344
  v_mfma_f32_16x16x32_bf16 v[52:55], v[132:135], v[104:107], v[52:55]
  ds_read_b64_tr_b16 v[158:159], v25 offset:58368
  s_add_u32 m0, s68, 20480
  v_mfma_f32_16x16x32_bf16 v[68:71], v[132:135], v[108:111], v[68:71]
  ds_read_b128 v[140:143], v11 offset:34816
  v_mfma_f32_16x16x32_bf16 v[64:67], v[128:131], v[108:111], v[64:67]
  ds_read_b64_tr_b16 v[160:161], v26 offset:57344
  buffer_load_dwordx4 v7, s[40:43], s70 offen lds
  v_mfma_f32_16x16x32_bf16 v[60:63], v[124:127], v[108:111], v[60:63]
  ds_read_b64_tr_b16 v[162:163], v26 offset:58368
  v_mfma_f32_16x16x32_bf16 v[56:59], v[120:123], v[108:111], v[56:59]
  ds_read_b128 v[144:147], v11 offset:36864
  s_add_u32 m0, s68, 24576
  v_mfma_f32_16x16x32_bf16 v[72:75], v[120:123], v[112:115], v[72:75]
  ds_read_b64_tr_b16 v[164:165], v27 offset:57344
  v_mfma_f32_16x16x32_bf16 v[76:79], v[124:127], v[112:115], v[76:79]
  ds_read_b64_tr_b16 v[166:167], v27 offset:58368
  buffer_load_dwordx4 v8, s[40:43], s70 offen lds
  v_mfma_f32_16x16x32_bf16 v[80:83], v[128:131], v[112:115], v[80:83]
  ds_read_b128 v[148:151], v11 offset:38912
  v_mfma_f32_16x16x32_bf16 v[84:87], v[132:135], v[112:115], v[84:87]
  s_add_u32 m0, s68, 28672
  v_mfma_f32_16x16x32_bf16 v[100:103], v[132:135], v[116:119], v[100:103]
  v_mfma_f32_16x16x32_bf16 v[96:99], v[128:131], v[116:119], v[96:99]
  buffer_load_dwordx4 v9, s[40:43], s70 offen lds
  v_mfma_f32_16x16x32_bf16 v[92:95], v[124:127], v[116:119], v[92:95]
  v_mfma_f32_16x16x32_bf16 v[88:91], v[120:123], v[116:119], v[88:91]
  s_waitcnt lgkmcnt(0)
  v_mfma_f32_16x16x32_bf16 v[40:43], v[152:155], v[136:139], v[40:43]
  v_mfma_f32_16x16x32_bf16 v[44:47], v[156:159], v[136:139], v[44:47]
  v_mfma_f32_16x16x32_bf16 v[48:51], v[160:163], v[136:139], v[48:51]
  s_waitcnt vmcnt(16)
  s_barrier
  ds_read_b64_tr_b16 v[120:121], v28 offset:16384
  ds_read_b64_tr_b16 v[122:123], v28 offset:17408
  s_add_u32 m0, s68, 32768
  v_mfma_f32_16x16x32_bf16 v[52:55], v[164:167], v[136:139], v[52:55]
  ds_read_b128 v[104:107], v12 offset:0
L_pad2:
  s_cbranch_execz L_pad50
  buffer_load_dwordx4 v2, s[44:47], s10 offen lds
  v_mfma_f32_16x16x32_bf16 v[68:71], v[164:167], v[140:143], v[68:71]
  ds_read_b64_tr_b16 v[124:125], v29 offset:16384
  v_readlane_b32 s69, v16, 14
  v_mfma_f32_16x16x32_bf16 v[64:67], v[160:163], v[140:143], v[64:67]
  ds_read_b64_tr_b16 v[126:127], v29 offset:17408
  ds_read_b128 v[108:111], v12 offset:2048
  s_add_u32 m0, s68, 36864
  v_mfma_f32_16x16x32_bf16 v[60:63], v[156:159], v[140:143], v[60:63]
  ds_read_b64_tr_b16 v[128:129], v30 offset:16384
  v_mfma_f32_16x16x32_bf16 v[56:59], v[152:155], v[140:143], v[56:59]
  ds_read_b64_tr_b16 v[130:131], v30 offset:17408
  buffer_load_dwordx4 v3, s[44:47], s10 offen lds
  v_mfma_f32_16x16x32_bf16 v[72:75], v[152:155], v[144:147], v[72:75]
  ds_read_b128 v[112:115], v12 offset:4096
  ds_read_b64_tr_b16 v[132:133], v31 offset:16384
  s_add_u32 m0, s68, 40960
  v_mfma_f32_16x16x32_bf16 v[76:79], v[156:159], v[144:147], v[76:79]
  ds_read_b64_tr_b16 v[134:135], v31 offset:17408
  buffer_load_dwordx4 v4, s[44:47], s10 offen lds
  v_mfma_f32_16x16x32_bf16 v[80:83], v[160:163], v[144:147], v[80:83]
  ds_read_b128 v[116:119], v12 offset:6144
  v_mfma_f32_16x16x32_bf16 v[84:87], v[164:167], v[144:147], v[84:87]
  s_add_u32 m0, s68, 45056
  v_mfma_f32_16x16x32_bf16 v[100:103], v[164:167], v[148:151], v[100:103]
  buffer_load_dwordx4 v5, s[44:47], s10 offen lds
  v_mfma_f32_16x16x32_bf16 v[96:99], v[160:163], v[148:151], v[96:99]
  s_mul_i32 s70, s69, 640
  v_mfma_f32_16x16x32_bf16 v[92:95], v[156:159], v[148:151], v[92:95]
  v_mfma_f32_16x16x32_bf16 v[88:91], v[152:155], v[148:151], v[88:91]
  s_waitcnt lgkmcnt(0)
  ds_read_b64_tr_b16 v[152:153], v28 offset:24576
  s_add_u32 m0, s68, 49152
  v_mfma_f32_16x16x32_bf16 v[40:43], v[120:123], v[104:107], v[40:43]
  ds_read_b64_tr_b16 v[154:155], v28 offset:25600
  v_mfma_f32_16x16x32_bf16 v[44:47], v[124:127], v[104:107], v[44:47]
  ds_read_b128 v[136:139], v13 offset:0
  buffer_load_dwordx4 v6, s[40:43], s11 offen lds
  v_mfma_f32_16x16x32_bf16 v[48:51], v[128:131], v[104:107], v[48:51]
  ds_read_b64_tr_b16 v[156:157], v29 offset:24576
  v_mfma_f32_16x16x32_bf16 v[52:55], v[132:135], v[104:107], v[52:55]
  ds_read_b64_tr_b16 v[158:159], v29 offset:25600
  s_add_u32 m0, s68, 53248
  v_mfma_f32_16x16x32_bf16 v[68:71], v[132:135], v[108:111], v[68:71]
  ds_read_b128 v[140:143], v13 offset:2048
  v_mfma_f32_16x16x32_bf16 v[64:67], v[128:131], v[108:111], v[64:67]
  ds_read_b64_tr_b16 v[160:161], v30 offset:24576
  buffer_load_dwordx4 v7, s[40:43], s11 offen lds
  v_mfma_f32_16x16x32_bf16 v[60:63], v[124:127], v[108:111], v[60:63]
  ds_read_b64_tr_b16 v[162:163], v30 offset:25600
  v_mfma_f32_16x16x32_bf16 v[56:59], v[120:123], v[108:111], v[56:59]
  ds_read_b128 v[144:147], v13 offset:4096
  s_add_u32 m0, s68, 57344
  v_mfma_f32_16x16x32_bf16 v[72:75], v[120:123], v[112:115], v[72:75]
  ds_read_b64_tr_b16 v[164:165], v31 offset:24576
  v_mfma_f32_16x16x32_bf16 v[76:79], v[124:127], v[112:115], v[76:79]
  ds_read_b64_tr_b16 v[166:167], v31 offset:25600
  buffer_load_dwordx4 v8, s[40:43], s11 offen lds
  v_mfma_f32_16x16x32_bf16 v[80:83], v[128:131], v[112:115], v[80:83]
  ds_read_b128 v[148:151], v13 offset:6144
  v_mfma_f32_16x16x32_bf16 v[84:87], v[132:135], v[112:115], v[84:87]
  s_add_u32 m0, s68, 61440
  v_mfma_f32_16x16x32_bf16 v[100:103], v[132:135], v[116:119], v[100:103]
  v_mfma_f32_16x16x32_bf16 v[96:99], v[128:131], v[116:119], v[96:99]
  buffer_load_dwordx4 v9, s[40:43], s11 offen lds
  v_mfma_f32_16x16x32_bf16 v[92:95], v[124:127], v[116:119], v[92:95]
  v_mfma_f32_16x16x32_bf16 v[88:91], v[120:123], v[116:119], v[88:91]
  s_waitcnt lgkmcnt(0)
  v_mfma_f32_16x16x32_bf16 v[40:43], v[152:155], v[136:139], v[40:43]
  v_mfma_f32_16x16x32_bf16 v[44:47], v[156:159], v[136:139], v[44:47]
  v_mfma_f32_16x16x32_bf16 v[48:51], v[160:163], v[136:139], v[48:51]
  s_waitcnt vmcnt(16)
  s_barrier
  ds_read_b64_tr_b16 v[120:121], v28 offset:49152
  ds_read_b64_tr_b16 v[122:123], v28 offset:50176
  s_add_u32 m0, s68, 65536
  v_mfma_f32_16x16x32_bf16 v[52:55], v[164:167], v[136:139], v[52:55]
  ds_read_b128 v[104:107], v12 offset:32768
  buffer_load_dwordx4 v2, s[44:47], s69 offen lds
  v_mfma_f32_16x16x32_bf16 v[68:71], v[164:167], v[140:143], v[68:71]
  ds_read_b64_tr_b16 v[124:125], v29 offset:49152
  v_readlane_b32 s10, v16, 15
  v_mfma_f32_16x16x32_bf16 v[64:67], v[160:163], v[140:143], v[64:67]
  ds_read_b64_tr_b16 v[126:127], v29 offset:50176
  ds_read_b128 v[108:111], v12 offset:34816
  s_add_u32 m0, s68, 69632
  v_mfma_f32_16x16x32_bf16 v[60:63], v[156:159], v[140:143], v[60:63]
  ds_read_b64_tr_b16 v[128:129], v30 offset:49152
  v_mfma_f32_16x16x32_bf16 v[56:59], v[152:155], v[140:143], v[56:59]
  ds_read_b64_tr_b16 v[130:131], v30 offset:50176
  buffer_load_dwordx4 v3, s[44:47], s69 offen lds
  v_mfma_f32_16x16x32_bf16 v[72:75], v[152:155], v[144:147], v[72:75]
  ds_read_b128 v[112:115], v12 offset:36864
  ds_read_b64_tr_b16 v[132:133], v31 offset:49152
  s_add_u32 m0, s68, 73728
  v_mfma_f32_16x16x32_bf16 v[76:79], v[156:159], v[144:147], v[76:79]
  ds_read_b64_tr_b16 v[134:135], v31 offset:50176
  buffer_load_dwordx4 v4, s[44:47], s69 offen lds
  v_mfma_f32_16x16x32_bf16 v[80:83], v[160:163], v[144:147], v[80:83]
  ds_read_b128 v[116:119], v12 offset:38912
  v_mfma_f32_16x16x32_bf16 v[84:87], v[164:167], v[144:147], v[84:87]
  s_add_u32 m0, s68, 77824
  v_mfma_f32_16x16x32_bf16 v[100:103], v[164:167], v[148:151], v[100:103]
  buffer_load_dwordx4 v5, s[44:47], s69 offen lds
  v_mfma_f32_16x16x32_bf16 v[96:99], v[160:163], v[148:151], v[96:99]
  s_mul_i32 s11, s10, 640
  v_mfma_f32_16x16x32_bf16 v[92:95], v[156:159], v[148:151], v[92:95]
  v_mfma_f32_16x16x32_bf16 v[88:91], v[152:155], v[148:151], v[88:91]
  s_waitcnt lgkmcnt(0)
  ds_read_b64_tr_b16 v[152:153], v28 offset:57344
  s_add_u32 m0, s68, 81920
  v_mfma_f32_16x16x32_bf16 v[40:43], v[120:123], v[104:107], v[40:43]
  ds_read_b64_tr_b16 v[154:155], v28 offset:58368
  v_mfma_f32_16x16x32_bf16 v[44:47], v[124:127], v[104:107], v[44:47]
  ds_read_b128 v[136:139], v13 offset:32768
  buffer_load_dwordx4 v6, s[40:43], s70 offen lds
  v_mfma_f32_16x16x32_bf16 v[48:51], v[128:131], v[104:107], v[48:51]
  ds_read_b64_tr_b16 v[156:157], v29 offset:57344
  v_mfma_f32_16x16x32_bf16 v[52:55], v[132:135], v[104:107], v[52:55]
  ds_read_b64_tr_b16 v[158:159], v29 offset:58368
  s_add_u32 m0, s68, 86016
  v_mfma_f32_16x16x32_bf16 v[68:71], v[132:135], v[108:111], v[68:71]
  ds_read_b128 v[140:143], v13 offset:34816
  v_mfma_f32_16x16x32_bf16 v[64:67], v[128:131], v[108:111], v[64:67]
  ds_read_b64_tr_b16 v[160:161], v30 offset:57344
  buffer_load_dwordx4 v7, s[40:43], s70 offen lds
  v_mfma_f32_16x16x32_bf16 v[60:63], v[124:127], v[108:111], v[60:63]
  ds_read_b64_tr_b16 v[162:163], v30 offset:58368
  v_mfma_f32_16x16x32_bf16 v[56:59], v[120:123], v[108:111], v[56:59]
  ds_read_b128 v[144:147], v13 offset:36864
  s_add_u32 m0, s68, 90112
  v_mfma_f32_16x16x32_bf16 v[72:75], v[120:123], v[112:115], v[72:75]
  ds_read_b64_tr_b16 v[164:165], v31 offset:57344
  v_mfma_f32_16x16x32_bf16 v[76:79], v[124:127], v[112:115], v[76:79]
  ds_read_b64_tr_b16 v[166:167], v31 offset:58368
  buffer_load_dwordx4 v8, s[40:43], s70 offen lds
  v_mfma_f32_16x16x32_bf16 v[80:83], v[128:131], v[112:115], v[80:83]
  ds_read_b128 v[148:151], v13 offset:38912
  v_mfma_f32_16x16x32_bf16 v[84:87], v[132:135], v[112:115], v[84:87]
  s_add_u32 m0, s68, 94208
  v_mfma_f32_16x16x32_bf16 v[100:103], v[132:135], v[116:119], v[100:103]
  v_mfma_f32_16x16x32_bf16 v[96:99], v[128:131], v[116:119], v[96:99]
  buffer_load_dwordx4 v9, s[40:43], s70 offen lds
  v_mfma_f32_16x16x32_bf16 v[92:95], v[124:127], v[116:119], v[92:95]
  v_mfma_f32_16x16x32_bf16 v[88:91], v[120:123], v[116:119], v[88:91]
  s_waitcnt lgkmcnt(0)
  v_mfma_f32_16x16x32_bf16 v[40:43], v[152:155], v[136:139], v[40:43]
  v_mfma_f32_16x16x32_bf16 v[44:47], v[156:159], v[136:139], v[44:47]
  v_mfma_f32_16x16x32_bf16 v[48:51], v[160:163], v[136:139], v[48:51]
  s_waitcnt vmcnt(16)
  s_barrier
  ds_read_b64_tr_b16 v[120:121], v24 offset:16384
  ds_read_b64_tr_b16 v[122:123], v24 offset:17408
  s_add_u32 m0, s68, 98304
  v_mfma_f32_16x16x32_bf16 v[52:55], v[164:167], v[136:139], v[52:55]
  ds_read_b128 v[104:107], v10 offset:0
  buffer_load_dwordx4 v2, s[44:47], s10 offen lds
  v_mfma_f32_16x16x32_bf16 v[68:71], v[164:167], v[140:143], v[68:71]
  ds_read_b64_tr_b16 v[124:125], v25 offset:16384
  v_readlane_b32 s69, v16, 16
  v_mfma_f32_16x16x32_bf16 v[64:67], v[160:163], v[140:143], v[64:67]
  ds_read_b64_tr_b16 v[126:127], v25 offset:17408
  ds_read_b128 v[108:111], v10 offset:2048
  s_add_u32 m0, s68, 102400
  v_mfma_f32_16x16x32_bf16 v[60:63], v[156:159], v[140:143], v[60:63]
  ds_read_b64_tr_b16 v[128:129], v26 offset:16384
  v_mfma_f32_16x16x32_bf16 v[56:59], v[152:155], v[140:143], v[56:59]
  ds_read_b64_tr_b16 v[130:131], v26 offset:17408
  buffer_load_dwordx4 v3, s[44:47], s10 offen lds
  v_mfma_f32_16x16x32_bf16 v[72:75], v[152:155], v[144:147], v[72:75]
  ds_read_b128 v[112:115], v10 offset:4096
  ds_read_b64_tr_b16 v[132:133], v27 offset:16384
  s_add_u32 m0, s68, 106496
  v_mfma_f32_16x16x32_bf16 v[76:79], v[156:159], v[144:147], v[76:79]
  ds_read_b64_tr_b16 v[134:135], v27 offset:17408
  buffer_load_dwordx4 v4, s[44:47], s10 offen lds
  v_mfma_f32_16x16x32_bf16 v[80:83], v[160:163], v[144:147], v[80:83]
  ds_read_b128 v[116:119], v10 offset:6144
  v_mfma_f32_16x16x32_bf16 v[84:87], v[164:167], v[144:147], v[84:87]
  s_add_u32 m0, s68, 110592
  v_mfma_f32_16x16x32_bf16 v[100:103], v[164:167], v[148:151], v[100:103]
  buffer_load_dwordx4 v5, s[44:47], s10 offen lds
  v_mfma_f32_16x16x32_bf16 v[96:99], v[160:163], v[148:151], v[96:99]
  s_mul_i32 s70, s69, 640
  v_mfma_f32_16x16x32_bf16 v[92:95], v[156:159], v[148:151], v[92:95]
  v_mfma_f32_16x16x32_bf16 v[88:91], v[152:155], v[148:151], v[88:91]
  s_waitcnt lgkmcnt(0)
  ds_read_b64_tr_b16 v[152:153], v24 offset:24576
  s_add_u32 m0, s68, 114688
  v_mfma_f32_16x16x32_bf16 v[40:43], v[120:123], v[104:107], v[40:43]
  ds_read_b64_tr_b16 v[154:155], v24 offset:25600
  v_mfma_f32_16x16x32_bf16 v[44:47], v[124:127], v[104:107], v[44:47]
  ds_read_b128 v[136:139], v11 offset:0
  buffer_load_dwordx4 v6, s[40:43], s11 offen lds
  v_mfma_f32_16x16x32_bf16 v[48:51], v[128:131], v[104:107], v[48:51]
  ds_read_b64_tr_b16 v[156:157], v25 offset:24576
  v_mfma_f32_16x16x32_bf16 v[52:55], v[132:135], v[104:107], v[52:55]
  ds_read_b64_tr_b16 v[158:159], v25 offset:25600
  s_add_u32 m0, s68, 118784
  v_mfma_f32_16x16x32_bf16 v[68:71], v[132:135], v[108:111], v[68:71]
  ds_read_b128 v[140:143], v11 offset:2048
  v_mfma_f32_16x16x32_bf16 v[64:67], v[128:131], v[108:111], v[64:67]
  ds_read_b64_tr_b16 v[160:161], v26 offset:24576
  buffer_load_dwordx4 v7, s[40:43], s11 offen lds
  v_mfma_f32_16x16x32_bf16 v[60:63], v[124:127], v[108:111], v[60:63]
  ds_read_b64_tr_b16 v[162:163], v26 offset:25600
  v_mfma_f32_16x16x32_bf16 v[56:59], v[120:123], v[108:111], v[56:59]
  ds_read_b128 v[144:147], v11 offset:4096
  s_add_u32 m0, s68, 122880
  v_mfma_f32_16x16x32_bf16 v[72:75], v[120:123], v[112:115], v[72:75]
  ds_read_b64_tr_b16 v[164:165], v27 offset:24576
  v_mfma_f32_16x16x32_bf16 v[76:79], v[124:127], v[112:115], v[76:79]
  ds_read_b64_tr_b16 v[166:167], v27 offset:25600
  buffer_load_dwordx4 v8, s[40:43], s11 offen lds
  v_mfma_f32_16x16x32_bf16 v[80:83], v[128:131], v[112:115], v[80:83]
  ds_read_b128 v[148:151], v11 offset:6144
  v_mfma_f32_16x16x32_bf16 v[84:87], v[132:135], v[112:115], v[84:87]
  s_add_u32 m0, s68, 126976
  v_mfma_f32_16x16x32_bf16 v[100:103], v[132:135], v[116:119], v[100:103]
  v_mfma_f32_16x16x32_bf16 v[96:99], v[128:131], v[116:119], v[96:99]
  buffer_load_dwordx4 v9, s[40:43], s11 offen lds
  v_mfma_f32_16x16x32_bf16 v[92:95], v[124:127], v[116:119], v[92:95]
  v_mfma_f32_16x16x32_bf16 v[88:91], v[120:123], v[116:119], v[88:91]
  s_waitcnt lgkmcnt(0)
  v_mfma_f32_16x16x32_bf16 v[40:43], v[152:155], v[136:139], v[40:43]
  v_mfma_f32_16x16x32_bf16 v[44:47], v[156:159], v[136:139], v[44:47]
  v_mfma_f32_16x16x32_bf16 v[48:51], v[160:163], v[136:139], v[48:51]
  s_waitcnt vmcnt(16)
  s_barrier
  ds_read_b64_tr_b16 v[120:121], v24 offset:49152
  ds_read_b64_tr_b16 v[122:123], v24 offset:50176
  s_add_u32 m0, s68, 0
  v_mfma_f32_16x16x32_bf16 v[52:55], v[164:167], v[136:139], v[52:55]
  ds_read_b128 v[104:107], v10 offset:32768
  buffer_load_dwordx4 v2, s[44:47], s69 offen lds
  v_mfma_f32_16x16x32_bf16 v[68:71], v[164:167], v[140:143], v[68:71]
  ds_read_b64_tr_b16 v[124:125], v25 offset:49152
  v_readlane_b32 s10, v16, 17
  v_mfma_f32_16x16x32_bf16 v[64:67], v[160:163], v[140:143], v[64:67]
  ds_read_b64_tr_b16 v[126:127], v25 offset:50176
  ds_read_b128 v[108:111], v10 offset:34816
  s_add_u32 m0, s68, 4096
  v_mfma_f32_16x16x32_bf16 v[60:63], v[156:159], v[140:143], v[60:63]
  ds_read_b64_tr_b16 v[128:129], v26 offset:49152
  v_mfma_f32_16x16x32_bf16 v[56:59], v[152:155], v[140:143], v[56:59]
  ds_read_b64_tr_b16 v[130:131], v26 offset:50176
  buffer_load_dwordx4 v3, s[44:47], s69 offen lds
  v_mfma_f32_16x16x32_bf16 v[72:75], v[152:155], v[144:147], v[72:75]
  ds_read_b128 v[112:115], v10 offset:36864
  ds_read_b64_tr_b16 v[132:133], v27 offset:49152
  s_add_u32 m0, s68, 8192
  v_mfma_f32_16x16x32_bf16 v[76:79], v[156:159], v[144:147], v[76:79]
  ds_read_b64_tr_b16 v[134:135], v27 offset:50176
  buffer_load_dwordx4 v4, s[44:47], s69 offen lds
  v_mfma_f32_16x16x32_bf16 v[80:83], v[160:163], v[144:147], v[80:83]
  ds_read_b128 v[116:119], v10 offset:38912
  v_mfma_f32_16x16x32_bf16 v[84:87], v[164:167], v[144:147], v[84:87]
  s_add_u32 m0, s68, 12288
  v_mfma_f32_16x16x32_bf16 v[100:103], v[164:167], v[148:151], v[100:103]
  buffer_load_dwordx4 v5, s[44:47], s69 offen lds
  v_mfma_f32_16x16x32_bf16 v[96:99], v[160:163], v[148:151], v[96:99]
  s_mul_i32 s11, s10, 640
L_pad3:
  s_cbranch_execz L_pad51
  v_mfma_f32_16x16x32_bf16 v[92:95], v[156:159], v[148:151], v[92:95]
  v_mfma_f32_16x16x32_bf16 v[88:91], v[152:155], v[148:151], v[88:91]
  s_waitcnt lgkmcnt(0)
  ds_read_b64_tr_b16 v[152:153], v24 offset:57344
  s_add_u32 m0, s68, 16384
  v_mfma_f32_16x16x32_bf16 v[40:43], v[120:123], v[104:107], v[40:43]
  ds_read_b64_tr_b16 v[154:155], v24 offset:58368
  v_mfma_f32_16x16x32_bf16 v[44:47], v[124:127], v[104:107], v[44:47]
  ds_read_b128 v[136:139], v11 offset:32768
  buffer_load_dwordx4 v6, s[40:43], s70 offen lds
  v_mfma_f32_16x16x32_bf16 v[48:51], v[128:131], v[104:107], v[48:51]
  ds_read_b64_tr_b16 v[156:157], v25 offset:57344
  v_mfma_f32_16x16x32_bf16 v[52:55], v[132:135], v[104:107], v[52:55]
  ds_read_b64_tr_b16 v[158:159], v25 offset:58368
  s_add_u32 m0, s68, 20480
  v_mfma_f32_16x16x32_bf16 v[68:71], v[132:135], v[108:111], v[68:71]
  ds_read_b128 v[140:143], v11 offset:34816
  v_mfma_f32_16x16x32_bf16 v[64:67], v[128:131], v[108:111], v[64:67]
  ds_read_b64_tr_b16 v[160:161], v26 offset:57344
  buffer_load_dwordx4 v7, s[40:43], s70 offen lds
  v_mfma_f32_16x16x32_bf16 v[60:63], v[124:127], v[108:111], v[60:63]
  ds_read_b64_tr_b16 v[162:163], v26 offset:58368
  v_mfma_f32_16x16x32_bf16 v[56:59], v[120:123], v[108:111], v[56:59]
  ds_read_b128 v[144:147], v11 offset:36864
  s_add_u32 m0, s68, 24576
  v_mfma_f32_16x16x32_bf16 v[72:75], v[120:123], v[112:115], v[72:75]
  ds_read_b64_tr_b16 v[164:165], v27 offset:57344
  v_mfma_f32_16x16x32_bf16 v[76:79], v[124:127], v[112:115], v[76:79]
  ds_read_b64_tr_b16 v[166:167], v27 offset:58368
  buffer_load_dwordx4 v8, s[40:43], s70 offen lds
  v_mfma_f32_16x16x32_bf16 v[80:83], v[128:131], v[112:115], v[80:83]
  ds_read_b128 v[148:151], v11 offset:38912
  v_mfma_f32_16x16x32_bf16 v[84:87], v[132:135], v[112:115], v[84:87]
  s_add_u32 m0, s68, 28672
  v_mfma_f32_16x16x32_bf16 v[100:103], v[132:135], v[116:119], v[100:103]
  v_mfma_f32_16x16x32_bf16 v[96:99], v[128:131], v[116:119], v[96:99]
  buffer_load_dwordx4 v9, s[40:43], s70 offen lds
  v_mfma_f32_16x16x32_bf16 v[92:95], v[124:127], v[116:119], v[92:95]
  v_mfma_f32_16x16x32_bf16 v[88:91], v[120:123], v[116:119], v[88:91]
  s_waitcnt lgkmcnt(0)
  v_mfma_f32_16x16x32_bf16 v[40:43], v[152:155], v[136:139], v[40:43]
  v_mfma_f32_16x16x32_bf16 v[44:47], v[156:159], v[136:139], v[44:47]
  v_mfma_f32_16x16x32_bf16 v[48:51], v[160:163], v[136:139], v[48:51]
  s_waitcnt vmcnt(16)
  s_barrier
  ds_read_b64_tr_b16 v[120:121], v28 offset:16384
  ds_read_b64_tr_b16 v[122:123], v28 offset:17408
  s_add_u32 m0, s68, 32768
  v_mfma_f32_16x16x32_bf16 v[52:55], v[164:167], v[136:139], v[52:55]
  ds_read_b128 v[104:107], v12 offset:0
  buffer_load_dwordx4 v2, s[44:47], s10 offen lds
  v_mfma_f32_16x16x32_bf16 v[68:71], v[164:167], v[140:143], v[68:71]
  ds_read_b64_tr_b16 v[124:125], v29 offset:16384
  v_readlane_b32 s69, v16, 18
  v_mfma_f32_16x16x32_bf16 v[64:67], v[160:163], v[140:143], v[64:67]
  ds_read_b64_tr_b16 v[126:127], v29 offset:17408
  ds_read_b128 v[108:111], v12 offset:2048
  s_add_u32 m0, s68, 36864
  v_mfma_f32_16x16x32_bf16 v[60:63], v[156:159], v[140:143], v[60:63]
  ds_read_b64_tr_b16 v[128:129], v30 offset:16384
  v_mfma_f32_16x16x32_bf16 v[56:59], v[152:155], v[140:143], v[56:59]
  ds_read_b64_tr_b16 v[130:131], v30 offset:17408
  buffer_load_dwordx4 v3, s[44:47], s10 offen lds
  v_mfma_f32_16x16x32_bf16 v[72:75], v[152:155], v[144:147], v[72:75]
  ds_read_b128 v[112:115], v12 offset:4096
  ds_read_b64_tr_b16 v[132:133], v31 offset:16384
  s_add_u32 m0, s68, 40960
  v_mfma_f32_16x16x32_bf16 v[76:79], v[156:159], v[144:147], v[76:79]
  ds_read_b64_tr_b16 v[134:135], v31 offset:17408
  buffer_load_dwordx4 v4, s[44:47], s10 offen lds
  v_mfma_f32_16x16x32_bf16 v[80:83], v[160:163], v[144:147], v[80:83]
  ds_read_b128 v[116:119], v12 offset:6144
  v_mfma_f32_16x16x32_bf16 v[84:87], v[164:167], v[144:147], v[84:87]
  s_add_u32 m0, s68, 45056
  v_mfma_f32_16x16x32_bf16 v[100:103], v[164:167], v[148:151], v[100:103]
  buffer_load_dwordx4 v5, s[44:47], s10 offen lds
  v_mfma_f32_16x16x32_bf16 v[96:99], v[160:163], v[148:151], v[96:99]
  s_mul_i32 s70, s69, 640
  v_mfma_f32_16x16x32_bf16 v[92:95], v[156:159], v[148:151], v[92:95]
  v_mfma_f32_16x16x32_bf16 v[88:91], v[152:155], v[148:151], v[88:91]
  s_waitcnt lgkmcnt(0)
  ds_read_b64_tr_b16 v[152:153], v28 offset:24576
  s_add_u32 m0, s68, 49152
  v_mfma_f32_16x16x32_bf16 v[40:43], v[120:123], v[104:107], v[40:43]
  ds_read_b64_tr_b16 v[154:155], v28 offset:25600
  v_mfma_f32_16x16x32_bf16 v[44:47], v[124:127], v[104:107], v[44:47]
  ds_read_b128 v[136:139], v13 offset:0
  buffer_load_dwordx4 v6, s[40:43], s11 offen lds
  v_mfma_f32_16x16x32_bf16 v[48:51], v[128:131], v[104:107], v[48:51]
  ds_read_b64_tr_b16 v[156:157], v29 offset:24576
  v_mfma_f32_16x16x32_bf16 v[52:55], v[132:135], v[104:107], v[52:55]
  ds_read_b64_tr_b16 v[158:159], v29 offset:25600
  s_add_u32 m0, s68, 53248
  v_mfma_f32_16x16x32_bf16 v[68:71], v[132:135], v[108:111], v[68:71]
  ds_read_b128 v[140:143], v13 offset:2048
  v_mfma_f32_16x16x32_bf16 v[64:67], v[128:131], v[108:111], v[64:67]
  ds_read_b64_tr_b16 v[160:161], v30 offset:24576
  buffer_load_dwordx4 v7, s[40:43], s11 offen lds
  v_mfma_f32_16x16x32_bf16 v[60:63], v[124:127], v[108:111], v[60:63]
  ds_read_b64_tr_b16 v[162:163], v30 offset:25600
  v_mfma_f32_16x16x32_bf16 v[56:59], v[120:123], v[108:111], v[56:59]
  ds_read_b128 v[144:147], v13 offset:4096
  s_add_u32 m0, s68, 57344
  v_mfma_f32_16x16x32_bf16 v[72:75], v[120:123], v[112:115], v[72:75]
  ds_read_b64_tr_b16 v[164:165], v31 offset:24576
  v_mfma_f32_16x16x32_bf16 v[76:79], v[124:127], v[112:115], v[76:79]
  ds_read_b64_tr_b16 v[166:167], v31 offset:25600
  buffer_load_dwordx4 v8, s[40:43], s11 offen lds
  v_mfma_f32_16x16x32_bf16 v[80:83], v[128:131], v[112:115], v[80:83]
  ds_read_b128 v[148:151], v13 offset:6144
  v_mfma_f32_16x16x32_bf16 v[84:87], v[132:135], v[112:115], v[84:87]
  s_add_u32 m0, s68, 61440
  v_mfma_f32_16x16x32_bf16 v[100:103], v[132:135], v[116:119], v[100:103]
  v_mfma_f32_16x16x32_bf16 v[96:99], v[128:131], v[116:119], v[96:99]
  buffer_load_dwordx4 v9, s[40:43], s11 offen lds
  v_mfma_f32_16x16x32_bf16 v[92:95], v[124:127], v[116:119], v[92:95]
  v_mfma_f32_16x16x32_bf16 v[88:91], v[120:123], v[116:119], v[88:91]
  s_waitcnt lgkmcnt(0)
  v_mfma_f32_16x16x32_bf16 v[40:43], v[152:155], v[136:139], v[40:43]
  v_mfma_f32_16x16x32_bf16 v[44:47], v[156:159], v[136:139], v[44:47]
  v_mfma_f32_16x16x32_bf16 v[48:51], v[160:163], v[136:139], v[48:51]
  s_waitcnt vmcnt(16)
  s_barrier
  ds_read_b64_tr_b16 v[120:121], v28 offset:49152
  ds_read_b64_tr_b16 v[122:123], v28 offset:50176
  s_add_u32 m0, s68, 65536
  v_mfma_f32_16x16x32_bf16 v[52:55], v[164:167], v[136:139], v[52:55]
  ds_read_b128 v[104:107], v12 offset:32768
  buffer_load_dwordx4 v2, s[44:47], s69 offen lds
  v_mfma_f32_16x16x32_bf16 v[68:71], v[164:167], v[140:143], v[68:71]
  ds_read_b64_tr_b16 v[124:125], v29 offset:49152
  v_readlane_b32 s10, v16, 19
  v_mfma_f32_16x16x32_bf16 v[64:67], v[160:163], v[140:143], v[64:67]
  ds_read_b64_tr_b16 v[126:127], v29 offset:50176
  ds_read_b128 v[108:111], v12 offset:34816
  s_add_u32 m0, s68, 69632
  v_mfma_f32_16x16x32_bf16 v[60:63], v[156:159], v[140:143], v[60:63]
  ds_read_b64_tr_b16 v[128:129], v30 offset:49152
  v_mfma_f32_16x16x32_bf16 v[56:59], v[152:155], v[140:143], v[56:59]
  ds_read_b64_tr_b16 v[130:131], v30 offset:50176
  buffer_load_dwordx4 v3, s[44:47], s69 offen lds
  v_mfma_f32_16x16x32_bf16 v[72:75], v[152:155], v[144:147], v[72:75]
  ds_read_b128 v[112:115], v12 offset:36864
  ds_read_b64_tr_b16 v[132:133], v31 offset:49152
  s_add_u32 m0, s68, 73728
  v_mfma_f32_16x16x32_bf16 v[76:79], v[156:159], v[144:147], v[76:79]
  ds_read_b64_tr_b16 v[134:135], v31 offset:50176
  buffer_load_dwordx4 v4, s[44:47], s69 offen lds
  v_mfma_f32_16x16x32_bf16 v[80:83], v[160:163], v[144:147], v[80:83]
  ds_read_b128 v[116:119], v12 offset:38912
  v_mfma_f32_16x16x32_bf16 v[84:87], v[164:167], v[144:147], v[84:87]
  s_add_u32 m0, s68, 77824
  v_mfma_f32_16x16x32_bf16 v[100:103], v[164:167], v[148:151], v[100:103]
  buffer_load_dwordx4 v5, s[44:47], s69 offen lds
  v_mfma_f32_16x16x32_bf16 v[96:99], v[160:163], v[148:151], v[96:99]
  s_mul_i32 s11, s10, 640
  v_mfma_f32_16x16x32_bf16 v[92:95], v[156:159], v[148:151], v[92:95]
  v_mfma_f32_16x16x32_bf16 v[88:91], v[152:155], v[148:151], v[88:91]
  s_waitcnt lgkmcnt(0)
  ds_read_b64_tr_b16 v[152:153], v28 offset:57344
  s_add_u32 m0, s68, 81920
  v_mfma_f32_16x16x32_bf16 v[40:43], v[120:123], v[104:107], v[40:43]
  ds_read_b64_tr_b16 v[154:155], v28 offset:58368
  v_mfma_f32_16x16x32_bf16 v[44:47], v[124:127], v[104:107], v[44:47]
  ds_read_b128 v[136:139], v13 offset:32768
  buffer_load_dwordx4 v6, s[40:43], s70 offen lds
  v_mfma_f32_16x16x32_bf16 v[48:51], v[128:131], v[104:107], v[48:51]
  ds_read_b64_tr_b16 v[156:157], v29 offset:57344
  v_mfma_f32_16x16x32_bf16 v[52:55], v[132:135], v[104:107], v[52:55]
  ds_read_b64_tr_b16 v[158:159], v29 offset:58368
  s_add_u32 m0, s68, 86016
  v_mfma_f32_16x16x32_bf16 v[68:71], v[132:135], v[108:111], v[68:71]
  ds_read_b128 v[140:143], v13 offset:34816
  v_mfma_f32_16x16x32_bf16 v[64:67], v[128:131], v[108:111], v[64:67]
  ds_read_b64_tr_b16 v[160:161], v30 offset:57344
  buffer_load_dwordx4 v7, s[40:43], s70 offen lds
  v_mfma_f32_16x16x32_bf16 v[60:63], v[124:127], v[108:111], v[60:63]
  ds_read_b64_tr_b16 v[162:163], v30 offset:58368
  v_mfma_f32_16x16x32_bf16 v[56:59], v[120:123], v[108:111], v[56:59]
  ds_read_b128 v[144:147], v13 offset:36864
  s_add_u32 m0, s68, 90112
  v_mfma_f32_16x16x32_bf16 v[72:75], v[120:123], v[112:115], v[72:75]
  ds_read_b64_tr_b16 v[164:165], v31 offset:57344
  v_mfma_f32_16x16x32_bf16 v[76:79], v[124:127], v[112:115], v[76:79]
  ds_read_b64_tr_b16 v[166:167], v31 offset:58368
  buffer_load_dwordx4 v8, s[40:43], s70 offen lds
  v_mfma_f32_16x16x32_bf16 v[80:83], v[128:131], v[112:115], v[80:83]
  ds_read_b128 v[148:151], v13 offset:38912
  v_mfma_f32_16x16x32_bf16 v[84:87], v[132:135], v[112:115], v[84:87]
  s_add_u32 m0, s68, 94208
  v_mfma_f32_16x16x32_bf16 v[100:103], v[132:135], v[116:119], v[100:103]
  v_mfma_f32_16x16x32_bf16 v[96:99], v[128:131], v[116:119], v[96:99]
  buffer_load_dwordx4 v9, s[40:43], s70 offen lds
  v_mfma_f32_16x16x32_bf16 v[92:95], v[124:127], v[116:119], v[92:95]
  v_mfma_f32_16x16x32_bf16 v[88:91], v[120:123], v[116:119], v[88:91]
  s_waitcnt lgkmcnt(0)
  v_mfma_f32_16x16x32_bf16 v[40:43], v[152:155], v[136:139], v[40:43]
  v_mfma_f32_16x16x32_bf16 v[44:47], v[156:159], v[136:139], v[44:47]
  v_mfma_f32_16x16x32_bf16 v[48:51], v[160:163], v[136:139], v[48:51]
  s_waitcnt vmcnt(16)
  s_barrier
  ds_read_b64_tr_b16 v[120:121], v24 offset:16384
  ds_read_b64_tr_b16 v[122:123], v24 offset:17408
  s_add_u32 m0, s68, 98304
  v_mfma_f32_16x16x32_bf16 v[52:55], v[164:167], v[136:139], v[52:55]
  ds_read_b128 v[104:107], v10 offset:0
  buffer_load_dwordx4 v2, s[44:47], s10 offen lds
  v_mfma_f32_16x16x32_bf16 v[68:71], v[164:167], v[140:143], v[68:71]
  ds_read_b64_tr_b16 v[124:125], v25 offset:16384
  v_readlane_b32 s69, v16, 20
  v_mfma_f32_16x16x32_bf16 v[64:67], v[160:163], v[140:143], v[64:67]
  ds_read_b64_tr_b16 v[126:127], v25 offset:17408
  ds_read_b128 v[108:111], v10 offset:2048
  s_add_u32 m0, s68, 102400
  v_mfma_f32_16x16x32_bf16 v[60:63], v[156:159], v[140:143], v[60:63]
  ds_read_b64_tr_b16 v[128:129], v26 offset:16384
  v_mfma_f32_16x16x32_bf16 v[56:59], v[152:155], v[140:143], v[56:59]
  ds_read_b64_tr_b16 v[130:131], v26 offset:17408
  buffer_load_dwordx4 v3, s[44:47], s10 offen lds
  v_mfma_f32_16x16x32_bf16 v[72:75], v[152:155], v[144:147], v[72:75]
  ds_read_b128 v[112:115], v10 offset:4096
  ds_read_b64_tr_b16 v[132:133], v27 offset:16384
  s_add_u32 m0, s68, 106496
  v_mfma_f32_16x16x32_bf16 v[76:79], v[156:159], v[144:147], v[76:79]
  ds_read_b64_tr_b16 v[134:135], v27 offset:17408
  buffer_load_dwordx4 v4, s[44:47], s10 offen lds
  v_mfma_f32_16x16x32_bf16 v[80:83], v[160:163], v[144:147], v[80:83]
  ds_read_b128 v[116:119], v10 offset:6144
  v_mfma_f32_16x16x32_bf16 v[84:87], v[164:167], v[144:147], v[84:87]
  s_add_u32 m0, s68, 110592
  v_mfma_f32_16x16x32_bf16 v[100:103], v[164:167], v[148:151], v[100:103]
  buffer_load_dwordx4 v5, s[44:47], s10 offen lds
  v_mfma_f32_16x16x32_bf16 v[96:99], v[160:163], v[148:151], v[96:99]
  s_mul_i32 s70, s69, 640
  v_mfma_f32_16x16x32_bf16 v[92:95], v[156:159], v[148:151], v[92:95]
  v_mfma_f32_16x16x32_bf16 v[88:91], v[152:155], v[148:151], v[88:91]
  s_waitcnt lgkmcnt(0)
  ds_read_b64_tr_b16 v[152:153], v24 offset:24576
  s_add_u32 m0, s68, 114688
  v_mfma_f32_16x16x32_bf16 v[40:43], v[120:123], v[104:107], v[40:43]
  ds_read_b64_tr_b16 v[154:155], v24 offset:25600
  v_mfma_f32_16x16x32_bf16 v[44:47], v[124:127], v[104:107], v[44:47]
  ds_read_b128 v[136:139], v11 offset:0
  buffer_load_dwordx4 v6, s[40:43], s11 offen lds
  v_mfma_f32_16x16x32_bf16 v[48:51], v[128:131], v[104:107], v[48:51]
  ds_read_b64_tr_b16 v[156:157], v25 offset:24576
  v_mfma_f32_16x16x32_bf16 v[52:55], v[132:135], v[104:107], v[52:55]
  ds_read_b64_tr_b16 v[158:159], v25 offset:25600
  s_add_u32 m0, s68, 118784
  v_mfma_f32_16x16x32_bf16 v[68:71], v[132:135], v[108:111], v[68:71]
  ds_read_b128 v[140:143], v11 offset:2048
  v_mfma_f32_16x16x32_bf16 v[64:67], v[128:131], v[108:111], v[64:67]
  ds_read_b64_tr_b16 v[160:161], v26 offset:24576
  buffer_load_dwordx4 v7, s[40:43], s11 offen lds
  v_mfma_f32_16x16x32_bf16 v[60:63], v[124:127], v[108:111], v[60:63]
  ds_read_b64_tr_b16 v[162:163], v26 offset:25600
  v_mfma_f32_16x16x32_bf16 v[56:59], v[120:123], v[108:111], v[56:59]
  ds_read_b128 v[144:147], v11 offset:4096
  s_add_u32 m0, s68, 122880
  v_mfma_f32_16x16x32_bf16 v[72:75], v[120:123], v[112:115], v[72:75]
  ds_read_b64_tr_b16 v[164:165], v27 offset:24576
  v_mfma_f32_16x16x32_bf16 v[76:79], v[124:127], v[112:115], v[76:79]
L_pad4:
  s_cbranch_execz L_pad52
  ds_read_b64_tr_b16 v[166:167], v27 offset:25600
  buffer_load_dwordx4 v8, s[40:43], s11 offen lds
  v_mfma_f32_16x16x32_bf16 v[80:83], v[128:131], v[112:115], v[80:83]
  ds_read_b128 v[148:151], v11 offset:6144
  v_mfma_f32_16x16x32_bf16 v[84:87], v[132:135], v[112:115], v[84:87]
  s_add_u32 m0, s68, 126976
  v_mfma_f32_16x16x32_bf16 v[100:103], v[132:135], v[116:119], v[100:103]
  v_mfma_f32_16x16x32_bf16 v[96:99], v[128:131], v[116:119], v[96:99]
  buffer_load_dwordx4 v9, s[40:43], s11 offen lds
  v_mfma_f32_16x16x32_bf16 v[92:95], v[124:127], v[116:119], v[92:95]
  v_mfma_f32_16x16x32_bf16 v[88:91], v[120:123], v[116:119], v[88:91]
  s_waitcnt lgkmcnt(0)
  v_mfma_f32_16x16x32_bf16 v[40:43], v[152:155], v[136:139], v[40:43]
  v_mfma_f32_16x16x32_bf16 v[44:47], v[156:159], v[136:139], v[44:47]
  v_mfma_f32_16x16x32_bf16 v[48:51], v[160:163], v[136:139], v[48:51]
  s_waitcnt vmcnt(16)
  s_barrier
  ds_read_b64_tr_b16 v[120:121], v24 offset:49152
  ds_read_b64_tr_b16 v[122:123], v24 offset:50176
  s_add_u32 m0, s68, 0
  v_mfma_f32_16x16x32_bf16 v[52:55], v[164:167], v[136:139], v[52:55]
  ds_read_b128 v[104:107], v10 offset:32768
  buffer_load_dwordx4 v2, s[44:47], s69 offen lds
  v_mfma_f32_16x16x32_bf16 v[68:71], v[164:167], v[140:143], v[68:71]
  ds_read_b64_tr_b16 v[124:125], v25 offset:49152
  v_readlane_b32 s10, v16, 21
  v_mfma_f32_16x16x32_bf16 v[64:67], v[160:163], v[140:143], v[64:67]
  ds_read_b64_tr_b16 v[126:127], v25 offset:50176
  ds_read_b128 v[108:111], v10 offset:34816
  s_add_u32 m0, s68, 4096
  v_mfma_f32_16x16x32_bf16 v[60:63], v[156:159], v[140:143], v[60:63]
  ds_read_b64_tr_b16 v[128:129], v26 offset:49152
  v_mfma_f32_16x16x32_bf16 v[56:59], v[152:155], v[140:143], v[56:59]
  ds_read_b64_tr_b16 v[130:131], v26 offset:50176
  buffer_load_dwordx4 v3, s[44:47], s69 offen lds
  v_mfma_f32_16x16x32_bf16 v[72:75], v[152:155], v[144:147], v[72:75]
  ds_read_b128 v[112:115], v10 offset:36864
  ds_read_b64_tr_b16 v[132:133], v27 offset:49152
  s_add_u32 m0, s68, 8192
  v_mfma_f32_16x16x32_bf16 v[76:79], v[156:159], v[144:147], v[76:79]
  ds_read_b64_tr_b16 v[134:135], v27 offset:50176
  buffer_load_dwordx4 v4, s[44:47], s69 offen lds
  v_mfma_f32_16x16x32_bf16 v[80:83], v[160:163], v[144:147], v[80:83]
  ds_read_b128 v[116:119], v10 offset:38912
  v_mfma_f32_16x16x32_bf16 v[84:87], v[164:167], v[144:147], v[84:87]
  s_add_u32 m0, s68, 12288
  v_mfma_f32_16x16x32_bf16 v[100:103], v[164:167], v[148:151], v[100:103]
  buffer_load_dwordx4 v5, s[44:47], s69 offen lds
  v_mfma_f32_16x16x32_bf16 v[96:99], v[160:163], v[148:151], v[96:99]
  s_mul_i32 s11, s10, 640
  v_mfma_f32_16x16x32_bf16 v[92:95], v[156:159], v[148:151], v[92:95]
  v_mfma_f32_16x16x32_bf16 v[88:91], v[152:155], v[148:151], v[88:91]
  s_waitcnt lgkmcnt(0)
  ds_read_b64_tr_b16 v[152:153], v24 offset:57344
  s_add_u32 m0, s68, 16384
  v_mfma_f32_16x16x32_bf16 v[40:43], v[120:123], v[104:107], v[40:43]
  ds_read_b64_tr_b16 v[154:155], v24 offset:58368
  v_mfma_f32_16x16x32_bf16 v[44:47], v[124:127], v[104:107], v[44:47]
  ds_read_b128 v[136:139], v11 offset:32768
  buffer_load_dwordx4 v6, s[40:43], s70 offen lds
  v_mfma_f32_16x16x32_bf16 v[48:51], v[128:131], v[104:107], v[48:51]
  ds_read_b64_tr_b16 v[156:157], v25 offset:57344
  v_mfma_f32_16x16x32_bf16 v[52:55], v[132:135], v[104:107], v[52:55]
  ds_read_b64_tr_b16 v[158:159], v25 offset:58368
  s_add_u32 m0, s68, 20480
  v_mfma_f32_16x16x32_bf16 v[68:71], v[132:135], v[108:111], v[68:71]
  ds_read_b128 v[140:143], v11 offset:34816
  v_mfma_f32_16x16x32_bf16 v[64:67], v[128:131], v[108:111], v[64:67]
  ds_read_b64_tr_b16 v[160:161], v26 offset:57344
  buffer_load_dwordx4 v7, s[40:43], s70 offen lds
  v_mfma_f32_16x16x32_bf16 v[60:63], v[124:127], v[108:111], v[60:63]
  ds_read_b64_tr_b16 v[162:163], v26 offset:58368
  v_mfma_f32_16x16x32_bf16 v[56:59], v[120:123], v[108:111], v[56:59]
  ds_read_b128 v[144:147], v11 offset:36864
  s_add_u32 m0, s68, 24576
  v_mfma_f32_16x16x32_bf16 v[72:75], v[120:123], v[112:115], v[72:75]
  ds_read_b64_tr_b16 v[164:165], v27 offset:57344
  v_mfma_f32_16x16x32_bf16 v[76:79], v[124:127], v[112:115], v[76:79]
  ds_read_b64_tr_b16 v[166:167], v27 offset:58368
  buffer_load_dwordx4 v8, s[40:43], s70 offen lds
  v_mfma_f32_16x16x32_bf16 v[80:83], v[128:131], v[112:115], v[80:83]
  ds_read_b128 v[148:151], v11 offset:38912
  v_mfma_f32_16x16x32_bf16 v[84:87], v[132:135], v[112:115], v[84:87]
  s_add_u32 m0, s68, 28672
  v_mfma_f32_16x16x32_bf16 v[100:103], v[132:135], v[116:119], v[100:103]
  v_mfma_f32_16x16x32_bf16 v[96:99], v[128:131], v[116:119], v[96:99]
  buffer_load_dwordx4 v9, s[40:43], s70 offen lds
  v_mfma_f32_16x16x32_bf16 v[92:95], v[124:127], v[116:119], v[92:95]
  v_mfma_f32_16x16x32_bf16 v[88:91], v[120:123], v[116:119], v[88:91]
  s_waitcnt lgkmcnt(0)
  v_mfma_f32_16x16x32_bf16 v[40:43], v[152:155], v[136:139], v[40:43]
  v_mfma_f32_16x16x32_bf16 v[44:47], v[156:159], v[136:139], v[44:47]
  v_mfma_f32_16x16x32_bf16 v[48:51], v[160:163], v[136:139], v[48:51]
  s_waitcnt vmcnt(16)
  s_barrier
  ds_read_b64_tr_b16 v[120:121], v28 offset:16384
  ds_read_b64_tr_b16 v[122:123], v28 offset:17408
  s_add_u32 m0, s68, 32768
  v_mfma_f32_16x16x32_bf16 v[52:55], v[164:167], v[136:139], v[52:55]
  ds_read_b128 v[104:107], v12 offset:0
  buffer_load_dwordx4 v2, s[44:47], s10 offen lds
  v_mfma_f32_16x16x32_bf16 v[68:71], v[164:167], v[140:143], v[68:71]
  ds_read_b64_tr_b16 v[124:125], v29 offset:16384
  v_readlane_b32 s69, v16, 22
  v_mfma_f32_16x16x32_bf16 v[64:67], v[160:163], v[140:143], v[64:67]
  ds_read_b64_tr_b16 v[126:127], v29 offset:17408
  ds_read_b128 v[108:111], v12 offset:2048
  s_add_u32 m0, s68, 36864
  v_mfma_f32_16x16x32_bf16 v[60:63], v[156:159], v[140:143], v[60:63]
  ds_read_b64_tr_b16 v[128:129], v30 offset:16384
  v_mfma_f32_16x16x32_bf16 v[56:59], v[152:155], v[140:143], v[56:59]
  ds_read_b64_tr_b16 v[130:131], v30 offset:17408
  buffer_load_dwordx4 v3, s[44:47], s10 offen lds
  v_mfma_f32_16x16x32_bf16 v[72:75], v[152:155], v[144:147], v[72:75]
  ds_read_b128 v[112:115], v12 offset:4096
  ds_read_b64_tr_b16 v[132:133], v31 offset:16384
  s_add_u32 m0, s68, 40960
  v_mfma_f32_16x16x32_bf16 v[76:79], v[156:159], v[144:147], v[76:79]
  ds_read_b64_tr_b16 v[134:135], v31 offset:17408
  buffer_load_dwordx4 v4, s[44:47], s10 offen lds
  v_mfma_f32_16x16x32_bf16 v[80:83], v[160:163], v[144:147], v[80:83]
  ds_read_b128 v[116:119], v12 offset:6144
  v_mfma_f32_16x16x32_bf16 v[84:87], v[164:167], v[144:147], v[84:87]
  s_add_u32 m0, s68, 45056
  v_mfma_f32_16x16x32_bf16 v[100:103], v[164:167], v[148:151], v[100:103]
  buffer_load_dwordx4 v5, s[44:47], s10 offen lds
  v_mfma_f32_16x16x32_bf16 v[96:99], v[160:163], v[148:151], v[96:99]
  s_mul_i32 s70, s69, 640
  v_mfma_f32_16x16x32_bf16 v[92:95], v[156:159], v[148:151], v[92:95]
  v_mfma_f32_16x16x32_bf16 v[88:91], v[152:155], v[148:151], v[88:91]
  s_waitcnt lgkmcnt(0)
  ds_read_b64_tr_b16 v[152:153], v28 offset:24576
  s_add_u32 m0, s68, 49152
  v_mfma_f32_16x16x32_bf16 v[40:43], v[120:123], v[104:107], v[40:43]
  ds_read_b64_tr_b16 v[154:155], v28 offset:25600
  v_mfma_f32_16x16x32_bf16 v[44:47], v[124:127], v[104:107], v[44:47]
  ds_read_b128 v[136:139], v13 offset:0
  buffer_load_dwordx4 v6, s[40:43], s11 offen lds
  v_mfma_f32_16x16x32_bf16 v[48:51], v[128:131], v[104:107], v[48:51]
  ds_read_b64_tr_b16 v[156:157], v29 offset:24576
  v_mfma_f32_16x16x32_bf16 v[52:55], v[132:135], v[104:107], v[52:55]
  ds_read_b64_tr_b16 v[158:159], v29 offset:25600
  s_add_u32 m0, s68, 53248
  v_mfma_f32_16x16x32_bf16 v[68:71], v[132:135], v[108:111], v[68:71]
  ds_read_b128 v[140:143], v13 offset:2048
  v_mfma_f32_16x16x32_bf16 v[64:67], v[128:131], v[108:111], v[64:67]
  ds_read_b64_tr_b16 v[160:161], v30 offset:24576
  buffer_load_dwordx4 v7, s[40:43], s11 offen lds
  v_mfma_f32_16x16x32_bf16 v[60:63], v[124:127], v[108:111], v[60:63]
  ds_read_b64_tr_b16 v[162:163], v30 offset:25600
  v_mfma_f32_16x16x32_bf16 v[56:59], v[120:123], v[108:111], v[56:59]
  ds_read_b128 v[144:147], v13 offset:4096
  s_add_u32 m0, s68, 57344
  v_mfma_f32_16x16x32_bf16 v[72:75], v[120:123], v[112:115], v[72:75]
  ds_read_b64_tr_b16 v[164:165], v31 offset:24576
  v_mfma_f32_16x16x32_bf16 v[76:79], v[124:127], v[112:115], v[76:79]
  ds_read_b64_tr_b16 v[166:167], v31 offset:25600
  buffer_load_dwordx4 v8, s[40:43], s11 offen lds
  v_mfma_f32_16x16x32_bf16 v[80:83], v[128:131], v[112:115], v[80:83]
  ds_read_b128 v[148:151], v13 offset:6144
  v_mfma_f32_16x16x32_bf16 v[84:87], v[132:135], v[112:115], v[84:87]
  s_add_u32 m0, s68, 61440
  v_mfma_f32_16x16x32_bf16 v[100:103], v[132:135], v[116:119], v[100:103]
  v_mfma_f32_16x16x32_bf16 v[96:99], v[128:131], v[116:119], v[96:99]
  buffer_load_dwordx4 v9, s[40:43], s11 offen lds
  v_mfma_f32_16x16x32_bf16 v[92:95], v[124:127], v[116:119], v[92:95]
  v_mfma_f32_16x16x32_bf16 v[88:91], v[120:123], v[116:119], v[88:91]
  s_waitcnt lgkmcnt(0)
  v_mfma_f32_16x16x32_bf16 v[40:43], v[152:155], v[136:139], v[40:43]
  v_mfma_f32_16x16x32_bf16 v[44:47], v[156:159], v[136:139], v[44:47]
  v_mfma_f32_16x16x32_bf16 v[48:51], v[160:163], v[136:139], v[48:51]
  s_waitcnt vmcnt(16)
  s_barrier
  ds_read_b64_tr_b16 v[120:121], v28 offset:49152
  ds_read_b64_tr_b16 v[122:123], v28 offset:50176
  s_add_u32 m0, s68, 65536
  v_mfma_f32_16x16x32_bf16 v[52:55], v[164:167], v[136:139], v[52:55]
  ds_read_b128 v[104:107], v12 offset:32768
  buffer_load_dwordx4 v2, s[44:47], s69 offen lds
  v_mfma_f32_16x16x32_bf16 v[68:71], v[164:167], v[140:143], v[68:71]
  ds_read_b64_tr_b16 v[124:125], v29 offset:49152
  v_readlane_b32 s10, v16, 23
  v_mfma_f32_16x16x32_bf16 v[64:67], v[160:163], v[140:143], v[64:67]
  ds_read_b64_tr_b16 v[126:127], v29 offset:50176
  ds_read_b128 v[108:111], v12 offset:34816
  s_add_u32 m0, s68, 69632
  v_mfma_f32_16x16x32_bf16 v[60:63], v[156:159], v[140:143], v[60:63]
  ds_read_b64_tr_b16 v[128:129], v30 offset:49152
  v_mfma_f32_16x16x32_bf16 v[56:59], v[152:155], v[140:143], v[56:59]
  ds_read_b64_tr_b16 v[130:131], v30 offset:50176
  buffer_load_dwordx4 v3, s[44:47], s69 offen lds
  v_mfma_f32_16x16x32_bf16 v[72:75], v[152:155], v[144:147], v[72:75]
  ds_read_b128 v[112:115], v12 offset:36864
  ds_read_b64_tr_b16 v[132:133], v31 offset:49152
  s_add_u32 m0, s68, 73728
  v_mfma_f32_16x16x32_bf16 v[76:79], v[156:159], v[144:147], v[76:79]
  ds_read_b64_tr_b16 v[134:135], v31 offset:50176
  buffer_load_dwordx4 v4, s[44:47], s69 offen lds
  v_mfma_f32_16x16x32_bf16 v[80:83], v[160:163], v[144:147], v[80:83]
  ds_read_b128 v[116:119], v12 offset:38912
  v_mfma_f32_16x16x32_bf16 v[84:87], v[164:167], v[144:147], v[84:87]
  s_add_u32 m0, s68, 77824
  v_mfma_f32_16x16x32_bf16 v[100:103], v[164:167], v[148:151], v[100:103]
  buffer_load_dwordx4 v5, s[44:47], s69 offen lds
  v_mfma_f32_16x16x32_bf16 v[96:99], v[160:163], v[148:151], v[96:99]
  s_mul_i32 s11, s10, 640
  v_mfma_f32_16x16x32_bf16 v[92:95], v[156:159], v[148:151], v[92:95]
  v_mfma_f32_16x16x32_bf16 v[88:91], v[152:155], v[148:151], v[88:91]
  s_waitcnt lgkmcnt(0)
  ds_read_b64_tr_b16 v[152:153], v28 offset:57344
  s_add_u32 m0, s68, 81920
  v_mfma_f32_16x16x32_bf16 v[40:43], v[120:123], v[104:107], v[40:43]
  ds_read_b64_tr_b16 v[154:155], v28 offset:58368
  v_mfma_f32_16x16x32_bf16 v[44:47], v[124:127], v[104:107], v[44:47]
  ds_read_b128 v[136:139], v13 offset:32768
  buffer_load_dwordx4 v6, s[40:43], s70 offen lds
  v_mfma_f32_16x16x32_bf16 v[48:51], v[128:131], v[104:107], v[48:51]
  ds_read_b64_tr_b16 v[156:157], v29 offset:57344
  v_mfma_f32_16x16x32_bf16 v[52:55], v[132:135], v[104:107], v[52:55]
  ds_read_b64_tr_b16 v[158:159], v29 offset:58368
  s_add_u32 m0, s68, 86016
  v_mfma_f32_16x16x32_bf16 v[68:71], v[132:135], v[108:111], v[68:71]
  ds_read_b128 v[140:143], v13 offset:34816
  v_mfma_f32_16x16x32_bf16 v[64:67], v[128:131], v[108:111], v[64:67]
  ds_read_b64_tr_b16 v[160:161], v30 offset:57344
  buffer_load_dwordx4 v7, s[40:43], s70 offen lds
  v_mfma_f32_16x16x32_bf16 v[60:63], v[124:127], v[108:111], v[60:63]
  ds_read_b64_tr_b16 v[162:163], v30 offset:58368
  v_mfma_f32_16x16x32_bf16 v[56:59], v[120:123], v[108:111], v[56:59]
  ds_read_b128 v[144:147], v13 offset:36864
  s_add_u32 m0, s68, 90112
  v_mfma_f32_16x16x32_bf16 v[72:75], v[120:123], v[112:115], v[72:75]
  ds_read_b64_tr_b16 v[164:165], v31 offset:57344
  v_mfma_f32_16x16x32_bf16 v[76:79], v[124:127], v[112:115], v[76:79]
  ds_read_b64_tr_b16 v[166:167], v31 offset:58368
  buffer_load_dwordx4 v8, s[40:43], s70 offen lds
  v_mfma_f32_16x16x32_bf16 v[80:83], v[128:131], v[112:115], v[80:83]
  ds_read_b128 v[148:151], v13 offset:38912
  v_mfma_f32_16x16x32_bf16 v[84:87], v[132:135], v[112:115], v[84:87]
  s_add_u32 m0, s68, 94208
  v_mfma_f32_16x16x32_bf16 v[100:103], v[132:135], v[116:119], v[100:103]
  v_mfma_f32_16x16x32_bf16 v[96:99], v[128:131], v[116:119], v[96:99]
  buffer_load_dwordx4 v9, s[40:43], s70 offen lds
  v_mfma_f32_16x16x32_bf16 v[92:95], v[124:127], v[116:119], v[92:95]
  v_mfma_f32_16x16x32_bf16 v[88:91], v[120:123], v[116:119], v[88:91]
  s_waitcnt lgkmcnt(0)
  v_mfma_f32_16x16x32_bf16 v[40:43], v[152:155], v[136:139], v[40:43]
  v_mfma_f32_16x16x32_bf16 v[44:47], v[156:159], v[136:139], v[44:47]
  v_mfma_f32_16x16x32_bf16 v[48:51], v[160:163], v[136:139], v[48:51]
  s_waitcnt vmcnt(16)
  s_barrier
  ds_read_b64_tr_b16 v[120:121], v24 offset:16384
  ds_read_b64_tr_b16 v[122:123], v24 offset:17408
  s_add_u32 m0, s68, 98304
  v_mfma_f32_16x16x32_bf16 v[52:55], v[164:167], v[136:139], v[52:55]
  ds_read_b128 v[104:107], v10 offset:0
  buffer_load_dwordx4 v2, s[44:47], s10 offen lds
  v_mfma_f32_16x16x32_bf16 v[68:71], v[164:167], v[140:143], v[68:71]
  ds_read_b64_tr_b16 v[124:125], v25 offset:16384
  v_readlane_b32 s69, v16, 24
  v_mfma_f32_16x16x32_bf16 v[64:67], v[160:163], v[140:143], v[64:67]
  ds_read_b64_tr_b16 v[126:127], v25 offset:17408
  ds_read_b128 v[108:111], v10 offset:2048
  s_add_u32 m0, s68, 102400
L_pad5:
  s_cbranch_execz L_pad53
  v_mfma_f32_16x16x32_bf16 v[60:63], v[156:159], v[140:143], v[60:63]
  ds_read_b64_tr_b16 v[128:129], v26 offset:16384
  v_mfma_f32_16x16x32_bf16 v[56:59], v[152:155], v[140:143], v[56:59]
  ds_read_b64_tr_b16 v[130:131], v26 offset:17408
  buffer_load_dwordx4 v3, s[44:47], s10 offen lds
  v_mfma_f32_16x16x32_bf16 v[72:75], v[152:155], v[144:147], v[72:75]
  ds_read_b128 v[112:115], v10 offset:4096
  ds_read_b64_tr_b16 v[132:133], v27 offset:16384
  s_add_u32 m0, s68, 106496
  v_mfma_f32_16x16x32_bf16 v[76:79], v[156:159], v[144:147], v[76:79]
  ds_read_b64_tr_b16 v[134:135], v27 offset:17408
  buffer_load_dwordx4 v4, s[44:47], s10 offen lds
  v_mfma_f32_16x16x32_bf16 v[80:83], v[160:163], v[144:147], v[80:83]
  ds_read_b128 v[116:119], v10 offset:6144
  v_mfma_f32_16x16x32_bf16 v[84:87], v[164:167], v[144:147], v[84:87]
  s_add_u32 m0, s68, 110592
  v_mfma_f32_16x16x32_bf16 v[100:103], v[164:167], v[148:151], v[100:103]
  buffer_load_dwordx4 v5, s[44:47], s10 offen lds
  v_mfma_f32_16x16x32_bf16 v[96:99], v[160:163], v[148:151], v[96:99]
  s_mul_i32 s70, s69, 640
  v_mfma_f32_16x16x32_bf16 v[92:95], v[156:159], v[148:151], v[92:95]
  v_mfma_f32_16x16x32_bf16 v[88:91], v[152:155], v[148:151], v[88:91]
  s_waitcnt lgkmcnt(0)
  ds_read_b64_tr_b16 v[152:153], v24 offset:24576
  s_add_u32 m0, s68, 114688
  v_mfma_f32_16x16x32_bf16 v[40:43], v[120:123], v[104:107], v[40:43]
  ds_read_b64_tr_b16 v[154:155], v24 offset:25600
  v_mfma_f32_16x16x32_bf16 v[44:47], v[124:127], v[104:107], v[44:47]
  ds_read_b128 v[136:139], v11 offset:0
  buffer_load_dwordx4 v6, s[40:43], s11 offen lds
  v_mfma_f32_16x16x32_bf16 v[48:51], v[128:131], v[104:107], v[48:51]
  ds_read_b64_tr_b16 v[156:157], v25 offset:24576
  v_mfma_f32_16x16x32_bf16 v[52:55], v[132:135], v[104:107], v[52:55]
  ds_read_b64_tr_b16 v[158:159], v25 offset:25600
  s_add_u32 m0, s68, 118784
  v_mfma_f32_16x16x32_bf16 v[68:71], v[132:135], v[108:111], v[68:71]
  ds_read_b128 v[140:143], v11 offset:2048
  v_mfma_f32_16x16x32_bf16 v[64:67], v[128:131], v[108:111], v[64:67]
  ds_read_b64_tr_b16 v[160:161], v26 offset:24576
  buffer_load_dwordx4 v7, s[40:43], s11 offen lds
  v_mfma_f32_16x16x32_bf16 v[60:63], v[124:127], v[108:111], v[60:63]
  ds_read_b64_tr_b16 v[162:163], v26 offset:25600
  v_mfma_f32_16x16x32_bf16 v[56:59], v[120:123], v[108:111], v[56:59]
  ds_read_b128 v[144:147], v11 offset:4096
  s_add_u32 m0, s68, 122880
  v_mfma_f32_16x16x32_bf16 v[72:75], v[120:123], v[112:115], v[72:75]
  ds_read_b64_tr_b16 v[164:165], v27 offset:24576
  v_mfma_f32_16x16x32_bf16 v[76:79], v[124:127], v[112:115], v[76:79]
  ds_read_b64_tr_b16 v[166:167], v27 offset:25600
  buffer_load_dwordx4 v8, s[40:43], s11 offen lds
  v_mfma_f32_16x16x32_bf16 v[80:83], v[128:131], v[112:115], v[80:83]
  ds_read_b128 v[148:151], v11 offset:6144
  v_mfma_f32_16x16x32_bf16 v[84:87], v[132:135], v[112:115], v[84:87]
  s_add_u32 m0, s68, 126976
  v_mfma_f32_16x16x32_bf16 v[100:103], v[132:135], v[116:119], v[100:103]
  v_mfma_f32_16x16x32_bf16 v[96:99], v[128:131], v[116:119], v[96:99]
  buffer_load_dwordx4 v9, s[40:43], s11 offen lds
  v_mfma_f32_16x16x32_bf16 v[92:95], v[124:127], v[116:119], v[92:95]
  v_mfma_f32_16x16x32_bf16 v[88:91], v[120:123], v[116:119], v[88:91]
  s_waitcnt lgkmcnt(0)
  v_mfma_f32_16x16x32_bf16 v[40:43], v[152:155], v[136:139], v[40:43]
  v_mfma_f32_16x16x32_bf16 v[44:47], v[156:159], v[136:139], v[44:47]
  v_mfma_f32_16x16x32_bf16 v[48:51], v[160:163], v[136:139], v[48:51]
  s_waitcnt vmcnt(16)
  s_barrier
  ds_read_b64_tr_b16 v[120:121], v24 offset:49152
  ds_read_b64_tr_b16 v[122:123], v24 offset:50176
  s_add_u32 m0, s68, 0
  v_mfma_f32_16x16x32_bf16 v[52:55], v[164:167], v[136:139], v[52:55]
  ds_read_b128 v[104:107], v10 offset:32768
  buffer_load_dwordx4 v2, s[44:47], s69 offen lds
  v_mfma_f32_16x16x32_bf16 v[68:71], v[164:167], v[140:143], v[68:71]
  ds_read_b64_tr_b16 v[124:125], v25 offset:49152
  v_readlane_b32 s10, v16, 25
  v_mfma_f32_16x16x32_bf16 v[64:67], v[160:163], v[140:143], v[64:67]
  ds_read_b64_tr_b16 v[126:127], v25 offset:50176
  ds_read_b128 v[108:111], v10 offset:34816
  s_add_u32 m0, s68, 4096
  v_mfma_f32_16x16x32_bf16 v[60:63], v[156:159], v[140:143], v[60:63]
  ds_read_b64_tr_b16 v[128:129], v26 offset:49152
  v_mfma_f32_16x16x32_bf16 v[56:59], v[152:155], v[140:143], v[56:59]
  ds_read_b64_tr_b16 v[130:131], v26 offset:50176
  buffer_load_dwordx4 v3, s[44:47], s69 offen lds
  v_mfma_f32_16x16x32_bf16 v[72:75], v[152:155], v[144:147], v[72:75]
  ds_read_b128 v[112:115], v10 offset:36864
  ds_read_b64_tr_b16 v[132:133], v27 offset:49152
  s_add_u32 m0, s68, 8192
  v_mfma_f32_16x16x32_bf16 v[76:79], v[156:159], v[144:147], v[76:79]
  ds_read_b64_tr_b16 v[134:135], v27 offset:50176
  buffer_load_dwordx4 v4, s[44:47], s69 offen lds
  v_mfma_f32_16x16x32_bf16 v[80:83], v[160:163], v[144:147], v[80:83]
  ds_read_b128 v[116:119], v10 offset:38912
  v_mfma_f32_16x16x32_bf16 v[84:87], v[164:167], v[144:147], v[84:87]
  s_add_u32 m0, s68, 12288
  v_mfma_f32_16x16x32_bf16 v[100:103], v[164:167], v[148:151], v[100:103]
  buffer_load_dwordx4 v5, s[44:47], s69 offen lds
  v_mfma_f32_16x16x32_bf16 v[96:99], v[160:163], v[148:151], v[96:99]
  s_mul_i32 s11, s10, 640
  v_mfma_f32_16x16x32_bf16 v[92:95], v[156:159], v[148:151], v[92:95]
  v_mfma_f32_16x16x32_bf16 v[88:91], v[152:155], v[148:151], v[88:91]
  s_waitcnt lgkmcnt(0)
  ds_read_b64_tr_b16 v[152:153], v24 offset:57344
  s_add_u32 m0, s68, 16384
  v_mfma_f32_16x16x32_bf16 v[40:43], v[120:123], v[104:107], v[40:43]
  ds_read_b64_tr_b16 v[154:155], v24 offset:58368
  v_mfma_f32_16x16x32_bf16 v[44:47], v[124:127], v[104:107], v[44:47]
  ds_read_b128 v[136:139], v11 offset:32768
  buffer_load_dwordx4 v6, s[40:43], s70 offen lds
  v_mfma_f32_16x16x32_bf16 v[48:51], v[128:131], v[104:107], v[48:51]
  ds_read_b64_tr_b16 v[156:157], v25 offset:57344
  v_mfma_f32_16x16x32_bf16 v[52:55], v[132:135], v[104:107], v[52:55]
  ds_read_b64_tr_b16 v[158:159], v25 offset:58368
  s_add_u32 m0, s68, 20480
  v_mfma_f32_16x16x32_bf16 v[68:71], v[132:135], v[108:111], v[68:71]
  ds_read_b128 v[140:143], v11 offset:34816
  v_mfma_f32_16x16x32_bf16 v[64:67], v[128:131], v[108:111], v[64:67]
  ds_read_b64_tr_b16 v[160:161], v26 offset:57344
  buffer_load_dwordx4 v7, s[40:43], s70 offen lds
  v_mfma_f32_16x16x32_bf16 v[60:63], v[124:127], v[108:111], v[60:63]
  ds_read_b64_tr_b16 v[162:163], v26 offset:58368
  v_mfma_f32_16x16x32_bf16 v[56:59], v[120:123], v[108:111], v[56:59]
  ds_read_b128 v[144:147], v11 offset:36864
  s_add_u32 m0, s68, 24576
  v_mfma_f32_16x16x32_bf16 v[72:75], v[120:123], v[112:115], v[72:75]
  ds_read_b64_tr_b16 v[164:165], v27 offset:57344
  v_mfma_f32_16x16x32_bf16 v[76:79], v[124:127], v[112:115], v[76:79]
  ds_read_b64_tr_b16 v[166:167], v27 offset:58368
  buffer_load_dwordx4 v8, s[40:43], s70 offen lds
  v_mfma_f32_16x16x32_bf16 v[80:83], v[128:131], v[112:115], v[80:83]
  ds_read_b128 v[148:151], v11 offset:38912
  v_mfma_f32_16x16x32_bf16 v[84:87], v[132:135], v[112:115], v[84:87]
  s_add_u32 m0, s68, 28672
  v_mfma_f32_16x16x32_bf16 v[100:103], v[132:135], v[116:119], v[100:103]
  v_mfma_f32_16x16x32_bf16 v[96:99], v[128:131], v[116:119], v[96:99]
  buffer_load_dwordx4 v9, s[40:43], s70 offen lds
  v_mfma_f32_16x16x32_bf16 v[92:95], v[124:127], v[116:119], v[92:95]
  v_mfma_f32_16x16x32_bf16 v[88:91], v[120:123], v[116:119], v[88:91]
  s_waitcnt lgkmcnt(0)
  v_mfma_f32_16x16x32_bf16 v[40:43], v[152:155], v[136:139], v[40:43]
  v_mfma_f32_16x16x32_bf16 v[44:47], v[156:159], v[136:139], v[44:47]
  v_mfma_f32_16x16x32_bf16 v[48:51], v[160:163], v[136:139], v[48:51]
  s_waitcnt vmcnt(16)
  s_barrier
  ds_read_b64_tr_b16 v[120:121], v28 offset:16384
  ds_read_b64_tr_b16 v[122:123], v28 offset:17408
  s_add_u32 m0, s68, 32768
  v_mfma_f32_16x16x32_bf16 v[52:55], v[164:167], v[136:139], v[52:55]
  ds_read_b128 v[104:107], v12 offset:0
  buffer_load_dwordx4 v2, s[44:47], s10 offen lds
  v_mfma_f32_16x16x32_bf16 v[68:71], v[164:167], v[140:143], v[68:71]
  ds_read_b64_tr_b16 v[124:125], v29 offset:16384
  v_readlane_b32 s69, v16, 26
  v_mfma_f32_16x16x32_bf16 v[64:67], v[160:163], v[140:143], v[64:67]
  ds_read_b64_tr_b16 v[126:127], v29 offset:17408
  ds_read_b128 v[108:111], v12 offset:2048
  s_add_u32 m0, s68, 36864
  v_mfma_f32_16x16x32_bf16 v[60:63], v[156:159], v[140:143], v[60:63]
  ds_read_b64_tr_b16 v[128:129], v30 offset:16384
  v_mfma_f32_16x16x32_bf16 v[56:59], v[152:155], v[140:143], v[56:59]
  ds_read_b64_tr_b16 v[130:131], v30 offset:17408
  buffer_load_dwordx4 v3, s[44:47], s10 offen lds
  v_mfma_f32_16x16x32_bf16 v[72:75], v[152:155], v[144:147], v[72:75]
  ds_read_b128 v[112:115], v12 offset:4096
  ds_read_b64_tr_b16 v[132:133], v31 offset:16384
  s_add_u32 m0, s68, 40960
  v_mfma_f32_16x16x32_bf16 v[76:79], v[156:159], v[144:147], v[76:79]
  ds_read_b64_tr_b16 v[134:135], v31 offset:17408
  buffer_load_dwordx4 v4, s[44:47], s10 offen lds
  v_mfma_f32_16x16x32_bf16 v[80:83], v[160:163], v[144:147], v[80:83]
  ds_read_b128 v[116:119], v12 offset:6144
  v_mfma_f32_16x16x32_bf16 v[84:87], v[164:167], v[144:147], v[84:87]
  s_add_u32 m0, s68, 45056
  v_mfma_f32_16x16x32_bf16 v[100:103], v[164:167], v[148:151], v[100:103]
  buffer_load_dwordx4 v5, s[44:47], s10 offen lds
  v_mfma_f32_16x16x32_bf16 v[96:99], v[160:163], v[148:151], v[96:99]
  s_mul_i32 s70, s69, 640
  v_mfma_f32_16x16x32_bf16 v[92:95], v[156:159], v[148:151], v[92:95]
  v_mfma_f32_16x16x32_bf16 v[88:91], v[152:155], v[148:151], v[88:91]
  s_waitcnt lgkmcnt(0)
  ds_read_b64_tr_b16 v[152:153], v28 offset:24576
  s_add_u32 m0, s68, 49152
  v_mfma_f32_16x16x32_bf16 v[40:43], v[120:123], v[104:107], v[40:43]
  ds_read_b64_tr_b16 v[154:155], v28 offset:25600
  v_mfma_f32_16x16x32_bf16 v[44:47], v[124:127], v[104:107], v[44:47]
  ds_read_b128 v[136:139], v13 offset:0
  buffer_load_dwordx4 v6, s[40:43], s11 offen lds
  v_mfma_f32_16x16x32_bf16 v[48:51], v[128:131], v[104:107], v[48:51]
  ds_read_b64_tr_b16 v[156:157], v29 offset:24576
  v_mfma_f32_16x16x32_bf16 v[52:55], v[132:135], v[104:107], v[52:55]
  ds_read_b64_tr_b16 v[158:159], v29 offset:25600
  s_add_u32 m0, s68, 53248
  v_mfma_f32_16x16x32_bf16 v[68:71], v[132:135], v[108:111], v[68:71]
  ds_read_b128 v[140:143], v13 offset:2048
  v_mfma_f32_16x16x32_bf16 v[64:67], v[128:131], v[108:111], v[64:67]
  ds_read_b64_tr_b16 v[160:161], v30 offset:24576
  buffer_load_dwordx4 v7, s[40:43], s11 offen lds
  v_mfma_f32_16x16x32_bf16 v[60:63], v[124:127], v[108:111], v[60:63]
  ds_read_b64_tr_b16 v[162:163], v30 offset:25600
  v_mfma_f32_16x16x32_bf16 v[56:59], v[120:123], v[108:111], v[56:59]
  ds_read_b128 v[144:147], v13 offset:4096
  s_add_u32 m0, s68, 57344
  v_mfma_f32_16x16x32_bf16 v[72:75], v[120:123], v[112:115], v[72:75]
  ds_read_b64_tr_b16 v[164:165], v31 offset:24576
  v_mfma_f32_16x16x32_bf16 v[76:79], v[124:127], v[112:115], v[76:79]
  ds_read_b64_tr_b16 v[166:167], v31 offset:25600
  buffer_load_dwordx4 v8, s[40:43], s11 offen lds
  v_mfma_f32_16x16x32_bf16 v[80:83], v[128:131], v[112:115], v[80:83]
  ds_read_b128 v[148:151], v13 offset:6144
  v_mfma_f32_16x16x32_bf16 v[84:87], v[132:135], v[112:115], v[84:87]
  s_add_u32 m0, s68, 61440
  v_mfma_f32_16x16x32_bf16 v[100:103], v[132:135], v[116:119], v[100:103]
  v_mfma_f32_16x16x32_bf16 v[96:99], v[128:131], v[116:119], v[96:99]
  buffer_load_dwordx4 v9, s[40:43], s11 offen lds
  v_mfma_f32_16x16x32_bf16 v[92:95], v[124:127], v[116:119], v[92:95]
  v_mfma_f32_16x16x32_bf16 v[88:91], v[120:123], v[116:119], v[88:91]
  s_waitcnt lgkmcnt(0)
  v_mfma_f32_16x16x32_bf16 v[40:43], v[152:155], v[136:139], v[40:43]
  v_mfma_f32_16x16x32_bf16 v[44:47], v[156:159], v[136:139], v[44:47]
  v_mfma_f32_16x16x32_bf16 v[48:51], v[160:163], v[136:139], v[48:51]
  s_waitcnt vmcnt(16)
  s_barrier
  ds_read_b64_tr_b16 v[120:121], v28 offset:49152
  ds_read_b64_tr_b16 v[122:123], v28 offset:50176
  s_add_u32 m0, s68, 65536
  v_mfma_f32_16x16x32_bf16 v[52:55], v[164:167], v[136:139], v[52:55]
  ds_read_b128 v[104:107], v12 offset:32768
  buffer_load_dwordx4 v2, s[44:47], s69 offen lds
  v_mfma_f32_16x16x32_bf16 v[68:71], v[164:167], v[140:143], v[68:71]
  ds_read_b64_tr_b16 v[124:125], v29 offset:49152
  v_readlane_b32 s10, v16, 27
  v_mfma_f32_16x16x32_bf16 v[64:67], v[160:163], v[140:143], v[64:67]
  ds_read_b64_tr_b16 v[126:127], v29 offset:50176
  ds_read_b128 v[108:111], v12 offset:34816
  s_add_u32 m0, s68, 69632
  v_mfma_f32_16x16x32_bf16 v[60:63], v[156:159], v[140:143], v[60:63]
  ds_read_b64_tr_b16 v[128:129], v30 offset:49152
  v_mfma_f32_16x16x32_bf16 v[56:59], v[152:155], v[140:143], v[56:59]
  ds_read_b64_tr_b16 v[130:131], v30 offset:50176
  buffer_load_dwordx4 v3, s[44:47], s69 offen lds
  v_mfma_f32_16x16x32_bf16 v[72:75], v[152:155], v[144:147], v[72:75]
  ds_read_b128 v[112:115], v12 offset:36864
  ds_read_b64_tr_b16 v[132:133], v31 offset:49152
  s_add_u32 m0, s68, 73728
  v_mfma_f32_16x16x32_bf16 v[76:79], v[156:159], v[144:147], v[76:79]
  ds_read_b64_tr_b16 v[134:135], v31 offset:50176
  buffer_load_dwordx4 v4, s[44:47], s69 offen lds
  v_mfma_f32_16x16x32_bf16 v[80:83], v[160:163], v[144:147], v[80:83]
  ds_read_b128 v[116:119], v12 offset:38912
  v_mfma_f32_16x16x32_bf16 v[84:87], v[164:167], v[144:147], v[84:87]
  s_add_u32 m0, s68, 77824
  v_mfma_f32_16x16x32_bf16 v[100:103], v[164:167], v[148:151], v[100:103]
  buffer_load_dwordx4 v5, s[44:47], s69 offen lds
  v_mfma_f32_16x16x32_bf16 v[96:99], v[160:163], v[148:151], v[96:99]
  s_mul_i32 s11, s10, 640
  v_mfma_f32_16x16x32_bf16 v[92:95], v[156:159], v[148:151], v[92:95]
  v_mfma_f32_16x16x32_bf16 v[88:91], v[152:155], v[148:151], v[88:91]
  s_waitcnt lgkmcnt(0)
  ds_read_b64_tr_b16 v[152:153], v28 offset:57344
  s_add_u32 m0, s68, 81920
  v_mfma_f32_16x16x32_bf16 v[40:43], v[120:123], v[104:107], v[40:43]
  ds_read_b64_tr_b16 v[154:155], v28 offset:58368
  v_mfma_f32_16x16x32_bf16 v[44:47], v[124:127], v[104:107], v[44:47]
  ds_read_b128 v[136:139], v13 offset:32768
L_pad6:
  s_cbranch_execz L_pad54
  buffer_load_dwordx4 v6, s[40:43], s70 offen lds
  v_mfma_f32_16x16x32_bf16 v[48:51], v[128:131], v[104:107], v[48:51]
  ds_read_b64_tr_b16 v[156:157], v29 offset:57344
  v_mfma_f32_16x16x32_bf16 v[52:55], v[132:135], v[104:107], v[52:55]
  ds_read_b64_tr_b16 v[158:159], v29 offset:58368
  s_add_u32 m0, s68, 86016
  v_mfma_f32_16x16x32_bf16 v[68:71], v[132:135], v[108:111], v[68:71]
  ds_read_b128 v[140:143], v13 offset:34816
  v_mfma_f32_16x16x32_bf16 v[64:67], v[128:131], v[108:111], v[64:67]
  ds_read_b64_tr_b16 v[160:161], v30 offset:57344
  buffer_load_dwordx4 v7, s[40:43], s70 offen lds
  v_mfma_f32_16x16x32_bf16 v[60:63], v[124:127], v[108:111], v[60:63]
  ds_read_b64_tr_b16 v[162:163], v30 offset:58368
  v_mfma_f32_16x16x32_bf16 v[56:59], v[120:123], v[108:111], v[56:59]
  ds_read_b128 v[144:147], v13 offset:36864
  s_add_u32 m0, s68, 90112
  v_mfma_f32_16x16x32_bf16 v[72:75], v[120:123], v[112:115], v[72:75]
  ds_read_b64_tr_b16 v[164:165], v31 offset:57344
  v_mfma_f32_16x16x32_bf16 v[76:79], v[124:127], v[112:115], v[76:79]
  ds_read_b64_tr_b16 v[166:167], v31 offset:58368
  buffer_load_dwordx4 v8, s[40:43], s70 offen lds
  v_mfma_f32_16x16x32_bf16 v[80:83], v[128:131], v[112:115], v[80:83]
  ds_read_b128 v[148:151], v13 offset:38912
  v_mfma_f32_16x16x32_bf16 v[84:87], v[132:135], v[112:115], v[84:87]
  s_add_u32 m0, s68, 94208
  v_mfma_f32_16x16x32_bf16 v[100:103], v[132:135], v[116:119], v[100:103]
  v_mfma_f32_16x16x32_bf16 v[96:99], v[128:131], v[116:119], v[96:99]
  buffer_load_dwordx4 v9, s[40:43], s70 offen lds
  v_mfma_f32_16x16x32_bf16 v[92:95], v[124:127], v[116:119], v[92:95]
  v_mfma_f32_16x16x32_bf16 v[88:91], v[120:123], v[116:119], v[88:91]
  s_waitcnt lgkmcnt(0)
  v_mfma_f32_16x16x32_bf16 v[40:43], v[152:155], v[136:139], v[40:43]
  v_mfma_f32_16x16x32_bf16 v[44:47], v[156:159], v[136:139], v[44:47]
  v_mfma_f32_16x16x32_bf16 v[48:51], v[160:163], v[136:139], v[48:51]
  s_waitcnt vmcnt(16)
  s_barrier
  ds_read_b64_tr_b16 v[120:121], v24 offset:16384
  ds_read_b64_tr_b16 v[122:123], v24 offset:17408
  s_add_u32 m0, s68, 98304
  v_mfma_f32_16x16x32_bf16 v[52:55], v[164:167], v[136:139], v[52:55]
  ds_read_b128 v[104:107], v10 offset:0
  buffer_load_dwordx4 v2, s[44:47], s10 offen lds
  v_mfma_f32_16x16x32_bf16 v[68:71], v[164:167], v[140:143], v[68:71]
  ds_read_b64_tr_b16 v[124:125], v25 offset:16384
  v_readlane_b32 s69, v16, 28
  v_mfma_f32_16x16x32_bf16 v[64:67], v[160:163], v[140:143], v[64:67]
  ds_read_b64_tr_b16 v[126:127], v25 offset:17408
  ds_read_b128 v[108:111], v10 offset:2048
  s_add_u32 m0, s68, 102400
  v_mfma_f32_16x16x32_bf16 v[60:63], v[156:159], v[140:143], v[60:63]
  ds_read_b64_tr_b16 v[128:129], v26 offset:16384
  v_mfma_f32_16x16x32_bf16 v[56:59], v[152:155], v[140:143], v[56:59]
  ds_read_b64_tr_b16 v[130:131], v26 offset:17408
  buffer_load_dwordx4 v3, s[44:47], s10 offen lds
  v_mfma_f32_16x16x32_bf16 v[72:75], v[152:155], v[144:147], v[72:75]
  ds_read_b128 v[112:115], v10 offset:4096
  ds_read_b64_tr_b16 v[132:133], v27 offset:16384
  s_add_u32 m0, s68, 106496
  v_mfma_f32_16x16x32_bf16 v[76:79], v[156:159], v[144:147], v[76:79]
  ds_read_b64_tr_b16 v[134:135], v27 offset:17408
  buffer_load_dwordx4 v4, s[44:47], s10 offen lds
  v_mfma_f32_16x16x32_bf16 v[80:83], v[160:163], v[144:147], v[80:83]
  ds_read_b128 v[116:119], v10 offset:6144
  v_mfma_f32_16x16x32_bf16 v[84:87], v[164:167], v[144:147], v[84:87]
  s_add_u32 m0, s68, 110592
  v_mfma_f32_16x16x32_bf16 v[100:103], v[164:167], v[148:151], v[100:103]
  buffer_load_dwordx4 v5, s[44:47], s10 offen lds
  v_mfma_f32_16x16x32_bf16 v[96:99], v[160:163], v[148:151], v[96:99]
  s_mul_i32 s70, s69, 640
  v_mfma_f32_16x16x32_bf16 v[92:95], v[156:159], v[148:151], v[92:95]
  v_mfma_f32_16x16x32_bf16 v[88:91], v[152:155], v[148:151], v[88:91]
  s_waitcnt lgkmcnt(0)
  ds_read_b64_tr_b16 v[152:153], v24 offset:24576
  s_add_u32 m0, s68, 114688
  v_mfma_f32_16x16x32_bf16 v[40:43], v[120:123], v[104:107], v[40:43]
  ds_read_b64_tr_b16 v[154:155], v24 offset:25600
  v_mfma_f32_16x16x32_bf16 v[44:47], v[124:127], v[104:107], v[44:47]
  ds_read_b128 v[136:139], v11 offset:0
  buffer_load_dwordx4 v6, s[40:43], s11 offen lds
  v_mfma_f32_16x16x32_bf16 v[48:51], v[128:131], v[104:107], v[48:51]
  ds_read_b64_tr_b16 v[156:157], v25 offset:24576
  v_mfma_f32_16x16x32_bf16 v[52:55], v[132:135], v[104:107], v[52:55]
  ds_read_b64_tr_b16 v[158:159], v25 offset:25600
  s_add_u32 m0, s68, 118784
  v_mfma_f32_16x16x32_bf16 v[68:71], v[132:135], v[108:111], v[68:71]
  ds_read_b128 v[140:143], v11 offset:2048
  v_mfma_f32_16x16x32_bf16 v[64:67], v[128:131], v[108:111], v[64:67]
  ds_read_b64_tr_b16 v[160:161], v26 offset:24576
  buffer_load_dwordx4 v7, s[40:43], s11 offen lds
  v_mfma_f32_16x16x32_bf16 v[60:63], v[124:127], v[108:111], v[60:63]
  ds_read_b64_tr_b16 v[162:163], v26 offset:25600
  v_mfma_f32_16x16x32_bf16 v[56:59], v[120:123], v[108:111], v[56:59]
  ds_read_b128 v[144:147], v11 offset:4096
  s_add_u32 m0, s68, 122880
  v_mfma_f32_16x16x32_bf16 v[72:75], v[120:123], v[112:115], v[72:75]
  ds_read_b64_tr_b16 v[164:165], v27 offset:24576
  v_mfma_f32_16x16x32_bf16 v[76:79], v[124:127], v[112:115], v[76:79]
  ds_read_b64_tr_b16 v[166:167], v27 offset:25600
  buffer_load_dwordx4 v8, s[40:43], s11 offen lds
  v_mfma_f32_16x16x32_bf16 v[80:83], v[128:131], v[112:115], v[80:83]
  ds_read_b128 v[148:151], v11 offset:6144
  v_mfma_f32_16x16x32_bf16 v[84:87], v[132:135], v[112:115], v[84:87]
  s_add_u32 m0, s68, 126976
  v_mfma_f32_16x16x32_bf16 v[100:103], v[132:135], v[116:119], v[100:103]
  v_mfma_f32_16x16x32_bf16 v[96:99], v[128:131], v[116:119], v[96:99]
  buffer_load_dwordx4 v9, s[40:43], s11 offen lds
  v_mfma_f32_16x16x32_bf16 v[92:95], v[124:127], v[116:119], v[92:95]
  v_mfma_f32_16x16x32_bf16 v[88:91], v[120:123], v[116:119], v[88:91]
  s_waitcnt lgkmcnt(0)
  v_mfma_f32_16x16x32_bf16 v[40:43], v[152:155], v[136:139], v[40:43]
  v_mfma_f32_16x16x32_bf16 v[44:47], v[156:159], v[136:139], v[44:47]
  v_mfma_f32_16x16x32_bf16 v[48:51], v[160:163], v[136:139], v[48:51]
  s_waitcnt vmcnt(16)
  s_barrier
  ds_read_b64_tr_b16 v[120:121], v24 offset:49152
  ds_read_b64_tr_b16 v[122:123], v24 offset:50176
  s_add_u32 m0, s68, 0
  v_mfma_f32_16x16x32_bf16 v[52:55], v[164:167], v[136:139], v[52:55]
  ds_read_b128 v[104:107], v10 offset:32768
  buffer_load_dwordx4 v2, s[44:47], s69 offen lds
  v_mfma_f32_16x16x32_bf16 v[68:71], v[164:167], v[140:143], v[68:71]
  ds_read_b64_tr_b16 v[124:125], v25 offset:49152
  v_readlane_b32 s10, v16, 29
  v_mfma_f32_16x16x32_bf16 v[64:67], v[160:163], v[140:143], v[64:67]
  ds_read_b64_tr_b16 v[126:127], v25 offset:50176
  ds_read_b128 v[108:111], v10 offset:34816
  s_add_u32 m0, s68, 4096
  v_mfma_f32_16x16x32_bf16 v[60:63], v[156:159], v[140:143], v[60:63]
  ds_read_b64_tr_b16 v[128:129], v26 offset:49152
  v_mfma_f32_16x16x32_bf16 v[56:59], v[152:155], v[140:143], v[56:59]
  ds_read_b64_tr_b16 v[130:131], v26 offset:50176
  buffer_load_dwordx4 v3, s[44:47], s69 offen lds
  v_mfma_f32_16x16x32_bf16 v[72:75], v[152:155], v[144:147], v[72:75]
  ds_read_b128 v[112:115], v10 offset:36864
  ds_read_b64_tr_b16 v[132:133], v27 offset:49152
  s_add_u32 m0, s68, 8192
  v_mfma_f32_16x16x32_bf16 v[76:79], v[156:159], v[144:147], v[76:79]
  ds_read_b64_tr_b16 v[134:135], v27 offset:50176
  buffer_load_dwordx4 v4, s[44:47], s69 offen lds
  v_mfma_f32_16x16x32_bf16 v[80:83], v[160:163], v[144:147], v[80:83]
  ds_read_b128 v[116:119], v10 offset:38912
  v_mfma_f32_16x16x32_bf16 v[84:87], v[164:167], v[144:147], v[84:87]
  s_add_u32 m0, s68, 12288
  v_mfma_f32_16x16x32_bf16 v[100:103], v[164:167], v[148:151], v[100:103]
  buffer_load_dwordx4 v5, s[44:47], s69 offen lds
  v_mfma_f32_16x16x32_bf16 v[96:99], v[160:163], v[148:151], v[96:99]
  s_mul_i32 s11, s10, 640
  v_mfma_f32_16x16x32_bf16 v[92:95], v[156:159], v[148:151], v[92:95]
  v_mfma_f32_16x16x32_bf16 v[88:91], v[152:155], v[148:151], v[88:91]
  s_waitcnt lgkmcnt(0)
  ds_read_b64_tr_b16 v[152:153], v24 offset:57344
  s_add_u32 m0, s68, 16384
  v_mfma_f32_16x16x32_bf16 v[40:43], v[120:123], v[104:107], v[40:43]
  ds_read_b64_tr_b16 v[154:155], v24 offset:58368
  v_mfma_f32_16x16x32_bf16 v[44:47], v[124:127], v[104:107], v[44:47]
  ds_read_b128 v[136:139], v11 offset:32768
  buffer_load_dwordx4 v6, s[40:43], s70 offen lds
  v_mfma_f32_16x16x32_bf16 v[48:51], v[128:131], v[104:107], v[48:51]
  ds_read_b64_tr_b16 v[156:157], v25 offset:57344
  v_mfma_f32_16x16x32_bf16 v[52:55], v[132:135], v[104:107], v[52:55]
  ds_read_b64_tr_b16 v[158:159], v25 offset:58368
  s_add_u32 m0, s68, 20480
  v_mfma_f32_16x16x32_bf16 v[68:71], v[132:135], v[108:111], v[68:71]
  ds_read_b128 v[140:143], v11 offset:34816
  v_mfma_f32_16x16x32_bf16 v[64:67], v[128:131], v[108:111], v[64:67]
  ds_read_b64_tr_b16 v[160:161], v26 offset:57344
  buffer_load_dwordx4 v7, s[40:43], s70 offen lds
  v_mfma_f32_16x16x32_bf16 v[60:63], v[124:127], v[108:111], v[60:63]
  ds_read_b64_tr_b16 v[162:163], v26 offset:58368
  v_mfma_f32_16x16x32_bf16 v[56:59], v[120:123], v[108:111], v[56:59]
  ds_read_b128 v[144:147], v11 offset:36864
  s_add_u32 m0, s68, 24576
  v_mfma_f32_16x16x32_bf16 v[72:75], v[120:123], v[112:115], v[72:75]
  ds_read_b64_tr_b16 v[164:165], v27 offset:57344
  v_mfma_f32_16x16x32_bf16 v[76:79], v[124:127], v[112:115], v[76:79]
  ds_read_b64_tr_b16 v[166:167], v27 offset:58368
  buffer_load_dwordx4 v8, s[40:43], s70 offen lds
  v_mfma_f32_16x16x32_bf16 v[80:83], v[128:131], v[112:115], v[80:83]
  ds_read_b128 v[148:151], v11 offset:38912
  v_mfma_f32_16x16x32_bf16 v[84:87], v[132:135], v[112:115], v[84:87]
  s_add_u32 m0, s68, 28672
  v_mfma_f32_16x16x32_bf16 v[100:103], v[132:135], v[116:119], v[100:103]
  v_mfma_f32_16x16x32_bf16 v[96:99], v[128:131], v[116:119], v[96:99]
  buffer_load_dwordx4 v9, s[40:43], s70 offen lds
  v_mfma_f32_16x16x32_bf16 v[92:95], v[124:127], v[116:119], v[92:95]
  v_mfma_f32_16x16x32_bf16 v[88:91], v[120:123], v[116:119], v[88:91]
  s_waitcnt lgkmcnt(0)
  v_mfma_f32_16x16x32_bf16 v[40:43], v[152:155], v[136:139], v[40:43]
  v_mfma_f32_16x16x32_bf16 v[44:47], v[156:159], v[136:139], v[44:47]
  v_mfma_f32_16x16x32_bf16 v[48:51], v[160:163], v[136:139], v[48:51]
  s_waitcnt vmcnt(16)
  s_barrier
  ds_read_b64_tr_b16 v[120:121], v28 offset:16384
  ds_read_b64_tr_b16 v[122:123], v28 offset:17408
  s_add_u32 m0, s68, 32768
  v_mfma_f32_16x16x32_bf16 v[52:55], v[164:167], v[136:139], v[52:55]
  ds_read_b128 v[104:107], v12 offset:0
  buffer_load_dwordx4 v2, s[44:47], s10 offen lds
  v_mfma_f32_16x16x32_bf16 v[68:71], v[164:167], v[140:143], v[68:71]
  ds_read_b64_tr_b16 v[124:125], v29 offset:16384
  v_readlane_b32 s69, v16, 30
  v_mfma_f32_16x16x32_bf16 v[64:67], v[160:163], v[140:143], v[64:67]
  ds_read_b64_tr_b16 v[126:127], v29 offset:17408
  ds_read_b128 v[108:111], v12 offset:2048
  s_add_u32 m0, s68, 36864
  v_mfma_f32_16x16x32_bf16 v[60:63], v[156:159], v[140:143], v[60:63]
  ds_read_b64_tr_b16 v[128:129], v30 offset:16384
  v_mfma_f32_16x16x32_bf16 v[56:59], v[152:155], v[140:143], v[56:59]
  ds_read_b64_tr_b16 v[130:131], v30 offset:17408
  buffer_load_dwordx4 v3, s[44:47], s10 offen lds
  v_mfma_f32_16x16x32_bf16 v[72:75], v[152:155], v[144:147], v[72:75]
  ds_read_b128 v[112:115], v12 offset:4096
  ds_read_b64_tr_b16 v[132:133], v31 offset:16384
  s_add_u32 m0, s68, 40960
  v_mfma_f32_16x16x32_bf16 v[76:79], v[156:159], v[144:147], v[76:79]
  ds_read_b64_tr_b16 v[134:135], v31 offset:17408
  buffer_load_dwordx4 v4, s[44:47], s10 offen lds
  v_mfma_f32_16x16x32_bf16 v[80:83], v[160:163], v[144:147], v[80:83]
  ds_read_b128 v[116:119], v12 offset:6144
  v_mfma_f32_16x16x32_bf16 v[84:87], v[164:167], v[144:147], v[84:87]
  s_add_u32 m0, s68, 45056
  v_mfma_f32_16x16x32_bf16 v[100:103], v[164:167], v[148:151], v[100:103]
  buffer_load_dwordx4 v5, s[44:47], s10 offen lds
  v_mfma_f32_16x16x32_bf16 v[96:99], v[160:163], v[148:151], v[96:99]
  s_mul_i32 s70, s69, 640
  v_mfma_f32_16x16x32_bf16 v[92:95], v[156:159], v[148:151], v[92:95]
  v_mfma_f32_16x16x32_bf16 v[88:91], v[152:155], v[148:151], v[88:91]
  s_waitcnt lgkmcnt(0)
  ds_read_b64_tr_b16 v[152:153], v28 offset:24576
  s_add_u32 m0, s68, 49152
  v_mfma_f32_16x16x32_bf16 v[40:43], v[120:123], v[104:107], v[40:43]
  ds_read_b64_tr_b16 v[154:155], v28 offset:25600
  v_mfma_f32_16x16x32_bf16 v[44:47], v[124:127], v[104:107], v[44:47]
  ds_read_b128 v[136:139], v13 offset:0
  buffer_load_dwordx4 v6, s[40:43], s11 offen lds
  v_mfma_f32_16x16x32_bf16 v[48:51], v[128:131], v[104:107], v[48:51]
  ds_read_b64_tr_b16 v[156:157], v29 offset:24576
  v_mfma_f32_16x16x32_bf16 v[52:55], v[132:135], v[104:107], v[52:55]
  ds_read_b64_tr_b16 v[158:159], v29 offset:25600
  s_add_u32 m0, s68, 53248
  v_mfma_f32_16x16x32_bf16 v[68:71], v[132:135], v[108:111], v[68:71]
  ds_read_b128 v[140:143], v13 offset:2048
  v_mfma_f32_16x16x32_bf16 v[64:67], v[128:131], v[108:111], v[64:67]
  ds_read_b64_tr_b16 v[160:161], v30 offset:24576
  buffer_load_dwordx4 v7, s[40:43], s11 offen lds
  v_mfma_f32_16x16x32_bf16 v[60:63], v[124:127], v[108:111], v[60:63]
  ds_read_b64_tr_b16 v[162:163], v30 offset:25600
  v_mfma_f32_16x16x32_bf16 v[56:59], v[120:123], v[108:111], v[56:59]
  ds_read_b128 v[144:147], v13 offset:4096
  s_add_u32 m0, s68, 57344
  v_mfma_f32_16x16x32_bf16 v[72:75], v[120:123], v[112:115], v[72:75]
  ds_read_b64_tr_b16 v[164:165], v31 offset:24576
  v_mfma_f32_16x16x32_bf16 v[76:79], v[124:127], v[112:115], v[76:79]
  ds_read_b64_tr_b16 v[166:167], v31 offset:25600
  buffer_load_dwordx4 v8, s[40:43], s11 offen lds
  v_mfma_f32_16x16x32_bf16 v[80:83], v[128:131], v[112:115], v[80:83]
  ds_read_b128 v[148:151], v13 offset:6144
  v_mfma_f32_16x16x32_bf16 v[84:87], v[132:135], v[112:115], v[84:87]
  s_add_u32 m0, s68, 61440
  v_mfma_f32_16x16x32_bf16 v[100:103], v[132:135], v[116:119], v[100:103]
  v_mfma_f32_16x16x32_bf16 v[96:99], v[128:131], v[116:119], v[96:99]
  buffer_load_dwordx4 v9, s[40:43], s11 offen lds
L_pad7:
  s_cbranch_execz L_pad55
  v_mfma_f32_16x16x32_bf16 v[92:95], v[124:127], v[116:119], v[92:95]
  v_mfma_f32_16x16x32_bf16 v[88:91], v[120:123], v[116:119], v[88:91]
  s_waitcnt lgkmcnt(0)
  v_mfma_f32_16x16x32_bf16 v[40:43], v[152:155], v[136:139], v[40:43]
  v_mfma_f32_16x16x32_bf16 v[44:47], v[156:159], v[136:139], v[44:47]
  v_mfma_f32_16x16x32_bf16 v[48:51], v[160:163], v[136:139], v[48:51]
  s_waitcnt vmcnt(16)
  s_barrier
  ds_read_b64_tr_b16 v[120:121], v28 offset:49152
  ds_read_b64_tr_b16 v[122:123], v28 offset:50176
  s_add_u32 m0, s68, 65536
  v_mfma_f32_16x16x32_bf16 v[52:55], v[164:167], v[136:139], v[52:55]
  ds_read_b128 v[104:107], v12 offset:32768
  buffer_load_dwordx4 v2, s[44:47], s69 offen lds
  v_mfma_f32_16x16x32_bf16 v[68:71], v[164:167], v[140:143], v[68:71]
  ds_read_b64_tr_b16 v[124:125], v29 offset:49152
  v_readlane_b32 s10, v16, 31
  v_mfma_f32_16x16x32_bf16 v[64:67], v[160:163], v[140:143], v[64:67]
  ds_read_b64_tr_b16 v[126:127], v29 offset:50176
  ds_read_b128 v[108:111], v12 offset:34816
  s_add_u32 m0, s68, 69632
  v_mfma_f32_16x16x32_bf16 v[60:63], v[156:159], v[140:143], v[60:63]
  ds_read_b64_tr_b16 v[128:129], v30 offset:49152
  v_mfma_f32_16x16x32_bf16 v[56:59], v[152:155], v[140:143], v[56:59]
  ds_read_b64_tr_b16 v[130:131], v30 offset:50176
  buffer_load_dwordx4 v3, s[44:47], s69 offen lds
  v_mfma_f32_16x16x32_bf16 v[72:75], v[152:155], v[144:147], v[72:75]
  ds_read_b128 v[112:115], v12 offset:36864
  ds_read_b64_tr_b16 v[132:133], v31 offset:49152
  s_add_u32 m0, s68, 73728
  v_mfma_f32_16x16x32_bf16 v[76:79], v[156:159], v[144:147], v[76:79]
  ds_read_b64_tr_b16 v[134:135], v31 offset:50176
  buffer_load_dwordx4 v4, s[44:47], s69 offen lds
  v_mfma_f32_16x16x32_bf16 v[80:83], v[160:163], v[144:147], v[80:83]
  ds_read_b128 v[116:119], v12 offset:38912
  v_mfma_f32_16x16x32_bf16 v[84:87], v[164:167], v[144:147], v[84:87]
  s_add_u32 m0, s68, 77824
  v_mfma_f32_16x16x32_bf16 v[100:103], v[164:167], v[148:151], v[100:103]
  buffer_load_dwordx4 v5, s[44:47], s69 offen lds
  v_mfma_f32_16x16x32_bf16 v[96:99], v[160:163], v[148:151], v[96:99]
  s_mul_i32 s11, s10, 640
  v_mfma_f32_16x16x32_bf16 v[92:95], v[156:159], v[148:151], v[92:95]
  v_mfma_f32_16x16x32_bf16 v[88:91], v[152:155], v[148:151], v[88:91]
  s_waitcnt lgkmcnt(0)
  ds_read_b64_tr_b16 v[152:153], v28 offset:57344
  s_add_u32 m0, s68, 81920
  v_mfma_f32_16x16x32_bf16 v[40:43], v[120:123], v[104:107], v[40:43]
  ds_read_b64_tr_b16 v[154:155], v28 offset:58368
  v_mfma_f32_16x16x32_bf16 v[44:47], v[124:127], v[104:107], v[44:47]
  ds_read_b128 v[136:139], v13 offset:32768
  buffer_load_dwordx4 v6, s[40:43], s70 offen lds
  v_mfma_f32_16x16x32_bf16 v[48:51], v[128:131], v[104:107], v[48:51]
  ds_read_b64_tr_b16 v[156:157], v29 offset:57344
  v_mfma_f32_16x16x32_bf16 v[52:55], v[132:135], v[104:107], v[52:55]
  ds_read_b64_tr_b16 v[158:159], v29 offset:58368
  s_add_u32 m0, s68, 86016
  v_mfma_f32_16x16x32_bf16 v[68:71], v[132:135], v[108:111], v[68:71]
  ds_read_b128 v[140:143], v13 offset:34816
  v_mfma_f32_16x16x32_bf16 v[64:67], v[128:131], v[108:111], v[64:67]
  ds_read_b64_tr_b16 v[160:161], v30 offset:57344
  buffer_load_dwordx4 v7, s[40:43], s70 offen lds
  v_mfma_f32_16x16x32_bf16 v[60:63], v[124:127], v[108:111], v[60:63]
  ds_read_b64_tr_b16 v[162:163], v30 offset:58368
  v_mfma_f32_16x16x32_bf16 v[56:59], v[120:123], v[108:111], v[56:59]
  ds_read_b128 v[144:147], v13 offset:36864
  s_add_u32 m0, s68, 90112
  v_mfma_f32_16x16x32_bf16 v[72:75], v[120:123], v[112:115], v[72:75]
  ds_read_b64_tr_b16 v[164:165], v31 offset:57344
  v_mfma_f32_16x16x32_bf16 v[76:79], v[124:127], v[112:115], v[76:79]
  ds_read_b64_tr_b16 v[166:167], v31 offset:58368
  buffer_load_dwordx4 v8, s[40:43], s70 offen lds
  v_mfma_f32_16x16x32_bf16 v[80:83], v[128:131], v[112:115], v[80:83]
  ds_read_b128 v[148:151], v13 offset:38912
  v_mfma_f32_16x16x32_bf16 v[84:87], v[132:135], v[112:115], v[84:87]
  s_add_u32 m0, s68, 94208
  v_mfma_f32_16x16x32_bf16 v[100:103], v[132:135], v[116:119], v[100:103]
  v_mfma_f32_16x16x32_bf16 v[96:99], v[128:131], v[116:119], v[96:99]
  buffer_load_dwordx4 v9, s[40:43], s70 offen lds
  v_mfma_f32_16x16x32_bf16 v[92:95], v[124:127], v[116:119], v[92:95]
  v_mfma_f32_16x16x32_bf16 v[88:91], v[120:123], v[116:119], v[88:91]
  s_waitcnt lgkmcnt(0)
  v_mfma_f32_16x16x32_bf16 v[40:43], v[152:155], v[136:139], v[40:43]
  v_mfma_f32_16x16x32_bf16 v[44:47], v[156:159], v[136:139], v[44:47]
  v_mfma_f32_16x16x32_bf16 v[48:51], v[160:163], v[136:139], v[48:51]
  s_waitcnt vmcnt(16)
  s_barrier
  ds_read_b64_tr_b16 v[120:121], v24 offset:16384
  ds_read_b64_tr_b16 v[122:123], v24 offset:17408
  s_add_u32 m0, s68, 98304
  v_mfma_f32_16x16x32_bf16 v[52:55], v[164:167], v[136:139], v[52:55]
  ds_read_b128 v[104:107], v10 offset:0
  buffer_load_dwordx4 v2, s[44:47], s10 offen lds
  v_mfma_f32_16x16x32_bf16 v[68:71], v[164:167], v[140:143], v[68:71]
  ds_read_b64_tr_b16 v[124:125], v25 offset:16384
  v_mfma_f32_16x16x32_bf16 v[64:67], v[160:163], v[140:143], v[64:67]
  ds_read_b64_tr_b16 v[126:127], v25 offset:17408
  ds_read_b128 v[108:111], v10 offset:2048
  s_add_u32 m0, s68, 102400
  v_mfma_f32_16x16x32_bf16 v[60:63], v[156:159], v[140:143], v[60:63]
  ds_read_b64_tr_b16 v[128:129], v26 offset:16384
  buffer_load_dwordx4 v3, s[44:47], s10 offen lds
  v_mfma_f32_16x16x32_bf16 v[56:59], v[152:155], v[140:143], v[56:59]
  ds_read_b64_tr_b16 v[130:131], v26 offset:17408
  v_mfma_f32_16x16x32_bf16 v[72:75], v[152:155], v[144:147], v[72:75]
  ds_read_b128 v[112:115], v10 offset:4096
  ds_read_b64_tr_b16 v[132:133], v27 offset:16384
  s_add_u32 m0, s68, 106496
  v_mfma_f32_16x16x32_bf16 v[76:79], v[156:159], v[144:147], v[76:79]
  ds_read_b64_tr_b16 v[134:135], v27 offset:17408
  v_mfma_f32_16x16x32_bf16 v[80:83], v[160:163], v[144:147], v[80:83]
  ds_read_b128 v[116:119], v10 offset:6144
  buffer_load_dwordx4 v4, s[44:47], s10 offen lds
  v_mfma_f32_16x16x32_bf16 v[84:87], v[164:167], v[144:147], v[84:87]
  s_add_u32 m0, s68, 110592
  v_mfma_f32_16x16x32_bf16 v[100:103], v[164:167], v[148:151], v[100:103]
  v_mfma_f32_16x16x32_bf16 v[96:99], v[160:163], v[148:151], v[96:99]
  buffer_load_dwordx4 v5, s[44:47], s10 offen lds
  v_mfma_f32_16x16x32_bf16 v[92:95], v[156:159], v[148:151], v[92:95]
  v_mfma_f32_16x16x32_bf16 v[88:91], v[152:155], v[148:151], v[88:91]
  s_waitcnt lgkmcnt(0)
  ds_read_b64_tr_b16 v[152:153], v24 offset:24576
  s_add_u32 m0, s68, 114688
  v_mfma_f32_16x16x32_bf16 v[40:43], v[120:123], v[104:107], v[40:43]
  ds_read_b64_tr_b16 v[154:155], v24 offset:25600
  buffer_load_dwordx4 v6, s[40:43], s11 offen lds
  v_mfma_f32_16x16x32_bf16 v[44:47], v[124:127], v[104:107], v[44:47]
  ds_read_b128 v[136:139], v11 offset:0
  s_add_u32 m0, s68, 118784
  v_mfma_f32_16x16x32_bf16 v[48:51], v[128:131], v[104:107], v[48:51]
  ds_read_b64_tr_b16 v[156:157], v25 offset:24576
  buffer_load_dwordx4 v7, s[40:43], s11 offen lds
  v_mfma_f32_16x16x32_bf16 v[52:55], v[132:135], v[104:107], v[52:55]
  ds_read_b64_tr_b16 v[158:159], v25 offset:25600
  s_add_u32 m0, s68, 122880
  v_mfma_f32_16x16x32_bf16 v[68:71], v[132:135], v[108:111], v[68:71]
  ds_read_b128 v[140:143], v11 offset:2048
  buffer_load_dwordx4 v8, s[40:43], s11 offen lds
  v_mfma_f32_16x16x32_bf16 v[64:67], v[128:131], v[108:111], v[64:67]
  ds_read_b64_tr_b16 v[160:161], v26 offset:24576
  s_add_u32 m0, s68, 126976
  v_mfma_f32_16x16x32_bf16 v[60:63], v[124:127], v[108:111], v[60:63]
  ds_read_b64_tr_b16 v[162:163], v26 offset:25600
  v_mfma_f32_16x16x32_bf16 v[56:59], v[120:123], v[108:111], v[56:59]
  ds_read_b128 v[144:147], v11 offset:4096
  buffer_load_dwordx4 v9, s[40:43], s11 offen lds
  v_mfma_f32_16x16x32_bf16 v[72:75], v[120:123], v[112:115], v[72:75]
  ds_read_b64_tr_b16 v[164:165], v27 offset:24576
  v_readlane_b32 s101, v38, 1
  v_mfma_f32_16x16x32_bf16 v[76:79], v[124:127], v[112:115], v[76:79]
  ds_read_b64_tr_b16 v[166:167], v27 offset:25600
  s_bitcmp1_b32 s100, 31
  v_mfma_f32_16x16x32_bf16 v[80:83], v[128:131], v[112:115], v[80:83]
  ds_read_b128 v[148:151], v11 offset:6144
  s_cselect_b32 s60, s24, s22
  v_mfma_f32_16x16x32_bf16 v[84:87], v[132:135], v[112:115], v[84:87]
  s_cselect_b32 s61, s25, s23
  v_mfma_f32_16x16x32_bf16 v[100:103], v[132:135], v[116:119], v[100:103]
  s_bitset0_b32 s100, 31
  v_mfma_f32_16x16x32_bf16 v[96:99], v[128:131], v[116:119], v[96:99]
  buffer_load_dwordx2 a[252:253], off, s[96:99], 0
  v_mfma_f32_16x16x32_bf16 v[92:95], v[124:127], v[116:119], v[92:95]
  v_mfma_f32_16x16x32_bf16 v[88:91], v[120:123], v[116:119], v[88:91]
  s_waitcnt lgkmcnt(0)
  v_mfma_f32_16x16x32_bf16 v[40:43], v[152:155], v[136:139], v[40:43]
  v_mfma_f32_16x16x32_bf16 v[44:47], v[156:159], v[136:139], v[44:47]
  v_mfma_f32_16x16x32_bf16 v[48:51], v[160:163], v[136:139], v[48:51]
  s_waitcnt vmcnt(17)
  s_barrier
  ds_read_b64_tr_b16 v[120:121], v24 offset:49152
  ds_read_b64_tr_b16 v[122:123], v24 offset:50176
  s_add_u32 m0, s68, 131072
  s_nop 0
  buffer_load_dwordx4 v36, s[60:63], s100 offen lds
  s_add_u32 m0, s68, 135168
  v_mfma_f32_16x16x32_bf16 v[52:55], v[164:167], v[136:139], v[52:55]
  ds_read_b128 v[104:107], v10 offset:32768
  buffer_load_dwordx4 v37, s[60:63], s100 offen lds
  v_readlane_b32 s100, v38, 2
  v_mfma_f32_16x16x32_bf16 v[68:71], v[164:167], v[140:143], v[68:71]
  ds_read_b64_tr_b16 v[124:125], v25 offset:49152
  s_bitcmp1_b32 s101, 31
  s_cselect_b32 s60, s24, s22
  v_mfma_f32_16x16x32_bf16 v[64:67], v[160:163], v[140:143], v[64:67]
  ds_read_b64_tr_b16 v[126:127], v25 offset:50176
  ds_read_b128 v[108:111], v10 offset:34816
  s_cselect_b32 s61, s25, s23
  s_bitset0_b32 s101, 31
  v_mfma_f32_16x16x32_bf16 v[60:63], v[156:159], v[140:143], v[60:63]
  ds_read_b64_tr_b16 v[128:129], v26 offset:49152
  s_add_u32 m0, s68, 139264
  s_nop 0
  buffer_load_dwordx4 v36, s[60:63], s101 offen lds
  v_mfma_f32_16x16x32_bf16 v[56:59], v[152:155], v[140:143], v[56:59]
  ds_read_b64_tr_b16 v[130:131], v26 offset:50176
  s_add_u32 m0, s68, 143360
  s_nop 0
  buffer_load_dwordx4 v37, s[60:63], s101 offen lds
  v_mfma_f32_16x16x32_bf16 v[72:75], v[152:155], v[144:147], v[72:75]
  ds_read_b128 v[112:115], v10 offset:36864
  ds_read_b64_tr_b16 v[132:133], v27 offset:49152
  v_readlane_b32 s101, v38, 3
  s_bitcmp1_b32 s100, 31
  v_mfma_f32_16x16x32_bf16 v[76:79], v[156:159], v[144:147], v[76:79]
  ds_read_b64_tr_b16 v[134:135], v27 offset:50176
  s_cselect_b32 s60, s24, s22
  s_cselect_b32 s61, s25, s23
  v_mfma_f32_16x16x32_bf16 v[80:83], v[160:163], v[144:147], v[80:83]
  ds_read_b128 v[116:119], v10 offset:38912
  s_bitset0_b32 s100, 31
  s_add_u32 m0, s68, 147456
  v_mfma_f32_16x16x32_bf16 v[84:87], v[164:167], v[144:147], v[84:87]
  buffer_load_dwordx4 v36, s[60:63], s100 offen lds
  s_add_u32 m0, s68, 151552
  v_mfma_f32_16x16x32_bf16 v[100:103], v[164:167], v[148:151], v[100:103]
  buffer_load_dwordx4 v37, s[60:63], s100 offen lds
  v_readlane_b32 s100, v38, 4
  v_mfma_f32_16x16x32_bf16 v[96:99], v[160:163], v[148:151], v[96:99]
  s_bitcmp1_b32 s101, 31
  s_cselect_b32 s60, s24, s22
  v_mfma_f32_16x16x32_bf16 v[92:95], v[156:159], v[148:151], v[92:95]
  s_cselect_b32 s61, s25, s23
  s_bitset0_b32 s101, 31
  v_mfma_f32_16x16x32_bf16 v[88:91], v[152:155], v[148:151], v[88:91]
  s_waitcnt lgkmcnt(0)
  ds_read_b64_tr_b16 v[152:153], v24 offset:57344
  s_add_u32 m0, s68, 155648
  s_nop 0
  buffer_load_dwordx4 v36, s[60:63], s101 offen lds
  v_mfma_f32_16x16x32_bf16 v[40:43], v[120:123], v[104:107], v[40:43]
  ds_read_b64_tr_b16 v[154:155], v24 offset:58368
  s_add_u32 m0, s68, 159744
  s_nop 0
  buffer_load_dwordx4 v37, s[60:63], s101 offen lds
  v_mfma_f32_16x16x32_bf16 v[44:47], v[124:127], v[104:107], v[44:47]
  ds_read_b128 v[136:139], v11 offset:32768
  v_readlane_b32 s101, v38, 5
  s_bitcmp1_b32 s100, 31
  v_mfma_f32_16x16x32_bf16 v[48:51], v[128:131], v[104:107], v[48:51]
  ds_read_b64_tr_b16 v[156:157], v25 offset:57344
  s_cselect_b32 s60, s24, s22
  v_mfma_f32_16x16x32_bf16 v[52:55], v[132:135], v[104:107], v[52:55]
  ds_read_b64_tr_b16 v[158:159], v25 offset:58368
  s_cselect_b32 s61, s25, s23
  s_bitset0_b32 s100, 31
  v_mfma_f32_16x16x32_bf16 v[68:71], v[132:135], v[108:111], v[68:71]
  ds_read_b128 v[140:143], v11 offset:34816
  s_add_u32 m0, s68, 0
  s_nop 0
  buffer_load_dwordx4 v36, s[60:63], s100 offen lds
  v_mfma_f32_16x16x32_bf16 v[64:67], v[128:131], v[108:111], v[64:67]
  ds_read_b64_tr_b16 v[160:161], v26 offset:57344
  s_add_u32 m0, s68, 4096
  v_mfma_f32_16x16x32_bf16 v[60:63], v[124:127], v[108:111], v[60:63]
  ds_read_b64_tr_b16 v[162:163], v26 offset:58368
  buffer_load_dwordx4 v37, s[60:63], s100 offen lds
  v_readlane_b32 s100, v38, 6
  v_mfma_f32_16x16x32_bf16 v[56:59], v[120:123], v[108:111], v[56:59]
  ds_read_b128 v[144:147], v11 offset:36864
  s_bitcmp1_b32 s101, 31
  s_cselect_b32 s60, s24, s22
  v_mfma_f32_16x16x32_bf16 v[72:75], v[120:123], v[112:115], v[72:75]
  ds_read_b64_tr_b16 v[164:165], v27 offset:57344
  s_cselect_b32 s61, s25, s23
  v_mfma_f32_16x16x32_bf16 v[76:79], v[124:127], v[112:115], v[76:79]
  ds_read_b64_tr_b16 v[166:167], v27 offset:58368
  s_bitset0_b32 s101, 31
  s_add_u32 m0, s68, 8192
  v_mfma_f32_16x16x32_bf16 v[80:83], v[128:131], v[112:115], v[80:83]
  ds_read_b128 v[148:151], v11 offset:38912
  buffer_load_dwordx4 v36, s[60:63], s101 offen lds
  s_add_u32 m0, s68, 12288
  v_mfma_f32_16x16x32_bf16 v[84:87], v[132:135], v[112:115], v[84:87]
  buffer_load_dwordx4 v37, s[60:63], s101 offen lds
  v_mfma_f32_16x16x32_bf16 v[100:103], v[132:135], v[116:119], v[100:103]
  v_readlane_b32 s101, v38, 7
  s_bitcmp1_b32 s100, 31
  v_mfma_f32_16x16x32_bf16 v[96:99], v[128:131], v[116:119], v[96:99]
  s_cselect_b32 s60, s24, s22
  s_cselect_b32 s61, s25, s23
  v_mfma_f32_16x16x32_bf16 v[92:95], v[124:127], v[116:119], v[92:95]
  s_bitset0_b32 s100, 31
  v_mfma_f32_16x16x32_bf16 v[88:91], v[120:123], v[116:119], v[88:91]
L_pad8:
  s_cbranch_execz L_pad56
  s_waitcnt lgkmcnt(0)
  v_mfma_f32_16x16x32_bf16 v[40:43], v[152:155], v[136:139], v[40:43]
  v_mfma_f32_16x16x32_bf16 v[44:47], v[156:159], v[136:139], v[44:47]
  v_mfma_f32_16x16x32_bf16 v[48:51], v[160:163], v[136:139], v[48:51]
  s_waitcnt vmcnt(21)
  s_barrier
  ds_read_b64_tr_b16 v[120:121], v28 offset:16384
  ds_read_b64_tr_b16 v[122:123], v28 offset:17408
  s_add_u32 m0, s68, 16384
  s_nop 0
  buffer_load_dwordx4 v36, s[60:63], s100 offen lds
  s_add_u32 m0, s68, 20480
  v_mfma_f32_16x16x32_bf16 v[52:55], v[164:167], v[136:139], v[52:55]
  ds_read_b128 v[104:107], v12 offset:0
  buffer_load_dwordx4 v37, s[60:63], s100 offen lds
  v_readlane_b32 s100, v38, 8
  v_mfma_f32_16x16x32_bf16 v[68:71], v[164:167], v[140:143], v[68:71]
  ds_read_b64_tr_b16 v[124:125], v29 offset:16384
  s_bitcmp1_b32 s101, 31
  s_cselect_b32 s60, s24, s22
  v_mfma_f32_16x16x32_bf16 v[64:67], v[160:163], v[140:143], v[64:67]
  ds_read_b64_tr_b16 v[126:127], v29 offset:17408
  ds_read_b128 v[108:111], v12 offset:2048
  s_cselect_b32 s61, s25, s23
  s_bitset0_b32 s101, 31
  v_mfma_f32_16x16x32_bf16 v[60:63], v[156:159], v[140:143], v[60:63]
  ds_read_b64_tr_b16 v[128:129], v30 offset:16384
  s_add_u32 m0, s68, 24576
  s_nop 0
  buffer_load_dwordx4 v36, s[60:63], s101 offen lds
  v_mfma_f32_16x16x32_bf16 v[56:59], v[152:155], v[140:143], v[56:59]
  ds_read_b64_tr_b16 v[130:131], v30 offset:17408
  s_add_u32 m0, s68, 28672
  s_nop 0
  buffer_load_dwordx4 v37, s[60:63], s101 offen lds
  v_mfma_f32_16x16x32_bf16 v[72:75], v[152:155], v[144:147], v[72:75]
  ds_read_b128 v[112:115], v12 offset:4096
  ds_read_b64_tr_b16 v[132:133], v31 offset:16384
  v_readlane_b32 s101, v38, 9
  s_bitcmp1_b32 s100, 31
  v_mfma_f32_16x16x32_bf16 v[76:79], v[156:159], v[144:147], v[76:79]
  ds_read_b64_tr_b16 v[134:135], v31 offset:17408
  s_cselect_b32 s60, s24, s22
  s_cselect_b32 s61, s25, s23
  v_mfma_f32_16x16x32_bf16 v[80:83], v[160:163], v[144:147], v[80:83]
  ds_read_b128 v[116:119], v12 offset:6144
  s_bitset0_b32 s100, 31
  s_add_u32 m0, s68, 32768
  v_mfma_f32_16x16x32_bf16 v[84:87], v[164:167], v[144:147], v[84:87]
  buffer_load_dwordx4 v36, s[60:63], s100 offen lds
  s_add_u32 m0, s68, 36864
  v_mfma_f32_16x16x32_bf16 v[100:103], v[164:167], v[148:151], v[100:103]
  buffer_load_dwordx4 v37, s[60:63], s100 offen lds
  v_readlane_b32 s100, v38, 10
  v_mfma_f32_16x16x32_bf16 v[96:99], v[160:163], v[148:151], v[96:99]
  s_bitcmp1_b32 s101, 31
  s_cselect_b32 s60, s24, s22
  v_mfma_f32_16x16x32_bf16 v[92:95], v[156:159], v[148:151], v[92:95]
  s_cselect_b32 s61, s25, s23
  s_bitset0_b32 s101, 31
  v_mfma_f32_16x16x32_bf16 v[88:91], v[152:155], v[148:151], v[88:91]
  s_waitcnt lgkmcnt(0)
  ds_read_b64_tr_b16 v[152:153], v28 offset:24576
  s_add_u32 m0, s68, 40960
  s_nop 0
  buffer_load_dwordx4 v36, s[60:63], s101 offen lds
  v_mfma_f32_16x16x32_bf16 v[40:43], v[120:123], v[104:107], v[40:43]
  ds_read_b64_tr_b16 v[154:155], v28 offset:25600
  s_add_u32 m0, s68, 45056
  s_nop 0
  buffer_load_dwordx4 v37, s[60:63], s101 offen lds
  v_mfma_f32_16x16x32_bf16 v[44:47], v[124:127], v[104:107], v[44:47]
  ds_read_b128 v[136:139], v13 offset:0
  v_readlane_b32 s101, v38, 11
  s_bitcmp1_b32 s100, 31
  v_mfma_f32_16x16x32_bf16 v[48:51], v[128:131], v[104:107], v[48:51]
  ds_read_b64_tr_b16 v[156:157], v29 offset:24576
  s_cselect_b32 s60, s24, s22
  v_mfma_f32_16x16x32_bf16 v[52:55], v[132:135], v[104:107], v[52:55]
  ds_read_b64_tr_b16 v[158:159], v29 offset:25600
  s_cselect_b32 s61, s25, s23
  s_bitset0_b32 s100, 31
  v_mfma_f32_16x16x32_bf16 v[68:71], v[132:135], v[108:111], v[68:71]
  ds_read_b128 v[140:143], v13 offset:2048
  s_add_u32 m0, s68, 49152
  s_nop 0
  buffer_load_dwordx4 v36, s[60:63], s100 offen lds
  v_mfma_f32_16x16x32_bf16 v[64:67], v[128:131], v[108:111], v[64:67]
  ds_read_b64_tr_b16 v[160:161], v30 offset:24576
  s_add_u32 m0, s68, 53248
  v_mfma_f32_16x16x32_bf16 v[60:63], v[124:127], v[108:111], v[60:63]
  ds_read_b64_tr_b16 v[162:163], v30 offset:25600
  buffer_load_dwordx4 v37, s[60:63], s100 offen lds
  v_readlane_b32 s100, v38, 12
  v_mfma_f32_16x16x32_bf16 v[56:59], v[120:123], v[108:111], v[56:59]
  ds_read_b128 v[144:147], v13 offset:4096
  s_bitcmp1_b32 s101, 31
  s_cselect_b32 s60, s24, s22
  v_mfma_f32_16x16x32_bf16 v[72:75], v[120:123], v[112:115], v[72:75]
  ds_read_b64_tr_b16 v[164:165], v31 offset:24576
  s_cselect_b32 s61, s25, s23
  v_mfma_f32_16x16x32_bf16 v[76:79], v[124:127], v[112:115], v[76:79]
  ds_read_b64_tr_b16 v[166:167], v31 offset:25600
  s_bitset0_b32 s101, 31
  s_add_u32 m0, s68, 57344
  v_mfma_f32_16x16x32_bf16 v[80:83], v[128:131], v[112:115], v[80:83]
  ds_read_b128 v[148:151], v13 offset:6144
  buffer_load_dwordx4 v36, s[60:63], s101 offen lds
  s_add_u32 m0, s68, 61440
  v_mfma_f32_16x16x32_bf16 v[84:87], v[132:135], v[112:115], v[84:87]
  buffer_load_dwordx4 v37, s[60:63], s101 offen lds
  v_mfma_f32_16x16x32_bf16 v[100:103], v[132:135], v[116:119], v[100:103]
  v_readlane_b32 s101, v38, 13
  s_bitcmp1_b32 s100, 31
  v_mfma_f32_16x16x32_bf16 v[96:99], v[128:131], v[116:119], v[96:99]
  s_cselect_b32 s60, s24, s22
  s_cselect_b32 s61, s25, s23
  v_mfma_f32_16x16x32_bf16 v[92:95], v[124:127], v[116:119], v[92:95]
  s_bitset0_b32 s100, 31
  v_mfma_f32_16x16x32_bf16 v[88:91], v[120:123], v[116:119], v[88:91]
  s_waitcnt lgkmcnt(0)
  v_mfma_f32_16x16x32_bf16 v[40:43], v[152:155], v[136:139], v[40:43]
  v_mfma_f32_16x16x32_bf16 v[44:47], v[156:159], v[136:139], v[44:47]
  v_mfma_f32_16x16x32_bf16 v[48:51], v[160:163], v[136:139], v[48:51]
  s_waitcnt vmcnt(25)
  s_barrier
  ds_read_b64_tr_b16 v[120:121], v28 offset:49152
  ds_read_b64_tr_b16 v[122:123], v28 offset:50176
  s_add_u32 m0, s68, 65536
  s_nop 0
  buffer_load_dwordx4 v36, s[60:63], s100 offen lds
  s_add_u32 m0, s68, 69632
  v_mfma_f32_16x16x32_bf16 v[52:55], v[164:167], v[136:139], v[52:55]
  ds_read_b128 v[104:107], v12 offset:32768
  buffer_load_dwordx4 v37, s[60:63], s100 offen lds
  v_readlane_b32 s100, v38, 14
  v_mfma_f32_16x16x32_bf16 v[68:71], v[164:167], v[140:143], v[68:71]
  ds_read_b64_tr_b16 v[124:125], v29 offset:49152
  s_bitcmp1_b32 s101, 31
  s_cselect_b32 s60, s24, s22
  v_mfma_f32_16x16x32_bf16 v[64:67], v[160:163], v[140:143], v[64:67]
  ds_read_b64_tr_b16 v[126:127], v29 offset:50176
  ds_read_b128 v[108:111], v12 offset:34816
  s_cselect_b32 s61, s25, s23
  s_bitset0_b32 s101, 31
  v_mfma_f32_16x16x32_bf16 v[60:63], v[156:159], v[140:143], v[60:63]
  ds_read_b64_tr_b16 v[128:129], v30 offset:49152
  s_add_u32 m0, s68, 73728
  s_nop 0
  buffer_load_dwordx4 v36, s[60:63], s101 offen lds
  v_mfma_f32_16x16x32_bf16 v[56:59], v[152:155], v[140:143], v[56:59]
  ds_read_b64_tr_b16 v[130:131], v30 offset:50176
  s_add_u32 m0, s68, 77824
  s_nop 0
  buffer_load_dwordx4 v37, s[60:63], s101 offen lds
  v_mfma_f32_16x16x32_bf16 v[72:75], v[152:155], v[144:147], v[72:75]
  ds_read_b128 v[112:115], v12 offset:36864
  ds_read_b64_tr_b16 v[132:133], v31 offset:49152
  v_readlane_b32 s101, v38, 15
  s_bitcmp1_b32 s100, 31
  v_mfma_f32_16x16x32_bf16 v[76:79], v[156:159], v[144:147], v[76:79]
  ds_read_b64_tr_b16 v[134:135], v31 offset:50176
  s_cselect_b32 s60, s24, s22
  s_cselect_b32 s61, s25, s23
  v_mfma_f32_16x16x32_bf16 v[80:83], v[160:163], v[144:147], v[80:83]
  ds_read_b128 v[116:119], v12 offset:38912
  s_bitset0_b32 s100, 31
  s_add_u32 m0, s68, 81920
  v_mfma_f32_16x16x32_bf16 v[84:87], v[164:167], v[144:147], v[84:87]
  buffer_load_dwordx4 v36, s[60:63], s100 offen lds
  s_add_u32 m0, s68, 86016
  v_mfma_f32_16x16x32_bf16 v[100:103], v[164:167], v[148:151], v[100:103]
  buffer_load_dwordx4 v37, s[60:63], s100 offen lds
  v_readlane_b32 s100, v38, 16
  v_mfma_f32_16x16x32_bf16 v[96:99], v[160:163], v[148:151], v[96:99]
  s_bitcmp1_b32 s101, 31
  s_cselect_b32 s60, s24, s22
  v_mfma_f32_16x16x32_bf16 v[92:95], v[156:159], v[148:151], v[92:95]
  s_cselect_b32 s61, s25, s23
  s_bitset0_b32 s101, 31
  v_mfma_f32_16x16x32_bf16 v[88:91], v[152:155], v[148:151], v[88:91]
  s_waitcnt lgkmcnt(0)
  ds_read_b64_tr_b16 v[152:153], v28 offset:57344
  s_add_u32 m0, s68, 90112
  v_mfma_f32_16x16x32_bf16 v[40:43], v[120:123], v[104:107], v[40:43]
  ds_read_b64_tr_b16 v[154:155], v28 offset:58368
  v_mfma_f32_16x16x32_bf16 v[44:47], v[124:127], v[104:107], v[44:47]
  ds_read_b128 v[136:139], v13 offset:32768
  v_mfma_f32_16x16x32_bf16 v[48:51], v[128:131], v[104:107], v[48:51]
  ds_read_b64_tr_b16 v[156:157], v29 offset:57344
  v_mfma_f32_16x16x32_bf16 v[52:55], v[132:135], v[104:107], v[52:55]
  ds_read_b64_tr_b16 v[158:159], v29 offset:58368
  buffer_load_dwordx4 v36, s[60:63], s101 offen lds
  v_mfma_f32_16x16x32_bf16 v[68:71], v[132:135], v[108:111], v[68:71]
  ds_read_b128 v[140:143], v13 offset:34816
  v_mfma_f32_16x16x32_bf16 v[64:67], v[128:131], v[108:111], v[64:67]
  ds_read_b64_tr_b16 v[160:161], v30 offset:57344
  v_mfma_f32_16x16x32_bf16 v[60:63], v[124:127], v[108:111], v[60:63]
  ds_read_b64_tr_b16 v[162:163], v30 offset:58368
  v_mfma_f32_16x16x32_bf16 v[56:59], v[120:123], v[108:111], v[56:59]
  ds_read_b128 v[144:147], v13 offset:36864
  s_add_u32 m0, s68, 94208
  v_mfma_f32_16x16x32_bf16 v[72:75], v[120:123], v[112:115], v[72:75]
  ds_read_b64_tr_b16 v[164:165], v31 offset:57344
  v_mfma_f32_16x16x32_bf16 v[76:79], v[124:127], v[112:115], v[76:79]
  ds_read_b64_tr_b16 v[166:167], v31 offset:58368
  v_mfma_f32_16x16x32_bf16 v[80:83], v[128:131], v[112:115], v[80:83]
  ds_read_b128 v[148:151], v13 offset:38912
  v_mfma_f32_16x16x32_bf16 v[84:87], v[132:135], v[112:115], v[84:87]
  buffer_load_dwordx4 v37, s[60:63], s101 offen lds
  v_mfma_f32_16x16x32_bf16 v[100:103], v[132:135], v[116:119], v[100:103]
  v_mfma_f32_16x16x32_bf16 v[96:99], v[128:131], v[116:119], v[96:99]
  v_mfma_f32_16x16x32_bf16 v[92:95], v[124:127], v[116:119], v[92:95]
  v_mfma_f32_16x16x32_bf16 v[88:91], v[120:123], v[116:119], v[88:91]
  s_waitcnt lgkmcnt(0)
  v_mfma_f32_16x16x32_bf16 v[40:43], v[152:155], v[136:139], v[40:43]
  v_mfma_f32_16x16x32_bf16 v[44:47], v[156:159], v[136:139], v[44:47]
  v_mfma_f32_16x16x32_bf16 v[48:51], v[160:163], v[136:139], v[48:51]
  v_mfma_f32_16x16x32_bf16 v[52:55], v[164:167], v[136:139], v[52:55]
  v_mfma_f32_16x16x32_bf16 v[68:71], v[164:167], v[140:143], v[68:71]
  v_mfma_f32_16x16x32_bf16 v[64:67], v[160:163], v[140:143], v[64:67]
  v_mfma_f32_16x16x32_bf16 v[60:63], v[156:159], v[140:143], v[60:63]
  v_mfma_f32_16x16x32_bf16 v[56:59], v[152:155], v[140:143], v[56:59]
  v_mfma_f32_16x16x32_bf16 v[72:75], v[152:155], v[144:147], v[72:75]
  v_mfma_f32_16x16x32_bf16 v[76:79], v[156:159], v[144:147], v[76:79]
  v_mfma_f32_16x16x32_bf16 v[80:83], v[160:163], v[144:147], v[80:83]
  v_mfma_f32_16x16x32_bf16 v[84:87], v[164:167], v[144:147], v[84:87]
  v_mfma_f32_16x16x32_bf16 v[100:103], v[164:167], v[148:151], v[100:103]
  v_mfma_f32_16x16x32_bf16 v[96:99], v[160:163], v[148:151], v[96:99]
  v_mfma_f32_16x16x32_bf16 v[92:95], v[156:159], v[148:151], v[92:95]
  v_mfma_f32_16x16x32_bf16 v[88:91], v[152:155], v[148:151], v[88:91]
L_pad9:
  s_cbranch_execz L_pad57
  s_nop 7
  v_lshlrev_b32 v18, 4, v1
  v_cvt_pk_bf16_f32 v104, v40, v41
  v_cvt_pk_bf16_f32 v105, v42, v43
  v_cvt_pk_bf16_f32 v106, v44, v45
  v_cvt_pk_bf16_f32 v107, v46, v47
  v_cvt_pk_bf16_f32 v108, v48, v49
  v_cvt_pk_bf16_f32 v109, v50, v51
  v_cvt_pk_bf16_f32 v110, v52, v53
  v_cvt_pk_bf16_f32 v111, v54, v55
  v_xor_b32 v104, s78, v104
  v_xor_b32 v105, s78, v105
  v_xor_b32 v106, s78, v106
  v_xor_b32 v107, s78, v107
  v_xor_b32 v108, s78, v108
  v_xor_b32 v109, s78, v109
  v_xor_b32 v110, s78, v110
  v_xor_b32 v111, s78, v111
  s_nop 1
  v_permlane32_swap_b32 v104, v106
  v_permlane32_swap_b32 v105, v107
  v_permlane32_swap_b32 v108, v110
  v_permlane32_swap_b32 v109, v111
  s_nop 0
  v_permlane16_swap_b32 v104, v106
  v_permlane16_swap_b32 v105, v107
  v_permlane16_swap_b32 v108, v110
  v_permlane16_swap_b32 v109, v111
  buffer_store_dwordx4 v[104:107], v18, s[56:59], s81 offen offset:0 sc1
  buffer_store_dwordx4 v[108:111], v18, s[56:59], s81 offen offset:1024 sc1
  s_add_u32 s81, s81, 90112
  v_cvt_pk_bf16_f32 v112, v56, v57
  v_cvt_pk_bf16_f32 v113, v58, v59
  v_cvt_pk_bf16_f32 v114, v60, v61
  v_cvt_pk_bf16_f32 v115, v62, v63
  v_cvt_pk_bf16_f32 v116, v64, v65
  v_cvt_pk_bf16_f32 v117, v66, v67
L_pad10:
  s_cbranch_execz L_pad58
  v_cvt_pk_bf16_f32 v118, v68, v69
  v_cvt_pk_bf16_f32 v119, v70, v71
  v_xor_b32 v112, s78, v112
  v_xor_b32 v113, s78, v113
  v_xor_b32 v114, s78, v114
  v_xor_b32 v115, s78, v115
  v_xor_b32 v116, s78, v116
  v_xor_b32 v117, s78, v117
  v_xor_b32 v118, s78, v118
  v_xor_b32 v119, s78, v119
  s_nop 1
  v_permlane32_swap_b32 v112, v114
  v_permlane32_swap_b32 v113, v115
  v_permlane32_swap_b32 v116, v118
  v_permlane32_swap_b32 v117, v119
  s_nop 0
  v_permlane16_swap_b32 v112, v114
  v_permlane16_swap_b32 v113, v115
  v_permlane16_swap_b32 v116, v118
  v_permlane16_swap_b32 v117, v119
  buffer_store_dwordx4 v[112:115], v18, s[56:59], s81 offen offset:0 sc1
  buffer_store_dwordx4 v[116:119], v18, s[56:59], s81 offen offset:1024 sc1
  s_add_u32 s81, s81, 90112
  v_cvt_pk_bf16_f32 v120, v72, v73
  v_cvt_pk_bf16_f32 v121, v74, v75
  v_cvt_pk_bf16_f32 v122, v76, v77
  v_cvt_pk_bf16_f32 v123, v78, v79
  v_cvt_pk_bf16_f32 v124, v80, v81
  v_cvt_pk_bf16_f32 v125, v82, v83
  v_cvt_pk_bf16_f32 v126, v84, v85
  v_cvt_pk_bf16_f32 v127, v86, v87
  v_xor_b32 v120, s78, v120
  v_xor_b32 v121, s78, v121
  v_xor_b32 v122, s78, v122
  v_xor_b32 v123, s78, v123
  v_xor_b32 v124, s78, v124
  v_xor_b32 v125, s78, v125
  v_xor_b32 v126, s78, v126
  v_xor_b32 v127, s78, v127
  s_nop 1
  v_permlane32_swap_b32 v120, v122
L_pad11:
  s_cbranch_execz L_pad59
  v_permlane32_swap_b32 v121, v123
  v_permlane32_swap_b32 v124, v126
  v_permlane32_swap_b32 v125, v127
  s_nop 0
  v_permlane16_swap_b32 v120, v122
  v_permlane16_swap_b32 v121, v123
  v_permlane16_swap_b32 v124, v126
  v_permlane16_swap_b32 v125, v127
  buffer_store_dwordx4 v[120:123], v18, s[56:59], s81 offen offset:0 sc1
  buffer_store_dwordx4 v[124:127], v18, s[56:59], s81 offen offset:1024 sc1
  s_add_u32 s81, s81, 90112
  v_cvt_pk_bf16_f32 v128, v88, v89
  v_cvt_pk_bf16_f32 v129, v90, v91
  v_cvt_pk_bf16_f32 v130, v92, v93
  v_cvt_pk_bf16_f32 v131, v94, v95
  v_cvt_pk_bf16_f32 v132, v96, v97
  v_cvt_pk_bf16_f32 v133, v98, v99
  v_cvt_pk_bf16_f32 v134, v100, v101
  v_cvt_pk_bf16_f32 v135, v102, v103
  v_xor_b32 v128, s78, v128
  v_xor_b32 v129, s78, v129
  v_xor_b32 v130, s78, v130
  v_xor_b32 v131, s78, v131
  v_xor_b32 v132, s78, v132
  v_xor_b32 v133, s78, v133
  v_xor_b32 v134, s78, v134
  v_xor_b32 v135, s78, v135
  s_nop 1
  v_permlane32_swap_b32 v128, v130
  v_permlane32_swap_b32 v129, v131
  v_permlane32_swap_b32 v132, v134
  v_permlane32_swap_b32 v133, v135
  s_nop 0
  v_permlane16_swap_b32 v128, v130
  v_permlane16_swap_b32 v129, v131
  v_permlane16_swap_b32 v132, v134
  v_permlane16_swap_b32 v133, v135
L_pad12:
  s_cbranch_execz L_pad60
  buffer_store_dwordx4 v[128:131], v18, s[56:59], s81 offen offset:0 sc1
  buffer_store_dwordx4 v[132:135], v18, s[56:59], s81 offen offset:1024 sc1
  s_add_u32 s81, s81, 90112
  s_waitcnt vmcnt(0)
  v_accvgpr_read_b32 v16, a252
  v_accvgpr_read_b32 v17, a253
  s_barrier
  s_mov_b32 s83, 100000
L_sig_chk_pq:
  v_readfirstlane_b32 s72, v16
  s_nop 3
  s_cmp_lg_u32 s72, 0
  s_cbranch_scc1 L_sig_go_pq
  s_sub_u32 s83, s83, 1
  s_cmp_eq_u32 s83, 0
  s_cbranch_scc1 L_sig_go_pq
  s_sleep 8
  buffer_load_dwordx2 v[16:17], off, s[96:99], 0 sc1
  s_waitcnt vmcnt(0)
  s_branch L_sig_chk_pq
L_sig_go_pq:
  s_mul_i32 s77, s4, 0x10000000
  buffer_store_dwordx2 v[16:17], v0, s[56:59], s77 offen sc1
  s_lshl_b32 s7, s7, 3
  s_mov_b32 s48, s32
  s_mov_b32 s49, s33
  s_mov_b32 s50, 1966080
  s_mov_b32 s51, 0x20000
  v_lshrrev_b32 v4, 3, v1
  s_lshl_b32 s72, s4, 3
  v_add_u32 v4, s72, v4
  v_mul_u32_u24 v4, 1280, v4
  v_lshrrev_b32 v5, 4, v1
  v_and_b32 v6, 7, v1
  v_lshlrev_b32 v7, 1, v5
  v_xor_b32 v7, v7, v6
  v_lshl_add_u32 v26, v7, 4, v4
  v_add_u32 v27, 40960, v26
  v_readlane_b32 s69, v39, 0
  v_readlane_b32 s101, v38, 17
  s_bitcmp1_b32 s100, 31
  s_cselect_b32 s60, s24, s22
  s_cselect_b32 s61, s25, s23
L_pad13:
  s_cbranch_execz L_pad61
  s_bitset0_b32 s100, 31
  s_add_u32 m0, s68, 98304
  s_nop 0
  buffer_load_dwordx4 v36, s[60:63], s100 offen lds
  s_add_u32 m0, s68, 102400
  s_nop 0
  buffer_load_dwordx4 v37, s[60:63], s100 offen lds
  v_readlane_b32 s100, v38, 18
  s_bitcmp1_b32 s101, 31
  s_cselect_b32 s60, s24, s22
  s_cselect_b32 s61, s25, s23
  s_bitset0_b32 s101, 31
  s_add_u32 m0, s68, 106496
  s_nop 0
  buffer_load_dwordx4 v36, s[60:63], s101 offen lds
  s_add_u32 m0, s68, 110592
  s_nop 0
  buffer_load_dwordx4 v37, s[60:63], s101 offen lds
  v_readlane_b32 s101, v38, 19
  s_bitcmp1_b32 s100, 31
  s_cselect_b32 s60, s24, s22
  s_cselect_b32 s61, s25, s23
  s_bitset0_b32 s100, 31
  s_add_u32 m0, s68, 114688
  s_nop 0
  buffer_load_dwordx4 v36, s[60:63], s100 offen lds
  s_add_u32 m0, s68, 118784
  s_nop 0
  buffer_load_dwordx4 v37, s[60:63], s100 offen lds
  v_readlane_b32 s100, v38, 20
  s_bitcmp1_b32 s101, 31
  s_cselect_b32 s60, s24, s22
  s_cselect_b32 s61, s25, s23
  s_bitset0_b32 s101, 31
  s_add_u32 m0, s68, 122880
  s_nop 0
  buffer_load_dwordx4 v36, s[60:63], s101 offen lds
  s_add_u32 m0, s68, 126976
  s_nop 0
  buffer_load_dwordx4 v37, s[60:63], s101 offen lds
  s_lshr_b32 s72, s4, 1
  s_mul_i32 s72, s72, 4
  s_add_u32 s72, s72, s7
  s_mul_i32 s73, s72, 90112
  v_lshlrev_b32 v8, 4, v1
  v_add_u32 v8, s73, v8
  v_add_u32 v9, 90112, v8
  v_add_u32 v10, 180224, v8
L_pad14:
  s_cbranch_execz L_pad62
  v_add_u32 v11, 270336, v8
  s_lshl_b32 s72, s72, 4
  v_and_b32 v4, 15, v1
  v_add_u32 v6, s72, v4
  v_lshlrev_b32 v12, 3, v6
  v_add_u32 v12, 15728640, v12
  v_mul_u32_u24 v3, 1280, v6
  v_lshl_add_u32 v3, v5, 4, v3
  s_lshl_b32 s72, s80, 7
  s_and_b32 s73, s4, 1
  s_lshl_b32 s74, s73, 6
  s_add_u32 s72, s72, s74
  v_add_u32 v3, s72, v3
  s_mov_b32 s44, s36
  s_mov_b32 s45, s37
  s_mov_b32 s46, 2621440
  s_mov_b32 s47, 0x20000
  v_bfe_u32 v6, v1, 1, 3
  v_xor_b32 v6, v6, v5
  v_lshlrev_b32 v6, 4, v6
  v_lshl_add_u32 v208, v4, 7, v6
  v_xor_b32 v208, s74, v208
  v_add_u32 v209, 65536, v208
  v_add_u32 v210, 131072, v208
  v_lshrrev_b32 v6, 2, v1
  v_lshlrev_b32 v212, 7, v6
  v_bfe_u32 v6, v1, 3, 2
  v_lshl_add_u32 v212, v6, 5, v212
  v_and_b32 v6, 3, v1
  v_lshl_add_u32 v212, v6, 3, v212
  s_lshl_b32 s74, s73, 12
  v_add_u32 v212, s74, v212
  v_xor_b32 v213, 32, v212
  v_xor_b32 v214, 64, v212
  v_xor_b32 v215, 96, v212
  v_add_u32 v216, 65536, v212
  v_add_u32 v217, 65536, v213
  v_add_u32 v218, 65536, v214
L_pad15:
  s_cbranch_execz L_pad63
  v_add_u32 v219, 65536, v215
  v_add_u32 v220, 131072, v212
  v_add_u32 v221, 131072, v213
  v_add_u32 v222, 131072, v214
  v_add_u32 v223, 131072, v215
  s_and_b32 s74, s80, 3
  s_lshr_b32 s75, s7, 3
  s_mul_i32 s75, s75, 4
  s_add_u32 s75, s75, s4
  s_lshl_b32 s75, s75, 7
  s_add_u32 s75, s75, 15745024
  v_min_u32 v6, 9, v4
  v_lshl_add_u32 v20, v6, 3, s75
  s_lshr_b32 s75, s7, 4
  s_add_u32 s75, s75, 16
  s_mul_i32 s75, s75, 4
  s_add_u32 s75, s75, s4
  s_lshl_b32 s75, s75, 7
  s_add_u32 s75, s75, 15745024
  v_min_u32 v6, 11, v1
  v_lshl_add_u32 v21, v6, 3, s75
  s_and_b32 s73, s4, 1
  s_lshl_b32 s74, s73, 6
  s_lshl_b32 s75, s73, 13
  v_xor_b32 v224, s74, v210
  v_add_u32 v224, s75, v224
  v_xor_b32 v225, 64, v224
  buffer_load_dwordx2 v[18:19], v20, s[56:59], 0 offen sc1
  ds_read_b128 v[168:171], v224 offset:0
  ds_read_b128 v[172:175], v224 offset:2048
  ds_read_b128 v[176:179], v224 offset:4096
  ds_read_b128 v[180:183], v224 offset:6144
  ds_read_b128 v[184:187], v225 offset:0
  ds_read_b128 v[188:191], v225 offset:2048
  ds_read_b128 v[192:195], v225 offset:4096
  ds_read_b128 v[196:199], v225 offset:6144
  v_readlane_b32 s69, v39, 2
  s_waitcnt lgkmcnt(4)
  v_mfma_f32_16x16x32_bf16 v[40:43], v[168:171], v[104:107], 0
  v_mfma_f32_16x16x32_bf16 v[44:47], v[172:175], v[104:107], 0
L_pad16:
  s_cbranch_execz L_pad64
  v_mfma_f32_16x16x32_bf16 v[48:51], v[176:179], v[104:107], 0
  v_mfma_f32_16x16x32_bf16 v[52:55], v[180:183], v[104:107], 0
  v_mfma_f32_16x16x32_bf16 v[56:59], v[168:171], v[112:115], 0
  v_mfma_f32_16x16x32_bf16 v[60:63], v[172:175], v[112:115], 0
  v_mfma_f32_16x16x32_bf16 v[64:67], v[176:179], v[112:115], 0
  v_mfma_f32_16x16x32_bf16 v[68:71], v[180:183], v[112:115], 0
  v_mfma_f32_16x16x32_bf16 v[72:75], v[168:171], v[120:123], 0
  v_mfma_f32_16x16x32_bf16 v[76:79], v[172:175], v[120:123], 0
  v_mfma_f32_16x16x32_bf16 v[80:83], v[176:179], v[120:123], 0
  v_mfma_f32_16x16x32_bf16 v[84:87], v[180:183], v[120:123], 0
  v_mfma_f32_16x16x32_bf16 v[88:91], v[168:171], v[128:131], 0
  v_mfma_f32_16x16x32_bf16 v[92:95], v[172:175], v[128:131], 0
  v_mfma_f32_16x16x32_bf16 v[96:99], v[176:179], v[128:131], 0
  v_mfma_f32_16x16x32_bf16 v[100:103], v[180:183], v[128:131], 0
  s_waitcnt vmcnt(0)
  s_mov_b32 s83, 100000
  s_branch L_paq_chk
L_paq:
  buffer_load_dwordx2 v[18:19], v20, s[56:59], 0 offen sc1
  s_waitcnt vmcnt(0)
L_paq_chk:
  v_cmp_ne_u64 vcc, v[18:19], v[16:17]
  s_nop 4
  s_cbranch_vccz L_paq_done
  s_sub_u32 s83, s83, 1
  s_cmp_eq_u32 s83, 0
  s_cbranch_scc1 L_paq_done
  s_sleep 6
  s_branch L_paq
L_paq_done:
  v_readlane_b32 s70, v39, 3
  buffer_load_dwordx4 a[32:35], v8, s[56:59], s69 offen sc1
  buffer_load_dwordx4 a[36:39], v9, s[56:59], s69 offen sc1
  buffer_load_dwordx4 a[40:43], v10, s[56:59], s69 offen sc1
  buffer_load_dwordx4 a[44:47], v11, s[56:59], s69 offen sc1
  s_nop 2
  v_readlane_b32 s69, v39, 4
  buffer_load_dwordx4 a[48:51], v8, s[56:59], s70 offen sc1
  buffer_load_dwordx4 a[52:55], v9, s[56:59], s70 offen sc1
  buffer_load_dwordx4 a[56:59], v10, s[56:59], s70 offen sc1
L_pad17:
  s_cbranch_execz L_pad65
  buffer_load_dwordx4 a[60:63], v11, s[56:59], s70 offen sc1
  s_nop 2
  v_readlane_b32 s70, v39, 5
  buffer_load_dwordx4 a[64:67], v8, s[56:59], s69 offen sc1
  buffer_load_dwordx4 a[68:71], v9, s[56:59], s69 offen sc1
  buffer_load_dwordx4 a[72:75], v10, s[56:59], s69 offen sc1
  buffer_load_dwordx4 a[76:79], v11, s[56:59], s69 offen sc1
  s_nop 2
  v_readlane_b32 s69, v39, 6
  buffer_load_dwordx4 a[0:3], v8, s[56:59], s70 offen sc1
  buffer_load_dwordx4 a[4:7], v9, s[56:59], s70 offen sc1
  buffer_load_dwordx4 a[8:11], v10, s[56:59], s70 offen sc1
  buffer_load_dwordx4 a[12:15], v11, s[56:59], s70 offen sc1
  s_nop 2
  s_waitcnt lgkmcnt(0)
  ds_read_b128 v[168:171], v210 offset:16384
  v_mfma_f32_16x16x32_bf16 v[40:43], v[184:187], v[108:111], v[40:43]
  v_mfma_f32_16x16x32_bf16 v[44:47], v[188:191], v[108:111], v[44:47]
  ds_read_b128 v[172:175], v210 offset:18432
  v_mfma_f32_16x16x32_bf16 v[48:51], v[192:195], v[108:111], v[48:51]
  v_mfma_f32_16x16x32_bf16 v[52:55], v[196:199], v[108:111], v[52:55]
  ds_read_b128 v[176:179], v210 offset:20480
  v_mfma_f32_16x16x32_bf16 v[56:59], v[184:187], v[116:119], v[56:59]
  v_mfma_f32_16x16x32_bf16 v[60:63], v[188:191], v[116:119], v[60:63]
  ds_read_b128 v[180:183], v210 offset:22528
  v_mfma_f32_16x16x32_bf16 v[64:67], v[192:195], v[116:119], v[64:67]
  v_mfma_f32_16x16x32_bf16 v[68:71], v[196:199], v[116:119], v[68:71]
  v_mfma_f32_16x16x32_bf16 v[72:75], v[184:187], v[124:127], v[72:75]
  v_mfma_f32_16x16x32_bf16 v[76:79], v[188:191], v[124:127], v[76:79]
  v_mfma_f32_16x16x32_bf16 v[80:83], v[192:195], v[124:127], v[80:83]
  v_mfma_f32_16x16x32_bf16 v[84:87], v[196:199], v[124:127], v[84:87]
  v_mfma_f32_16x16x32_bf16 v[88:91], v[184:187], v[132:135], v[88:91]
  v_mfma_f32_16x16x32_bf16 v[92:95], v[188:191], v[132:135], v[92:95]
  v_mfma_f32_16x16x32_bf16 v[96:99], v[192:195], v[132:135], v[96:99]
L_pad18:
  s_cbranch_execz L_pad66
  v_mfma_f32_16x16x32_bf16 v[100:103], v[196:199], v[132:135], v[100:103]
  s_waitcnt vmcnt(12) lgkmcnt(0)
  ds_read_b128 v[184:187], v210 offset:24576
  v_readlane_b32 s70, v39, 7
  v_mfma_f32_16x16x32_bf16 v[40:43], v[168:171], a[32:35], v[40:43]
  v_mfma_f32_16x16x32_bf16 v[44:47], v[172:175], a[32:35], v[44:47]
  v_mfma_f32_16x16x32_bf16 v[48:51], v[176:179], a[32:35], v[48:51]
  ds_read_b128 v[188:191], v210 offset:26624
  buffer_load_dwordx4 a[16:19], v8, s[56:59], s69 offen sc1
  v_mfma_f32_16x16x32_bf16 v[52:55], v[180:183], a[32:35], v[52:55]
  v_mfma_f32_16x16x32_bf16 v[56:59], v[168:171], a[36:39], v[56:59]
  v_mfma_f32_16x16x32_bf16 v[60:63], v[172:175], a[36:39], v[60:63]
  ds_read_b128 v[192:195], v210 offset:28672
  buffer_load_dwordx4 a[20:23], v9, s[56:59], s69 offen sc1
  v_mfma_f32_16x16x32_bf16 v[64:67], v[176:179], a[36:39], v[64:67]
  v_mfma_f32_16x16x32_bf16 v[68:71], v[180:183], a[36:39], v[68:71]
  v_mfma_f32_16x16x32_bf16 v[72:75], v[168:171], a[40:43], v[72:75]
  ds_read_b128 v[196:199], v210 offset:30720
  buffer_load_dwordx4 a[24:27], v10, s[56:59], s69 offen sc1
  v_mfma_f32_16x16x32_bf16 v[76:79], v[172:175], a[40:43], v[76:79]
  v_mfma_f32_16x16x32_bf16 v[80:83], v[176:179], a[40:43], v[80:83]
  v_mfma_f32_16x16x32_bf16 v[84:87], v[180:183], a[40:43], v[84:87]
  buffer_load_dwordx4 a[28:31], v11, s[56:59], s69 offen sc1
  v_mfma_f32_16x16x32_bf16 v[88:91], v[168:171], a[44:47], v[88:91]
  v_mfma_f32_16x16x32_bf16 v[92:95], v[172:175], a[44:47], v[92:95]
  v_mfma_f32_16x16x32_bf16 v[96:99], v[176:179], a[44:47], v[96:99]
  v_mfma_f32_16x16x32_bf16 v[100:103], v[180:183], a[44:47], v[100:103]
  s_waitcnt vmcnt(12) lgkmcnt(0)
  ds_read_b128 v[168:171], v208 offset:0
  v_readlane_b32 s69, v39, 8
  v_mfma_f32_16x16x32_bf16 v[40:43], v[184:187], a[48:51], v[40:43]
  v_mfma_f32_16x16x32_bf16 v[44:47], v[188:191], a[48:51], v[44:47]
  v_mfma_f32_16x16x32_bf16 v[48:51], v[192:195], a[48:51], v[48:51]
L_pad19:
  s_cbranch_execz L_pad67
  ds_read_b128 v[172:175], v208 offset:2048
  buffer_load_dwordx4 a[32:35], v8, s[56:59], s70 offen sc1
  v_mfma_f32_16x16x32_bf16 v[52:55], v[196:199], a[48:51], v[52:55]
  v_mfma_f32_16x16x32_bf16 v[56:59], v[184:187], a[52:55], v[56:59]
  v_mfma_f32_16x16x32_bf16 v[60:63], v[188:191], a[52:55], v[60:63]
  ds_read_b128 v[176:179], v208 offset:4096
  buffer_load_dwordx4 a[36:39], v9, s[56:59], s70 offen sc1
  v_mfma_f32_16x16x32_bf16 v[64:67], v[192:195], a[52:55], v[64:67]
  v_mfma_f32_16x16x32_bf16 v[68:71], v[196:199], a[52:55], v[68:71]
  v_mfma_f32_16x16x32_bf16 v[72:75], v[184:187], a[56:59], v[72:75]
  ds_read_b128 v[180:183], v208 offset:6144
  buffer_load_dwordx4 a[40:43], v10, s[56:59], s70 offen sc1
  v_mfma_f32_16x16x32_bf16 v[76:79], v[188:191], a[56:59], v[76:79]
  v_mfma_f32_16x16x32_bf16 v[80:83], v[192:195], a[56:59], v[80:83]
  v_mfma_f32_16x16x32_bf16 v[84:87], v[196:199], a[56:59], v[84:87]
  buffer_load_dwordx4 a[44:47], v11, s[56:59], s70 offen sc1
  v_mfma_f32_16x16x32_bf16 v[88:91], v[184:187], a[60:63], v[88:91]
  v_mfma_f32_16x16x32_bf16 v[92:95], v[188:191], a[60:63], v[92:95]
  v_mfma_f32_16x16x32_bf16 v[96:99], v[192:195], a[60:63], v[96:99]
  v_mfma_f32_16x16x32_bf16 v[100:103], v[196:199], a[60:63], v[100:103]
  s_waitcnt vmcnt(12) lgkmcnt(0)
  s_barrier
  ds_read_b128 v[184:187], v208 offset:8192
  v_readlane_b32 s70, v39, 9
  v_mfma_f32_16x16x32_bf16 v[40:43], v[168:171], a[64:67], v[40:43]
  v_mfma_f32_16x16x32_bf16 v[44:47], v[172:175], a[64:67], v[44:47]
  v_mfma_f32_16x16x32_bf16 v[48:51], v[176:179], a[64:67], v[48:51]
  ds_read_b128 v[188:191], v208 offset:10240
  buffer_load_dwordx4 a[48:51], v8, s[56:59], s69 offen sc1
  v_mfma_f32_16x16x32_bf16 v[52:55], v[180:183], a[64:67], v[52:55]
  v_mfma_f32_16x16x32_bf16 v[56:59], v[168:171], a[68:71], v[56:59]
  v_mfma_f32_16x16x32_bf16 v[60:63], v[172:175], a[68:71], v[60:63]
  ds_read_b128 v[192:195], v208 offset:12288
L_pad20:
  s_cbranch_execz L_pad68
  buffer_load_dwordx4 a[52:55], v9, s[56:59], s69 offen sc1
  v_mfma_f32_16x16x32_bf16 v[64:67], v[176:179], a[68:71], v[64:67]
  v_mfma_f32_16x16x32_bf16 v[68:71], v[180:183], a[68:71], v[68:71]
  v_mfma_f32_16x16x32_bf16 v[72:75], v[168:171], a[72:75], v[72:75]
  ds_read_b128 v[196:199], v208 offset:14336
  buffer_load_dwordx4 a[56:59], v10, s[56:59], s69 offen sc1
  v_mfma_f32_16x16x32_bf16 v[76:79], v[172:175], a[72:75], v[76:79]
  v_mfma_f32_16x16x32_bf16 v[80:83], v[176:179], a[72:75], v[80:83]
  v_mfma_f32_16x16x32_bf16 v[84:87], v[180:183], a[72:75], v[84:87]
  buffer_load_dwordx4 a[60:63], v11, s[56:59], s69 offen sc1
  v_mfma_f32_16x16x32_bf16 v[88:91], v[168:171], a[76:79], v[88:91]
  v_mfma_f32_16x16x32_bf16 v[92:95], v[172:175], a[76:79], v[92:95]
  v_mfma_f32_16x16x32_bf16 v[96:99], v[176:179], a[76:79], v[96:99]
  v_mfma_f32_16x16x32_bf16 v[100:103], v[180:183], a[76:79], v[100:103]
  s_waitcnt vmcnt(12) lgkmcnt(0)
  ds_read_b128 v[168:171], v208 offset:16384
  v_readlane_b32 s69, v39, 10
  v_mfma_f32_16x16x32_bf16 v[40:43], v[184:187], a[0:3], v[40:43]
  v_mfma_f32_16x16x32_bf16 v[44:47], v[188:191], a[0:3], v[44:47]
  v_mfma_f32_16x16x32_bf16 v[48:51], v[192:195], a[0:3], v[48:51]
  ds_read_b128 v[172:175], v208 offset:18432
  buffer_load_dwordx4 a[64:67], v8, s[56:59], s70 offen sc1
  v_mfma_f32_16x16x32_bf16 v[52:55], v[196:199], a[0:3], v[52:55]
  v_mfma_f32_16x16x32_bf16 v[56:59], v[184:187], a[4:7], v[56:59]
  v_mfma_f32_16x16x32_bf16 v[60:63], v[188:191], a[4:7], v[60:63]
  ds_read_b128 v[176:179], v208 offset:20480
  buffer_load_dwordx4 a[68:71], v9, s[56:59], s70 offen sc1
  v_mfma_f32_16x16x32_bf16 v[64:67], v[192:195], a[4:7], v[64:67]
  v_mfma_f32_16x16x32_bf16 v[68:71], v[196:199], a[4:7], v[68:71]
  v_mfma_f32_16x16x32_bf16 v[72:75], v[184:187], a[8:11], v[72:75]
  ds_read_b128 v[180:183], v208 offset:22528
  buffer_load_dwordx4 a[72:75], v10, s[56:59], s70 offen sc1
L_pad21:
  s_cbranch_execz L_pad69
  v_mfma_f32_16x16x32_bf16 v[76:79], v[188:191], a[8:11], v[76:79]
  v_mfma_f32_16x16x32_bf16 v[80:83], v[192:195], a[8:11], v[80:83]
  v_mfma_f32_16x16x32_bf16 v[84:87], v[196:199], a[8:11], v[84:87]
  buffer_load_dwordx4 a[76:79], v11, s[56:59], s70 offen sc1
  v_mfma_f32_16x16x32_bf16 v[88:91], v[184:187], a[12:15], v[88:91]
  v_mfma_f32_16x16x32_bf16 v[92:95], v[188:191], a[12:15], v[92:95]
  v_mfma_f32_16x16x32_bf16 v[96:99], v[192:195], a[12:15], v[96:99]
  v_mfma_f32_16x16x32_bf16 v[100:103], v[196:199], a[12:15], v[100:103]
  s_waitcnt vmcnt(12) lgkmcnt(0)
  ds_read_b128 v[184:187], v208 offset:24576
  v_readlane_b32 s70, v39, 11
  v_mfma_f32_16x16x32_bf16 v[40:43], v[168:171], a[16:19], v[40:43]
  v_mfma_f32_16x16x32_bf16 v[44:47], v[172:175], a[16:19], v[44:47]
  v_mfma_f32_16x16x32_bf16 v[48:51], v[176:179], a[16:19], v[48:51]
  ds_read_b128 v[188:191], v208 offset:26624
  buffer_load_dwordx4 a[0:3], v8, s[56:59], s69 offen sc1
  v_mfma_f32_16x16x32_bf16 v[52:55], v[180:183], a[16:19], v[52:55]
  v_mfma_f32_16x16x32_bf16 v[56:59], v[168:171], a[20:23], v[56:59]
  v_mfma_f32_16x16x32_bf16 v[60:63], v[172:175], a[20:23], v[60:63]
  ds_read_b128 v[192:195], v208 offset:28672
  buffer_load_dwordx4 a[4:7], v9, s[56:59], s69 offen sc1
  v_mfma_f32_16x16x32_bf16 v[64:67], v[176:179], a[20:23], v[64:67]
  v_mfma_f32_16x16x32_bf16 v[68:71], v[180:183], a[20:23], v[68:71]
  v_mfma_f32_16x16x32_bf16 v[72:75], v[168:171], a[24:27], v[72:75]
  ds_read_b128 v[196:199], v208 offset:30720
  buffer_load_dwordx4 a[8:11], v10, s[56:59], s69 offen sc1
  v_mfma_f32_16x16x32_bf16 v[76:79], v[172:175], a[24:27], v[76:79]
  v_mfma_f32_16x16x32_bf16 v[80:83], v[176:179], a[24:27], v[80:83]
  v_mfma_f32_16x16x32_bf16 v[84:87], v[180:183], a[24:27], v[84:87]
  buffer_load_dwordx4 a[12:15], v11, s[56:59], s69 offen sc1
  v_mfma_f32_16x16x32_bf16 v[88:91], v[168:171], a[28:31], v[88:91]
  v_mfma_f32_16x16x32_bf16 v[92:95], v[172:175], a[28:31], v[92:95]
L_pad22:
  s_cbranch_execz L_pad70
  v_mfma_f32_16x16x32_bf16 v[96:99], v[176:179], a[28:31], v[96:99]
  v_mfma_f32_16x16x32_bf16 v[100:103], v[180:183], a[28:31], v[100:103]
  s_waitcnt vmcnt(12) lgkmcnt(0)
  ds_read_b128 v[168:171], v208 offset:32768
  v_readlane_b32 s69, v39, 12
  v_mfma_f32_16x16x32_bf16 v[40:43], v[184:187], a[32:35], v[40:43]
  v_mfma_f32_16x16x32_bf16 v[44:47], v[188:191], a[32:35], v[44:47]
  v_mfma_f32_16x16x32_bf16 v[48:51], v[192:195], a[32:35], v[48:51]
  ds_read_b128 v[172:175], v208 offset:34816
  buffer_load_dwordx4 a[16:19], v8, s[56:59], s70 offen sc1
  v_mfma_f32_16x16x32_bf16 v[52:55], v[196:199], a[32:35], v[52:55]
  v_mfma_f32_16x16x32_bf16 v[56:59], v[184:187], a[36:39], v[56:59]
  v_mfma_f32_16x16x32_bf16 v[60:63], v[188:191], a[36:39], v[60:63]
  ds_read_b128 v[176:179], v208 offset:36864
  buffer_load_dwordx4 a[20:23], v9, s[56:59], s70 offen sc1
  v_mfma_f32_16x16x32_bf16 v[64:67], v[192:195], a[36:39], v[64:67]
  v_mfma_f32_16x16x32_bf16 v[68:71], v[196:199], a[36:39], v[68:71]
  v_mfma_f32_16x16x32_bf16 v[72:75], v[184:187], a[40:43], v[72:75]
  ds_read_b128 v[180:183], v208 offset:38912
  buffer_load_dwordx4 a[24:27], v10, s[56:59], s70 offen sc1
  v_mfma_f32_16x16x32_bf16 v[76:79], v[188:191], a[40:43], v[76:79]
  v_mfma_f32_16x16x32_bf16 v[80:83], v[192:195], a[40:43], v[80:83]
  v_mfma_f32_16x16x32_bf16 v[84:87], v[196:199], a[40:43], v[84:87]
  buffer_load_dwordx4 a[28:31], v11, s[56:59], s70 offen sc1
  v_mfma_f32_16x16x32_bf16 v[88:91], v[184:187], a[44:47], v[88:91]
  v_mfma_f32_16x16x32_bf16 v[92:95], v[188:191], a[44:47], v[92:95]
  v_mfma_f32_16x16x32_bf16 v[96:99], v[192:195], a[44:47], v[96:99]
  v_mfma_f32_16x16x32_bf16 v[100:103], v[196:199], a[44:47], v[100:103]
  s_waitcnt vmcnt(12) lgkmcnt(0)
  s_barrier
  ds_read_b128 v[184:187], v208 offset:40960
  v_readlane_b32 s70, v39, 13
  v_mfma_f32_16x16x32_bf16 v[40:43], v[168:171], a[48:51], v[40:43]
L_pad23:
  s_cbranch_execz L_pad71
  v_mfma_f32_16x16x32_bf16 v[44:47], v[172:175], a[48:51], v[44:47]
  v_mfma_f32_16x16x32_bf16 v[48:51], v[176:179], a[48:51], v[48:51]
  ds_read_b128 v[188:191], v208 offset:43008
  buffer_load_dwordx4 a[32:35], v8, s[56:59], s69 offen sc1
  v_mfma_f32_16x16x32_bf16 v[52:55], v[180:183], a[48:51], v[52:55]
  v_mfma_f32_16x16x32_bf16 v[56:59], v[168:171], a[52:55], v[56:59]
  v_mfma_f32_16x16x32_bf16 v[60:63], v[172:175], a[52:55], v[60:63]
  ds_read_b128 v[192:195], v208 offset:45056
  buffer_load_dwordx4 a[36:39], v9, s[56:59], s69 offen sc1
  v_mfma_f32_16x16x32_bf16 v[64:67], v[176:179], a[52:55], v[64:67]
  v_mfma_f32_16x16x32_bf16 v[68:71], v[180:183], a[52:55], v[68:71]
  v_mfma_f32_16x16x32_bf16 v[72:75], v[168:171], a[56:59], v[72:75]
  ds_read_b128 v[196:199], v208 offset:47104
  buffer_load_dwordx4 a[40:43], v10, s[56:59], s69 offen sc1
  v_mfma_f32_16x16x32_bf16 v[76:79], v[172:175], a[56:59], v[76:79]
  v_mfma_f32_16x16x32_bf16 v[80:83], v[176:179], a[56:59], v[80:83]
  v_mfma_f32_16x16x32_bf16 v[84:87], v[180:183], a[56:59], v[84:87]
  buffer_load_dwordx4 a[44:47], v11, s[56:59], s69 offen sc1
  v_mfma_f32_16x16x32_bf16 v[88:91], v[168:171], a[60:63], v[88:91]
  v_mfma_f32_16x16x32_bf16 v[92:95], v[172:175], a[60:63], v[92:95]
  v_mfma_f32_16x16x32_bf16 v[96:99], v[176:179], a[60:63], v[96:99]
  v_mfma_f32_16x16x32_bf16 v[100:103], v[180:183], a[60:63], v[100:103]
  s_waitcnt vmcnt(12) lgkmcnt(0)
  ds_read_b128 v[168:171], v208 offset:49152
  v_readlane_b32 s69, v39, 14
  v_mfma_f32_16x16x32_bf16 v[40:43], v[184:187], a[64:67], v[40:43]
  v_mfma_f32_16x16x32_bf16 v[44:47], v[188:191], a[64:67], v[44:47]
  v_mfma_f32_16x16x32_bf16 v[48:51], v[192:195], a[64:67], v[48:51]
  ds_read_b128 v[172:175], v208 offset:51200
  buffer_load_dwordx4 a[48:51], v8, s[56:59], s70 offen sc1
  v_mfma_f32_16x16x32_bf16 v[52:55], v[196:199], a[64:67], v[52:55]
  v_mfma_f32_16x16x32_bf16 v[56:59], v[184:187], a[68:71], v[56:59]
L_pad24:
  s_cbranch_execz L_pad72
  v_mfma_f32_16x16x32_bf16 v[60:63], v[188:191], a[68:71], v[60:63]
  ds_read_b128 v[176:179], v208 offset:53248
  buffer_load_dwordx4 a[52:55], v9, s[56:59], s70 offen sc1
  v_mfma_f32_16x16x32_bf16 v[64:67], v[192:195], a[68:71], v[64:67]
  v_mfma_f32_16x16x32_bf16 v[68:71], v[196:199], a[68:71], v[68:71]
  v_mfma_f32_16x16x32_bf16 v[72:75], v[184:187], a[72:75], v[72:75]
  ds_read_b128 v[180:183], v208 offset:55296
  buffer_load_dwordx4 a[56:59], v10, s[56:59], s70 offen sc1
  v_mfma_f32_16x16x32_bf16 v[76:79], v[188:191], a[72:75], v[76:79]
  v_mfma_f32_16x16x32_bf16 v[80:83], v[192:195], a[72:75], v[80:83]
  v_mfma_f32_16x16x32_bf16 v[84:87], v[196:199], a[72:75], v[84:87]
  buffer_load_dwordx4 a[60:63], v11, s[56:59], s70 offen sc1
  v_mfma_f32_16x16x32_bf16 v[88:91], v[184:187], a[76:79], v[88:91]
  v_mfma_f32_16x16x32_bf16 v[92:95], v[188:191], a[76:79], v[92:95]
  v_mfma_f32_16x16x32_bf16 v[96:99], v[192:195], a[76:79], v[96:99]
  v_mfma_f32_16x16x32_bf16 v[100:103], v[196:199], a[76:79], v[100:103]
  s_waitcnt vmcnt(12) lgkmcnt(0)
  ds_read_b128 v[184:187], v208 offset:57344
  v_readlane_b32 s70, v39, 15
  v_mfma_f32_16x16x32_bf16 v[40:43], v[168:171], a[0:3], v[40:43]
  v_mfma_f32_16x16x32_bf16 v[44:47], v[172:175], a[0:3], v[44:47]
  v_mfma_f32_16x16x32_bf16 v[48:51], v[176:179], a[0:3], v[48:51]
  ds_read_b128 v[188:191], v208 offset:59392
  buffer_load_dwordx4 a[64:67], v8, s[56:59], s69 offen sc1
  v_mfma_f32_16x16x32_bf16 v[52:55], v[180:183], a[0:3], v[52:55]
  v_mfma_f32_16x16x32_bf16 v[56:59], v[168:171], a[4:7], v[56:59]
  v_mfma_f32_16x16x32_bf16 v[60:63], v[172:175], a[4:7], v[60:63]
  ds_read_b128 v[192:195], v208 offset:61440
  buffer_load_dwordx4 a[68:71], v9, s[56:59], s69 offen sc1
  v_mfma_f32_16x16x32_bf16 v[64:67], v[176:179], a[4:7], v[64:67]
  v_mfma_f32_16x16x32_bf16 v[68:71], v[180:183], a[4:7], v[68:71]
  v_mfma_f32_16x16x32_bf16 v[72:75], v[168:171], a[8:11], v[72:75]
L_pad25:
  s_cbranch_execz L_pad73
  ds_read_b128 v[196:199], v208 offset:63488
  buffer_load_dwordx4 a[72:75], v10, s[56:59], s69 offen sc1
  v_mfma_f32_16x16x32_bf16 v[76:79], v[172:175], a[8:11], v[76:79]
  v_mfma_f32_16x16x32_bf16 v[80:83], v[176:179], a[8:11], v[80:83]
  v_mfma_f32_16x16x32_bf16 v[84:87], v[180:183], a[8:11], v[84:87]
  buffer_load_dwordx4 a[76:79], v11, s[56:59], s69 offen sc1
  v_mfma_f32_16x16x32_bf16 v[88:91], v[168:171], a[12:15], v[88:91]
  v_mfma_f32_16x16x32_bf16 v[92:95], v[172:175], a[12:15], v[92:95]
  v_mfma_f32_16x16x32_bf16 v[96:99], v[176:179], a[12:15], v[96:99]
  v_mfma_f32_16x16x32_bf16 v[100:103], v[180:183], a[12:15], v[100:103]
  s_waitcnt vmcnt(12) lgkmcnt(0)
  ds_read_b128 v[168:171], v209 offset:0
  v_readlane_b32 s69, v39, 16
  v_mfma_f32_16x16x32_bf16 v[40:43], v[184:187], a[16:19], v[40:43]
  v_mfma_f32_16x16x32_bf16 v[44:47], v[188:191], a[16:19], v[44:47]
  v_mfma_f32_16x16x32_bf16 v[48:51], v[192:195], a[16:19], v[48:51]
  ds_read_b128 v[172:175], v209 offset:2048
  buffer_load_dwordx4 a[0:3], v8, s[56:59], s70 offen sc1
  v_mfma_f32_16x16x32_bf16 v[52:55], v[196:199], a[16:19], v[52:55]
  v_mfma_f32_16x16x32_bf16 v[56:59], v[184:187], a[20:23], v[56:59]
  v_mfma_f32_16x16x32_bf16 v[60:63], v[188:191], a[20:23], v[60:63]
  ds_read_b128 v[176:179], v209 offset:4096
  buffer_load_dwordx4 a[4:7], v9, s[56:59], s70 offen sc1
  v_mfma_f32_16x16x32_bf16 v[64:67], v[192:195], a[20:23], v[64:67]
  v_mfma_f32_16x16x32_bf16 v[68:71], v[196:199], a[20:23], v[68:71]
  v_mfma_f32_16x16x32_bf16 v[72:75], v[184:187], a[24:27], v[72:75]
  ds_read_b128 v[180:183], v209 offset:6144
  buffer_load_dwordx4 a[8:11], v10, s[56:59], s70 offen sc1
  v_mfma_f32_16x16x32_bf16 v[76:79], v[188:191], a[24:27], v[76:79]
  v_mfma_f32_16x16x32_bf16 v[80:83], v[192:195], a[24:27], v[80:83]
  v_mfma_f32_16x16x32_bf16 v[84:87], v[196:199], a[24:27], v[84:87]
  buffer_load_dwordx4 a[12:15], v11, s[56:59], s70 offen sc1
L_pad26:
  s_cbranch_execz L_pad74
  v_mfma_f32_16x16x32_bf16 v[88:91], v[184:187], a[28:31], v[88:91]
  v_mfma_f32_16x16x32_bf16 v[92:95], v[188:191], a[28:31], v[92:95]
  v_mfma_f32_16x16x32_bf16 v[96:99], v[192:195], a[28:31], v[96:99]
  v_mfma_f32_16x16x32_bf16 v[100:103], v[196:199], a[28:31], v[100:103]
  s_waitcnt vmcnt(12) lgkmcnt(0)
  s_barrier
  ds_read_b128 v[184:187], v209 offset:8192
  v_readlane_b32 s70, v39, 17
  v_mfma_f32_16x16x32_bf16 v[40:43], v[168:171], a[32:35], v[40:43]
  v_mfma_f32_16x16x32_bf16 v[44:47], v[172:175], a[32:35], v[44:47]
  v_mfma_f32_16x16x32_bf16 v[48:51], v[176:179], a[32:35], v[48:51]
  ds_read_b128 v[188:191], v209 offset:10240
  buffer_load_dwordx4 a[16:19], v8, s[56:59], s69 offen sc1
  v_mfma_f32_16x16x32_bf16 v[52:55], v[180:183], a[32:35], v[52:55]
  v_mfma_f32_16x16x32_bf16 v[56:59], v[168:171], a[36:39], v[56:59]
  v_mfma_f32_16x16x32_bf16 v[60:63], v[172:175], a[36:39], v[60:63]
  ds_read_b128 v[192:195], v209 offset:12288
  buffer_load_dwordx4 a[20:23], v9, s[56:59], s69 offen sc1
  v_mfma_f32_16x16x32_bf16 v[64:67], v[176:179], a[36:39], v[64:67]
  v_mfma_f32_16x16x32_bf16 v[68:71], v[180:183], a[36:39], v[68:71]
  v_mfma_f32_16x16x32_bf16 v[72:75], v[168:171], a[40:43], v[72:75]
  ds_read_b128 v[196:199], v209 offset:14336
  buffer_load_dwordx4 a[24:27], v10, s[56:59], s69 offen sc1
  v_mfma_f32_16x16x32_bf16 v[76:79], v[172:175], a[40:43], v[76:79]
  v_mfma_f32_16x16x32_bf16 v[80:83], v[176:179], a[40:43], v[80:83]
  v_mfma_f32_16x16x32_bf16 v[84:87], v[180:183], a[40:43], v[84:87]
  buffer_load_dwordx4 a[28:31], v11, s[56:59], s69 offen sc1
  v_mfma_f32_16x16x32_bf16 v[88:91], v[168:171], a[44:47], v[88:91]
  v_mfma_f32_16x16x32_bf16 v[92:95], v[172:175], a[44:47], v[92:95]
  v_mfma_f32_16x16x32_bf16 v[96:99], v[176:179], a[44:47], v[96:99]
  v_mfma_f32_16x16x32_bf16 v[100:103], v[180:183], a[44:47], v[100:103]
  s_waitcnt vmcnt(12) lgkmcnt(0)
  ds_read_b128 v[168:171], v209 offset:16384
L_pad27:
  s_cbranch_execz L_pad75
  buffer_load_dwordx2 v[18:19], v21, s[56:59], 0 offen sc1
  v_readlane_b32 s69, v39, 18
  v_mfma_f32_16x16x32_bf16 v[40:43], v[184:187], a[48:51], v[40:43]
  buffer_load_dwordx4 a[32:35], v8, s[56:59], s70 offen sc1
  v_mfma_f32_16x16x32_bf16 v[44:47], v[188:191], a[48:51], v[44:47]
  buffer_load_dwordx4 a[36:39], v9, s[56:59], s70 offen sc1
  buffer_load_dwordx4 a[40:43], v10, s[56:59], s70 offen sc1
  v_mfma_f32_16x16x32_bf16 v[48:51], v[192:195], a[48:51], v[48:51]
  ds_read_b128 v[172:175], v209 offset:18432
  buffer_load_dwordx4 a[44:47], v11, s[56:59], s70 offen sc1
  v_mfma_f32_16x16x32_bf16 v[52:55], v[196:199], a[48:51], v[52:55]
  v_readlane_b32 s101, v38, 21
  s_add_u32 m0, s68, 131072
  v_mfma_f32_16x16x32_bf16 v[56:59], v[184:187], a[52:55], v[56:59]
  buffer_load_dwordx4 v26, s[48:51], s100 offen lds
  v_mfma_f32_16x16x32_bf16 v[60:63], v[188:191], a[52:55], v[60:63]
  ds_read_b128 v[176:179], v209 offset:20480
  s_add_u32 m0, s68, 135168
  s_nop 0
  buffer_load_dwordx4 v27, s[48:51], s100 offen lds
  v_mfma_f32_16x16x32_bf16 v[64:67], v[192:195], a[52:55], v[64:67]
  s_nop 0
  v_mfma_f32_16x16x32_bf16 v[68:71], v[196:199], a[52:55], v[68:71]
  v_readlane_b32 s100, v38, 22
  s_add_u32 m0, s68, 139264
  v_mfma_f32_16x16x32_bf16 v[72:75], v[184:187], a[56:59], v[72:75]
  ds_read_b128 v[180:183], v209 offset:22528
  buffer_load_dwordx4 v26, s[48:51], s101 offen lds
  v_mfma_f32_16x16x32_bf16 v[76:79], v[188:191], a[56:59], v[76:79]
  s_add_u32 m0, s68, 143360
  s_nop 0
  buffer_load_dwordx4 v27, s[48:51], s101 offen lds
  v_mfma_f32_16x16x32_bf16 v[80:83], v[192:195], a[56:59], v[80:83]
  s_nop 0
  v_mfma_f32_16x16x32_bf16 v[84:87], v[196:199], a[56:59], v[84:87]
L_pad28:
  s_cbranch_execz L_pad76
  v_readlane_b32 s101, v38, 23
  s_add_u32 m0, s68, 147456
  v_mfma_f32_16x16x32_bf16 v[88:91], v[184:187], a[60:63], v[88:91]
  buffer_load_dwordx4 v26, s[48:51], s100 offen lds
  v_mfma_f32_16x16x32_bf16 v[92:95], v[188:191], a[60:63], v[92:95]
  s_add_u32 m0, s68, 151552
  s_nop 0
  buffer_load_dwordx4 v27, s[48:51], s100 offen lds
  v_mfma_f32_16x16x32_bf16 v[96:99], v[192:195], a[60:63], v[96:99]
  s_nop 0
  v_mfma_f32_16x16x32_bf16 v[100:103], v[196:199], a[60:63], v[100:103]
  s_waitcnt vmcnt(19) lgkmcnt(0)
  ds_read_b128 v[184:187], v209 offset:24576
  v_readlane_b32 s70, v39, 19
  buffer_load_dwordx4 a[48:51], v8, s[56:59], s69 offen sc1
  v_mfma_f32_16x16x32_bf16 v[40:43], v[168:171], a[64:67], v[40:43]
  buffer_load_dwordx4 a[52:55], v9, s[56:59], s69 offen sc1
  v_mfma_f32_16x16x32_bf16 v[44:47], v[172:175], a[64:67], v[44:47]
  buffer_load_dwordx4 a[56:59], v10, s[56:59], s69 offen sc1
  buffer_load_dwordx4 a[60:63], v11, s[56:59], s69 offen sc1
  v_mfma_f32_16x16x32_bf16 v[48:51], v[176:179], a[64:67], v[48:51]
  ds_read_b128 v[188:191], v209 offset:26624
  v_readlane_b32 s100, v38, 24
  v_mfma_f32_16x16x32_bf16 v[52:55], v[180:183], a[64:67], v[52:55]
  s_add_u32 m0, s68, 155648
  s_nop 0
  buffer_load_dwordx4 v26, s[48:51], s101 offen lds
  v_mfma_f32_16x16x32_bf16 v[56:59], v[168:171], a[68:71], v[56:59]
  s_add_u32 m0, s68, 159744
  v_mfma_f32_16x16x32_bf16 v[60:63], v[172:175], a[68:71], v[60:63]
  ds_read_b128 v[192:195], v209 offset:28672
  buffer_load_dwordx4 v27, s[48:51], s101 offen lds
  s_nop 0
  v_mfma_f32_16x16x32_bf16 v[64:67], v[176:179], a[68:71], v[64:67]
  v_readlane_b32 s101, v38, 25
L_pad29:
  s_cbranch_execz L_pad77
  v_mfma_f32_16x16x32_bf16 v[68:71], v[180:183], a[68:71], v[68:71]
  s_add_u32 m0, s68, 0
  v_mfma_f32_16x16x32_bf16 v[72:75], v[168:171], a[72:75], v[72:75]
  ds_read_b128 v[196:199], v209 offset:30720
  buffer_load_dwordx4 v26, s[48:51], s100 offen lds
  s_add_u32 m0, s68, 4096
  v_mfma_f32_16x16x32_bf16 v[76:79], v[172:175], a[72:75], v[76:79]
  buffer_load_dwordx4 v27, s[48:51], s100 offen lds
  v_mfma_f32_16x16x32_bf16 v[80:83], v[176:179], a[72:75], v[80:83]
  s_nop 0
  v_readlane_b32 s100, v38, 26
  v_mfma_f32_16x16x32_bf16 v[84:87], v[180:183], a[72:75], v[84:87]
  s_add_u32 m0, s68, 8192
  v_mfma_f32_16x16x32_bf16 v[88:91], v[168:171], a[76:79], v[88:91]
  buffer_load_dwordx4 v26, s[48:51], s101 offen lds
  s_add_u32 m0, s68, 12288
  v_mfma_f32_16x16x32_bf16 v[92:95], v[172:175], a[76:79], v[92:95]
  buffer_load_dwordx4 v27, s[48:51], s101 offen lds
  v_mfma_f32_16x16x32_bf16 v[96:99], v[176:179], a[76:79], v[96:99]
  s_nop 0
  v_mfma_f32_16x16x32_bf16 v[100:103], v[180:183], a[76:79], v[100:103]
  s_waitcnt vmcnt(25) lgkmcnt(0)
  ds_read_b128 v[168:171], v209 offset:32768
  v_readlane_b32 s69, v39, 20
  buffer_load_dwordx4 a[64:67], v8, s[56:59], s70 offen sc1
  v_mfma_f32_16x16x32_bf16 v[40:43], v[184:187], a[0:3], v[40:43]
  buffer_load_dwordx4 a[68:71], v9, s[56:59], s70 offen sc1
  v_mfma_f32_16x16x32_bf16 v[44:47], v[188:191], a[0:3], v[44:47]
  buffer_load_dwordx4 a[72:75], v10, s[56:59], s70 offen sc1
  buffer_load_dwordx4 a[76:79], v11, s[56:59], s70 offen sc1
  v_mfma_f32_16x16x32_bf16 v[48:51], v[192:195], a[0:3], v[48:51]
  ds_read_b128 v[172:175], v209 offset:34816
  v_readlane_b32 s101, v38, 27
  v_mfma_f32_16x16x32_bf16 v[52:55], v[196:199], a[0:3], v[52:55]
L_pad30:
  s_cbranch_execz L_pad78
  s_add_u32 m0, s68, 16384
  s_nop 0
  buffer_load_dwordx4 v26, s[48:51], s100 offen lds
  v_mfma_f32_16x16x32_bf16 v[56:59], v[184:187], a[4:7], v[56:59]
  s_add_u32 m0, s68, 20480
  v_mfma_f32_16x16x32_bf16 v[60:63], v[188:191], a[4:7], v[60:63]
  ds_read_b128 v[176:179], v209 offset:36864
  buffer_load_dwordx4 v27, s[48:51], s100 offen lds
  s_nop 0
  v_mfma_f32_16x16x32_bf16 v[64:67], v[192:195], a[4:7], v[64:67]
  v_readlane_b32 s100, v38, 28
  v_mfma_f32_16x16x32_bf16 v[68:71], v[196:199], a[4:7], v[68:71]
  s_add_u32 m0, s68, 24576
  v_mfma_f32_16x16x32_bf16 v[72:75], v[184:187], a[8:11], v[72:75]
  ds_read_b128 v[180:183], v209 offset:38912
  buffer_load_dwordx4 v26, s[48:51], s101 offen lds
  s_add_u32 m0, s68, 28672
  v_mfma_f32_16x16x32_bf16 v[76:79], v[188:191], a[8:11], v[76:79]
  buffer_load_dwordx4 v27, s[48:51], s101 offen lds
  v_mfma_f32_16x16x32_bf16 v[80:83], v[192:195], a[8:11], v[80:83]
  s_nop 0
  v_readlane_b32 s101, v38, 29
  v_mfma_f32_16x16x32_bf16 v[84:87], v[196:199], a[8:11], v[84:87]
  s_add_u32 m0, s68, 32768
  v_mfma_f32_16x16x32_bf16 v[88:91], v[184:187], a[12:15], v[88:91]
  buffer_load_dwordx4 v26, s[48:51], s100 offen lds
  s_add_u32 m0, s68, 36864
  v_mfma_f32_16x16x32_bf16 v[92:95], v[188:191], a[12:15], v[92:95]
  buffer_load_dwordx4 v27, s[48:51], s100 offen lds
  v_mfma_f32_16x16x32_bf16 v[96:99], v[192:195], a[12:15], v[96:99]
  s_nop 0
  v_mfma_f32_16x16x32_bf16 v[100:103], v[196:199], a[12:15], v[100:103]
  s_waitcnt vmcnt(24) lgkmcnt(0)
  s_barrier
  s_mov_b32 s83, 100000
L_pad31:
  s_cbranch_execz L_pad79
  s_branch L_pbq_chk
L_pbq:
  buffer_load_dwordx2 v[18:19], v21, s[56:59], 0 offen sc1
  s_waitcnt vmcnt(0)
L_pbq_chk:
  v_cmp_ne_u64 vcc, v[18:19], v[16:17]
  s_nop 4
  s_cbranch_vccz L_pbq_done
  s_sub_u32 s83, s83, 1
  s_cmp_eq_u32 s83, 0
  s_cbranch_scc1 L_pbq_done
  s_sleep 6
  s_branch L_pbq
L_pbq_done:
  ds_read_b128 v[184:187], v209 offset:40960
  v_readlane_b32 s70, v39, 21
  buffer_load_dwordx2 v[200:201], v12, s[56:59], 0 offen offset:0 sc1
  v_mfma_f32_16x16x32_bf16 v[40:43], v[168:171], a[16:19], v[40:43]
  buffer_load_dwordx2 v[202:203], v12, s[56:59], 0 offen offset:128 sc1
  buffer_load_dwordx2 v[204:205], v12, s[56:59], 0 offen offset:256 sc1
  v_mfma_f32_16x16x32_bf16 v[44:47], v[172:175], a[16:19], v[44:47]
  buffer_load_dwordx2 v[206:207], v12, s[56:59], 0 offen offset:384 sc1
  buffer_load_dwordx4 a[0:3], v8, s[56:59], s69 offen sc1
  v_mfma_f32_16x16x32_bf16 v[48:51], v[176:179], a[16:19], v[48:51]
  ds_read_b128 v[188:191], v209 offset:43008
  buffer_load_dwordx4 a[4:7], v9, s[56:59], s69 offen sc1
  v_mfma_f32_16x16x32_bf16 v[52:55], v[180:183], a[16:19], v[52:55]
  buffer_load_dwordx4 a[8:11], v10, s[56:59], s69 offen sc1
  buffer_load_dwordx4 a[12:15], v11, s[56:59], s69 offen sc1
  v_mfma_f32_16x16x32_bf16 v[56:59], v[168:171], a[20:23], v[56:59]
  v_readlane_b32 s100, v38, 30
  s_add_u32 m0, s68, 40960
  v_mfma_f32_16x16x32_bf16 v[60:63], v[172:175], a[20:23], v[60:63]
  ds_read_b128 v[192:195], v209 offset:45056
  buffer_load_dwordx4 v26, s[48:51], s101 offen lds
  v_mfma_f32_16x16x32_bf16 v[64:67], v[176:179], a[20:23], v[64:67]
  s_add_u32 m0, s68, 45056
  s_nop 0
  buffer_load_dwordx4 v27, s[48:51], s101 offen lds
  v_mfma_f32_16x16x32_bf16 v[68:71], v[180:183], a[20:23], v[68:71]
L_pad32:
  s_cbranch_execz L_pad80
  s_nop 0
  v_readlane_b32 s101, v38, 31
  v_mfma_f32_16x16x32_bf16 v[72:75], v[168:171], a[24:27], v[72:75]
  ds_read_b128 v[196:199], v209 offset:47104
  s_add_u32 m0, s68, 49152
  v_mfma_f32_16x16x32_bf16 v[76:79], v[172:175], a[24:27], v[76:79]
  buffer_load_dwordx4 v26, s[48:51], s100 offen lds
  s_add_u32 m0, s68, 53248
  v_mfma_f32_16x16x32_bf16 v[80:83], v[176:179], a[24:27], v[80:83]
  buffer_load_dwordx4 v27, s[48:51], s100 offen lds
  s_nop 0
  v_mfma_f32_16x16x32_bf16 v[84:87], v[180:183], a[24:27], v[84:87]
  v_readlane_b32 s100, v38, 32
  v_mfma_f32_16x16x32_bf16 v[88:91], v[168:171], a[28:31], v[88:91]
  s_add_u32 m0, s68, 57344
  s_nop 0
  buffer_load_dwordx4 v26, s[48:51], s101 offen lds
  v_mfma_f32_16x16x32_bf16 v[92:95], v[172:175], a[28:31], v[92:95]
  s_add_u32 m0, s68, 61440
  s_nop 0
  buffer_load_dwordx4 v27, s[48:51], s101 offen lds
  v_mfma_f32_16x16x32_bf16 v[96:99], v[176:179], a[28:31], v[96:99]
  s_nop 0
  v_mfma_f32_16x16x32_bf16 v[100:103], v[180:183], a[28:31], v[100:103]
  s_waitcnt vmcnt(40) lgkmcnt(0)
  ds_read_b128 v[168:171], v209 offset:49152
  v_readlane_b32 s69, v39, 22
  buffer_load_dwordx4 a[16:19], v8, s[56:59], s70 offen sc1
  v_mfma_f32_16x16x32_bf16 v[40:43], v[184:187], a[32:35], v[40:43]
  buffer_load_dwordx4 a[20:23], v9, s[56:59], s70 offen sc1
  v_mfma_f32_16x16x32_bf16 v[44:47], v[188:191], a[32:35], v[44:47]
  buffer_load_dwordx4 a[24:27], v10, s[56:59], s70 offen sc1
  buffer_load_dwordx4 a[28:31], v11, s[56:59], s70 offen sc1
  v_mfma_f32_16x16x32_bf16 v[48:51], v[192:195], a[32:35], v[48:51]
  ds_read_b128 v[172:175], v209 offset:51200
  v_readlane_b32 s101, v38, 33
L_pad33:
  s_cbranch_execz L_pad81
  v_mfma_f32_16x16x32_bf16 v[52:55], v[196:199], a[32:35], v[52:55]
  s_add_u32 m0, s68, 65536
  s_nop 0
  buffer_load_dwordx4 v26, s[48:51], s100 offen lds
  v_mfma_f32_16x16x32_bf16 v[56:59], v[184:187], a[36:39], v[56:59]
  s_add_u32 m0, s68, 69632
  v_mfma_f32_16x16x32_bf16 v[60:63], v[188:191], a[36:39], v[60:63]
  ds_read_b128 v[176:179], v209 offset:53248
  buffer_load_dwordx4 v27, s[48:51], s100 offen lds
  s_nop 0
  v_mfma_f32_16x16x32_bf16 v[64:67], v[192:195], a[36:39], v[64:67]
  v_readlane_b32 s100, v38, 34
  v_mfma_f32_16x16x32_bf16 v[68:71], v[196:199], a[36:39], v[68:71]
  s_add_u32 m0, s68, 73728
  v_mfma_f32_16x16x32_bf16 v[72:75], v[184:187], a[40:43], v[72:75]
  ds_read_b128 v[180:183], v209 offset:55296
  buffer_load_dwordx4 v26, s[48:51], s101 offen lds
  s_add_u32 m0, s68, 77824
  v_mfma_f32_16x16x32_bf16 v[76:79], v[188:191], a[40:43], v[76:79]
  buffer_load_dwordx4 v27, s[48:51], s101 offen lds
  v_mfma_f32_16x16x32_bf16 v[80:83], v[192:195], a[40:43], v[80:83]
  s_nop 0
  v_readlane_b32 s101, v38, 35
  v_mfma_f32_16x16x32_bf16 v[84:87], v[196:199], a[40:43], v[84:87]
  s_add_u32 m0, s68, 81920
  v_mfma_f32_16x16x32_bf16 v[88:91], v[184:187], a[44:47], v[88:91]
  buffer_load_dwordx4 v26, s[48:51], s100 offen lds
  s_add_u32 m0, s68, 86016
  v_mfma_f32_16x16x32_bf16 v[92:95], v[188:191], a[44:47], v[92:95]
  buffer_load_dwordx4 v27, s[48:51], s100 offen lds
  v_mfma_f32_16x16x32_bf16 v[96:99], v[192:195], a[44:47], v[96:99]
  s_nop 0
  v_mfma_f32_16x16x32_bf16 v[100:103], v[196:199], a[44:47], v[100:103]
  s_waitcnt vmcnt(40) lgkmcnt(0)
  ds_read_b128 v[184:187], v209 offset:57344
L_pad34:
  s_cbranch_execz L_pad82
  v_readlane_b32 s70, v39, 23
  v_mfma_f32_16x16x32_bf16 v[40:43], v[168:171], a[48:51], v[40:43]
  buffer_load_dwordx4 a[32:35], v8, s[56:59], s69 offen sc1
  v_mfma_f32_16x16x32_bf16 v[44:47], v[172:175], a[48:51], v[44:47]
  buffer_load_dwordx4 a[36:39], v9, s[56:59], s69 offen sc1
  v_mfma_f32_16x16x32_bf16 v[48:51], v[176:179], a[48:51], v[48:51]
  ds_read_b128 v[188:191], v209 offset:59392
  v_mfma_f32_16x16x32_bf16 v[52:55], v[180:183], a[48:51], v[52:55]
  buffer_load_dwordx4 a[40:43], v10, s[56:59], s69 offen sc1
  v_mfma_f32_16x16x32_bf16 v[56:59], v[168:171], a[52:55], v[56:59]
  buffer_load_dwordx4 a[44:47], v11, s[56:59], s69 offen sc1
  v_mfma_f32_16x16x32_bf16 v[60:63], v[172:175], a[52:55], v[60:63]
  ds_read_b128 v[192:195], v209 offset:61440
  v_mfma_f32_16x16x32_bf16 v[64:67], v[176:179], a[52:55], v[64:67]
  v_readlane_b32 s100, v38, 36
  v_mfma_f32_16x16x32_bf16 v[68:71], v[180:183], a[52:55], v[68:71]
  s_add_u32 m0, s68, 90112
  v_mfma_f32_16x16x32_bf16 v[72:75], v[168:171], a[56:59], v[72:75]
  ds_read_b128 v[196:199], v209 offset:63488
  v_mfma_f32_16x16x32_bf16 v[76:79], v[172:175], a[56:59], v[76:79]
  buffer_load_dwordx4 v26, s[48:51], s101 offen lds
  v_mfma_f32_16x16x32_bf16 v[80:83], v[176:179], a[56:59], v[80:83]
  s_add_u32 m0, s68, 94208
  v_mfma_f32_16x16x32_bf16 v[84:87], v[180:183], a[56:59], v[84:87]
  v_mfma_f32_16x16x32_bf16 v[88:91], v[168:171], a[60:63], v[88:91]
  buffer_load_dwordx4 v27, s[48:51], s101 offen lds
  v_mfma_f32_16x16x32_bf16 v[92:95], v[172:175], a[60:63], v[92:95]
  s_nop 0
  v_mfma_f32_16x16x32_bf16 v[96:99], v[176:179], a[60:63], v[96:99]
  v_mfma_f32_16x16x32_bf16 v[100:103], v[180:183], a[60:63], v[100:103]
  s_waitcnt vmcnt(36) lgkmcnt(0)
  ds_read_b64_tr_b16 v[168:169], v220 offset:0
  v_readlane_b32 s69, v39, 24
L_pad35:
  s_cbranch_execz L_pad83
  v_mfma_f32_16x16x32_bf16 v[40:43], v[184:187], a[64:67], v[40:43]
  ds_read_b64_tr_b16 v[170:171], v220 offset:2048
  v_mfma_f32_16x16x32_bf16 v[44:47], v[188:191], a[64:67], v[44:47]
  v_mfma_f32_16x16x32_bf16 v[48:51], v[192:195], a[64:67], v[48:51]
  ds_read_b64_tr_b16 v[172:173], v221 offset:0
  buffer_load_dwordx4 a[48:51], v8, s[56:59], s70 offen sc1
  v_mfma_f32_16x16x32_bf16 v[52:55], v[196:199], a[64:67], v[52:55]
  ds_read_b64_tr_b16 v[174:175], v221 offset:2048
  v_mfma_f32_16x16x32_bf16 v[56:59], v[184:187], a[68:71], v[56:59]
  v_mfma_f32_16x16x32_bf16 v[60:63], v[188:191], a[68:71], v[60:63]
  ds_read_b64_tr_b16 v[176:177], v222 offset:0
  buffer_load_dwordx4 a[52:55], v9, s[56:59], s70 offen sc1
  v_mfma_f32_16x16x32_bf16 v[64:67], v[192:195], a[68:71], v[64:67]
  v_mfma_f32_16x16x32_bf16 v[68:71], v[196:199], a[68:71], v[68:71]
  ds_read_b64_tr_b16 v[178:179], v222 offset:2048
  v_mfma_f32_16x16x32_bf16 v[72:75], v[184:187], a[72:75], v[72:75]
  ds_read_b64_tr_b16 v[180:181], v223 offset:0
  buffer_load_dwordx4 a[56:59], v10, s[56:59], s70 offen sc1
  v_mfma_f32_16x16x32_bf16 v[76:79], v[188:191], a[72:75], v[76:79]
  v_mfma_f32_16x16x32_bf16 v[80:83], v[192:195], a[72:75], v[80:83]
  ds_read_b64_tr_b16 v[182:183], v223 offset:2048
  v_mfma_f32_16x16x32_bf16 v[84:87], v[196:199], a[72:75], v[84:87]
  buffer_load_dwordx4 a[60:63], v11, s[56:59], s70 offen sc1
  v_mfma_f32_16x16x32_bf16 v[88:91], v[184:187], a[76:79], v[88:91]
  v_mfma_f32_16x16x32_bf16 v[92:95], v[188:191], a[76:79], v[92:95]
  v_mfma_f32_16x16x32_bf16 v[96:99], v[192:195], a[76:79], v[96:99]
  v_mfma_f32_16x16x32_bf16 v[100:103], v[196:199], a[76:79], v[100:103]
  s_waitcnt vmcnt(26) lgkmcnt(0)
  s_barrier
  ds_read_b64_tr_b16 v[184:185], v220 offset:8192
  v_readlane_b32 s70, v39, 25
  buffer_load_dwordx4 a[64:67], v8, s[56:59], s69 offen sc1
  v_mfma_f32_16x16x32_bf16 v[104:107], v[168:171], a[0:3], 0
L_pad36:
  s_cbranch_execz L_pad84
  ds_read_b64_tr_b16 v[186:187], v220 offset:10240
  buffer_load_dwordx4 a[68:71], v9, s[56:59], s69 offen sc1
  v_mfma_f32_16x16x32_bf16 v[108:111], v[172:175], a[0:3], 0
  buffer_load_dwordx4 a[72:75], v10, s[56:59], s69 offen sc1
  buffer_load_dwordx4 a[76:79], v11, s[56:59], s69 offen sc1
  v_mfma_f32_16x16x32_bf16 v[112:115], v[176:179], a[0:3], 0
  ds_read_b64_tr_b16 v[188:189], v221 offset:8192
  v_readlane_b32 s101, v38, 37
  v_mfma_f32_16x16x32_bf16 v[116:119], v[180:183], a[0:3], 0
  ds_read_b64_tr_b16 v[190:191], v221 offset:10240
  s_add_u32 m0, s68, 98304
  s_nop 0
  buffer_load_dwordx4 v26, s[48:51], s100 offen lds
  v_mfma_f32_16x16x32_bf16 v[120:123], v[168:171], a[4:7], 0
  s_add_u32 m0, s68, 102400
  v_mfma_f32_16x16x32_bf16 v[124:127], v[172:175], a[4:7], 0
  ds_read_b64_tr_b16 v[192:193], v222 offset:8192
  buffer_load_dwordx4 v27, s[48:51], s100 offen lds
  s_nop 0
  v_mfma_f32_16x16x32_bf16 v[128:131], v[176:179], a[4:7], 0
  v_readlane_b32 s100, v38, 38
  v_mfma_f32_16x16x32_bf16 v[132:135], v[180:183], a[4:7], 0
  ds_read_b64_tr_b16 v[194:195], v222 offset:10240
  s_add_u32 m0, s68, 106496
  v_mfma_f32_16x16x32_bf16 v[136:139], v[168:171], a[8:11], 0
  ds_read_b64_tr_b16 v[196:197], v223 offset:8192
  buffer_load_dwordx4 v26, s[48:51], s101 offen lds
  s_add_u32 m0, s68, 110592
  v_mfma_f32_16x16x32_bf16 v[140:143], v[172:175], a[8:11], 0
  buffer_load_dwordx4 v27, s[48:51], s101 offen lds
  v_mfma_f32_16x16x32_bf16 v[144:147], v[176:179], a[8:11], 0
  ds_read_b64_tr_b16 v[198:199], v223 offset:10240
  s_nop 0
  v_readlane_b32 s101, v38, 39
L_pad37:
  s_cbranch_execz L_pad85
  v_mfma_f32_16x16x32_bf16 v[148:151], v[180:183], a[8:11], 0
  s_add_u32 m0, s68, 114688
  v_mfma_f32_16x16x32_bf16 v[152:155], v[168:171], a[12:15], 0
  buffer_load_dwordx4 v26, s[48:51], s100 offen lds
  s_add_u32 m0, s68, 118784
  v_mfma_f32_16x16x32_bf16 v[156:159], v[172:175], a[12:15], 0
  buffer_load_dwordx4 v27, s[48:51], s100 offen lds
  v_mfma_f32_16x16x32_bf16 v[160:163], v[176:179], a[12:15], 0
  s_nop 0
  v_mfma_f32_16x16x32_bf16 v[164:167], v[180:183], a[12:15], 0
  s_waitcnt vmcnt(26) lgkmcnt(0)
  ds_read_b64_tr_b16 v[168:169], v220 offset:16384
  v_readlane_b32 s69, v39, 26
  v_mfma_f32_16x16x32_bf16 v[104:107], v[184:187], a[16:19], v[104:107]
  ds_read_b64_tr_b16 v[170:171], v220 offset:18432
  buffer_load_dwordx4 a[0:3], v8, s[56:59], s70 offen sc1
  v_mfma_f32_16x16x32_bf16 v[108:111], v[188:191], a[16:19], v[108:111]
  buffer_load_dwordx4 a[4:7], v9, s[56:59], s70 offen sc1
  v_mfma_f32_16x16x32_bf16 v[112:115], v[192:195], a[16:19], v[112:115]
  ds_read_b64_tr_b16 v[172:173], v221 offset:16384
  v_mfma_f32_16x16x32_bf16 v[116:119], v[196:199], a[16:19], v[116:119]
  ds_read_b64_tr_b16 v[174:175], v221 offset:18432
  buffer_load_dwordx4 a[8:11], v10, s[56:59], s70 offen sc1
  v_mfma_f32_16x16x32_bf16 v[120:123], v[184:187], a[20:23], v[120:123]
  buffer_load_dwordx4 a[12:15], v11, s[56:59], s70 offen sc1
  v_mfma_f32_16x16x32_bf16 v[124:127], v[188:191], a[20:23], v[124:127]
  ds_read_b64_tr_b16 v[176:177], v222 offset:16384
  v_mfma_f32_16x16x32_bf16 v[128:131], v[192:195], a[20:23], v[128:131]
  v_readlane_b32 s100, v38, 40
  v_mfma_f32_16x16x32_bf16 v[132:135], v[196:199], a[20:23], v[132:135]
  ds_read_b64_tr_b16 v[178:179], v222 offset:18432
  s_add_u32 m0, s68, 122880
  v_mfma_f32_16x16x32_bf16 v[136:139], v[184:187], a[24:27], v[136:139]
L_pad38:
  s_cbranch_execz L_pad86
  ds_read_b64_tr_b16 v[180:181], v223 offset:16384
  v_mfma_f32_16x16x32_bf16 v[140:143], v[188:191], a[24:27], v[140:143]
  buffer_load_dwordx4 v26, s[48:51], s101 offen lds
  v_mfma_f32_16x16x32_bf16 v[144:147], v[192:195], a[24:27], v[144:147]
  ds_read_b64_tr_b16 v[182:183], v223 offset:18432
  s_add_u32 m0, s68, 126976
  v_mfma_f32_16x16x32_bf16 v[148:151], v[196:199], a[24:27], v[148:151]
  v_mfma_f32_16x16x32_bf16 v[152:155], v[184:187], a[28:31], v[152:155]
  buffer_load_dwordx4 v27, s[48:51], s101 offen lds
  v_mfma_f32_16x16x32_bf16 v[156:159], v[188:191], a[28:31], v[156:159]
  s_nop 0
  v_mfma_f32_16x16x32_bf16 v[160:163], v[192:195], a[28:31], v[160:163]
  v_mfma_f32_16x16x32_bf16 v[164:167], v[196:199], a[28:31], v[164:167]
  s_waitcnt vmcnt(22) lgkmcnt(0)
  ds_read_b64_tr_b16 v[184:185], v220 offset:24576
  v_readlane_b32 s70, v39, 27
  v_mfma_f32_16x16x32_bf16 v[104:107], v[168:171], a[32:35], v[104:107]
  ds_read_b64_tr_b16 v[186:187], v220 offset:26624
  v_mfma_f32_16x16x32_bf16 v[108:111], v[172:175], a[32:35], v[108:111]
  v_mfma_f32_16x16x32_bf16 v[112:115], v[176:179], a[32:35], v[112:115]
  ds_read_b64_tr_b16 v[188:189], v221 offset:24576
  buffer_load_dwordx4 a[16:19], v8, s[56:59], s69 offen sc1
  v_mfma_f32_16x16x32_bf16 v[116:119], v[180:183], a[32:35], v[116:119]
  ds_read_b64_tr_b16 v[190:191], v221 offset:26624
  v_mfma_f32_16x16x32_bf16 v[120:123], v[168:171], a[36:39], v[120:123]
  v_mfma_f32_16x16x32_bf16 v[124:127], v[172:175], a[36:39], v[124:127]
  ds_read_b64_tr_b16 v[192:193], v222 offset:24576
  buffer_load_dwordx4 a[20:23], v9, s[56:59], s69 offen sc1
  v_mfma_f32_16x16x32_bf16 v[128:131], v[176:179], a[36:39], v[128:131]
  v_mfma_f32_16x16x32_bf16 v[132:135], v[180:183], a[36:39], v[132:135]
  ds_read_b64_tr_b16 v[194:195], v222 offset:26624
  v_mfma_f32_16x16x32_bf16 v[136:139], v[168:171], a[40:43], v[136:139]
  ds_read_b64_tr_b16 v[196:197], v223 offset:24576
L_pad39:
  s_cbranch_execz L_pad87
  buffer_load_dwordx4 a[24:27], v10, s[56:59], s69 offen sc1
  v_mfma_f32_16x16x32_bf16 v[140:143], v[172:175], a[40:43], v[140:143]
  v_mfma_f32_16x16x32_bf16 v[144:147], v[176:179], a[40:43], v[144:147]
  ds_read_b64_tr_b16 v[198:199], v223 offset:26624
  v_mfma_f32_16x16x32_bf16 v[148:151], v[180:183], a[40:43], v[148:151]
  buffer_load_dwordx4 a[28:31], v11, s[56:59], s69 offen sc1
  v_mfma_f32_16x16x32_bf16 v[152:155], v[168:171], a[44:47], v[152:155]
  v_mfma_f32_16x16x32_bf16 v[156:159], v[172:175], a[44:47], v[156:159]
  v_mfma_f32_16x16x32_bf16 v[160:163], v[176:179], a[44:47], v[160:163]
  v_mfma_f32_16x16x32_bf16 v[164:167], v[180:183], a[44:47], v[164:167]
  s_waitcnt vmcnt(20) lgkmcnt(0)
  ds_read_b64_tr_b16 v[168:169], v212 offset:0
  v_readlane_b32 s69, v39, 28
  v_mfma_f32_16x16x32_bf16 v[104:107], v[184:187], a[48:51], v[104:107]
  ds_read_b64_tr_b16 v[170:171], v212 offset:2048
  v_mfma_f32_16x16x32_bf16 v[108:111], v[188:191], a[48:51], v[108:111]
  v_mfma_f32_16x16x32_bf16 v[112:115], v[192:195], a[48:51], v[112:115]
  ds_read_b64_tr_b16 v[172:173], v213 offset:0
  buffer_load_dwordx4 a[32:35], v8, s[56:59], s70 offen sc1
  v_mfma_f32_16x16x32_bf16 v[116:119], v[196:199], a[48:51], v[116:119]
  ds_read_b64_tr_b16 v[174:175], v213 offset:2048
  v_mfma_f32_16x16x32_bf16 v[120:123], v[184:187], a[52:55], v[120:123]
  v_mfma_f32_16x16x32_bf16 v[124:127], v[188:191], a[52:55], v[124:127]
  ds_read_b64_tr_b16 v[176:177], v214 offset:0
  buffer_load_dwordx4 a[36:39], v9, s[56:59], s70 offen sc1
  v_mfma_f32_16x16x32_bf16 v[128:131], v[192:195], a[52:55], v[128:131]
  v_mfma_f32_16x16x32_bf16 v[132:135], v[196:199], a[52:55], v[132:135]
  ds_read_b64_tr_b16 v[178:179], v214 offset:2048
  v_mfma_f32_16x16x32_bf16 v[136:139], v[184:187], a[56:59], v[136:139]
  ds_read_b64_tr_b16 v[180:181], v215 offset:0
  buffer_load_dwordx4 a[40:43], v10, s[56:59], s70 offen sc1
  v_mfma_f32_16x16x32_bf16 v[140:143], v[188:191], a[56:59], v[140:143]
L_pad40:
  s_cbranch_execz L_pad88
  v_mfma_f32_16x16x32_bf16 v[144:147], v[192:195], a[56:59], v[144:147]
  ds_read_b64_tr_b16 v[182:183], v215 offset:2048
  v_mfma_f32_16x16x32_bf16 v[148:151], v[196:199], a[56:59], v[148:151]
  buffer_load_dwordx4 a[44:47], v11, s[56:59], s70 offen sc1
  v_mfma_f32_16x16x32_bf16 v[152:155], v[184:187], a[60:63], v[152:155]
  v_mfma_f32_16x16x32_bf16 v[156:159], v[188:191], a[60:63], v[156:159]
  v_mfma_f32_16x16x32_bf16 v[160:163], v[192:195], a[60:63], v[160:163]
  v_mfma_f32_16x16x32_bf16 v[164:167], v[196:199], a[60:63], v[164:167]
  s_waitcnt vmcnt(20) lgkmcnt(0)
  s_barrier
  ds_read_b64_tr_b16 v[184:185], v212 offset:8192
  v_readlane_b32 s70, v39, 29
  buffer_load_dwordx4 a[48:51], v8, s[56:59], s69 offen sc1
  v_mfma_f32_16x16x32_bf16 v[104:107], v[168:171], a[64:67], v[104:107]
  ds_read_b64_tr_b16 v[186:187], v212 offset:10240
  buffer_load_dwordx4 a[52:55], v9, s[56:59], s69 offen sc1
  v_mfma_f32_16x16x32_bf16 v[108:111], v[172:175], a[64:67], v[108:111]
  buffer_load_dwordx4 a[56:59], v10, s[56:59], s69 offen sc1
  buffer_load_dwordx4 a[60:63], v11, s[56:59], s69 offen sc1
  v_mfma_f32_16x16x32_bf16 v[112:115], v[176:179], a[64:67], v[112:115]
  ds_read_b64_tr_b16 v[188:189], v213 offset:8192
  v_readlane_b32 s101, v38, 41
  v_mfma_f32_16x16x32_bf16 v[116:119], v[180:183], a[64:67], v[116:119]
  ds_read_b64_tr_b16 v[190:191], v213 offset:10240
  s_add_u32 m0, s68, 131072
  s_nop 0
  buffer_load_dwordx4 v26, s[48:51], s100 offen lds
  v_mfma_f32_16x16x32_bf16 v[120:123], v[168:171], a[68:71], v[120:123]
  s_add_u32 m0, s68, 135168
  v_mfma_f32_16x16x32_bf16 v[124:127], v[172:175], a[68:71], v[124:127]
  ds_read_b64_tr_b16 v[192:193], v214 offset:8192
  buffer_load_dwordx4 v27, s[48:51], s100 offen lds
  s_nop 0
  v_mfma_f32_16x16x32_bf16 v[128:131], v[176:179], a[68:71], v[128:131]
L_pad41:
  s_cbranch_execz L_pad89
  v_readlane_b32 s100, v38, 42
  v_mfma_f32_16x16x32_bf16 v[132:135], v[180:183], a[68:71], v[132:135]
  ds_read_b64_tr_b16 v[194:195], v214 offset:10240
  s_add_u32 m0, s68, 139264
  v_mfma_f32_16x16x32_bf16 v[136:139], v[168:171], a[72:75], v[136:139]
  ds_read_b64_tr_b16 v[196:197], v215 offset:8192
  buffer_load_dwordx4 v26, s[48:51], s101 offen lds
  s_add_u32 m0, s68, 143360
  v_mfma_f32_16x16x32_bf16 v[140:143], v[172:175], a[72:75], v[140:143]
  buffer_load_dwordx4 v27, s[48:51], s101 offen lds
  v_mfma_f32_16x16x32_bf16 v[144:147], v[176:179], a[72:75], v[144:147]
  ds_read_b64_tr_b16 v[198:199], v215 offset:10240
  s_nop 0
  v_readlane_b32 s101, v38, 43
  v_mfma_f32_16x16x32_bf16 v[148:151], v[180:183], a[72:75], v[148:151]
  s_add_u32 m0, s68, 147456
  v_mfma_f32_16x16x32_bf16 v[152:155], v[168:171], a[76:79], v[152:155]
  buffer_load_dwordx4 v26, s[48:51], s100 offen lds
  s_add_u32 m0, s68, 151552
  v_mfma_f32_16x16x32_bf16 v[156:159], v[172:175], a[76:79], v[156:159]
  buffer_load_dwordx4 v27, s[48:51], s100 offen lds
  v_mfma_f32_16x16x32_bf16 v[160:163], v[176:179], a[76:79], v[160:163]
  s_nop 0
  v_mfma_f32_16x16x32_bf16 v[164:167], v[180:183], a[76:79], v[164:167]
  s_waitcnt vmcnt(20) lgkmcnt(0)
  ds_read_b64_tr_b16 v[168:169], v212 offset:16384
  v_readlane_b32 s69, v39, 30
  v_mfma_f32_16x16x32_bf16 v[104:107], v[184:187], a[0:3], v[104:107]
  ds_read_b64_tr_b16 v[170:171], v212 offset:18432
  buffer_load_dwordx4 a[64:67], v8, s[56:59], s70 offen sc1
  v_mfma_f32_16x16x32_bf16 v[108:111], v[188:191], a[0:3], v[108:111]
  v_mfma_f32_16x16x32_bf16 v[112:115], v[192:195], a[0:3], v[112:115]
  ds_read_b64_tr_b16 v[172:173], v213 offset:16384
L_pad42:
  s_cbranch_execz L_pad90
  buffer_load_dwordx4 a[68:71], v9, s[56:59], s70 offen sc1
  v_mfma_f32_16x16x32_bf16 v[116:119], v[196:199], a[0:3], v[116:119]
  ds_read_b64_tr_b16 v[174:175], v213 offset:18432
  buffer_load_dwordx4 a[72:75], v10, s[56:59], s70 offen sc1
  v_mfma_f32_16x16x32_bf16 v[120:123], v[184:187], a[4:7], v[120:123]
  v_mfma_f32_16x16x32_bf16 v[124:127], v[188:191], a[4:7], v[124:127]
  ds_read_b64_tr_b16 v[176:177], v214 offset:16384
  buffer_load_dwordx4 a[76:79], v11, s[56:59], s70 offen sc1
  v_mfma_f32_16x16x32_bf16 v[128:131], v[192:195], a[4:7], v[128:131]
  v_mfma_f32_16x16x32_bf16 v[132:135], v[196:199], a[4:7], v[132:135]
  ds_read_b64_tr_b16 v[178:179], v214 offset:18432
  s_add_u32 m0, s68, 155648
  v_mfma_f32_16x16x32_bf16 v[136:139], v[184:187], a[8:11], v[136:139]
  ds_read_b64_tr_b16 v[180:181], v215 offset:16384
  buffer_load_dwordx4 v26, s[48:51], s101 offen lds
  v_mfma_f32_16x16x32_bf16 v[140:143], v[188:191], a[8:11], v[140:143]
  v_mfma_f32_16x16x32_bf16 v[144:147], v[192:195], a[8:11], v[144:147]
  ds_read_b64_tr_b16 v[182:183], v215 offset:18432
  s_add_u32 m0, s68, 159744
  v_mfma_f32_16x16x32_bf16 v[148:151], v[196:199], a[8:11], v[148:151]
  buffer_load_dwordx4 v27, s[48:51], s101 offen lds
  v_mfma_f32_16x16x32_bf16 v[152:155], v[184:187], a[12:15], v[152:155]
  v_mfma_f32_16x16x32_bf16 v[156:159], v[188:191], a[12:15], v[156:159]
  s_nop 0
  v_mfma_f32_16x16x32_bf16 v[160:163], v[192:195], a[12:15], v[160:163]
  v_mfma_f32_16x16x32_bf16 v[164:167], v[196:199], a[12:15], v[164:167]
  s_waitcnt vmcnt(20) lgkmcnt(0)
  ds_read_b64_tr_b16 v[184:185], v212 offset:24576
  v_readlane_b32 s70, v39, 31
  v_mfma_f32_16x16x32_bf16 v[104:107], v[168:171], a[16:19], v[104:107]
  ds_read_b64_tr_b16 v[186:187], v212 offset:26624
  v_mfma_f32_16x16x32_bf16 v[108:111], v[172:175], a[16:19], v[108:111]
  v_mfma_f32_16x16x32_bf16 v[112:115], v[176:179], a[16:19], v[112:115]
L_pad43:
  s_cbranch_execz L_pad91
  ds_read_b64_tr_b16 v[188:189], v213 offset:24576
  buffer_load_dwordx4 a[0:3], v8, s[56:59], s69 offen sc1
  v_mfma_f32_16x16x32_bf16 v[116:119], v[180:183], a[16:19], v[116:119]
  ds_read_b64_tr_b16 v[190:191], v213 offset:26624
  v_mfma_f32_16x16x32_bf16 v[120:123], v[168:171], a[20:23], v[120:123]
  v_mfma_f32_16x16x32_bf16 v[124:127], v[172:175], a[20:23], v[124:127]
  ds_read_b64_tr_b16 v[192:193], v214 offset:24576
  buffer_load_dwordx4 a[4:7], v9, s[56:59], s69 offen sc1
  v_mfma_f32_16x16x32_bf16 v[128:131], v[176:179], a[20:23], v[128:131]
  v_mfma_f32_16x16x32_bf16 v[132:135], v[180:183], a[20:23], v[132:135]
  ds_read_b64_tr_b16 v[194:195], v214 offset:26624
  v_mfma_f32_16x16x32_bf16 v[136:139], v[168:171], a[24:27], v[136:139]
  ds_read_b64_tr_b16 v[196:197], v215 offset:24576
  buffer_load_dwordx4 a[8:11], v10, s[56:59], s69 offen sc1
  v_mfma_f32_16x16x32_bf16 v[140:143], v[172:175], a[24:27], v[140:143]
  v_mfma_f32_16x16x32_bf16 v[144:147], v[176:179], a[24:27], v[144:147]
  ds_read_b64_tr_b16 v[198:199], v215 offset:26624
  v_mfma_f32_16x16x32_bf16 v[148:151], v[180:183], a[24:27], v[148:151]
  buffer_load_dwordx4 a[12:15], v11, s[56:59], s69 offen sc1
  v_mfma_f32_16x16x32_bf16 v[152:155], v[168:171], a[28:31], v[152:155]
  v_mfma_f32_16x16x32_bf16 v[156:159], v[172:175], a[28:31], v[156:159]
  v_mfma_f32_16x16x32_bf16 v[160:163], v[176:179], a[28:31], v[160:163]
  v_mfma_f32_16x16x32_bf16 v[164:167], v[180:183], a[28:31], v[164:167]
  s_waitcnt vmcnt(20) lgkmcnt(0)
  ds_read_b64_tr_b16 v[168:169], v212 offset:32768
  v_readlane_b32 s69, v39, 32
  v_mfma_f32_16x16x32_bf16 v[104:107], v[184:187], a[32:35], v[104:107]
  ds_read_b64_tr_b16 v[170:171], v212 offset:34816
  v_mfma_f32_16x16x32_bf16 v[108:111], v[188:191], a[32:35], v[108:111]
  v_mfma_f32_16x16x32_bf16 v[112:115], v[192:195], a[32:35], v[112:115]
  ds_read_b64_tr_b16 v[172:173], v213 offset:32768
  buffer_load_dwordx4 a[16:19], v8, s[56:59], s70 offen sc1
L_pad44:
  s_cbranch_execz L_pad92
  v_mfma_f32_16x16x32_bf16 v[116:119], v[196:199], a[32:35], v[116:119]
  ds_read_b64_tr_b16 v[174:175], v213 offset:34816
  v_mfma_f32_16x16x32_bf16 v[120:123], v[184:187], a[36:39], v[120:123]
  v_mfma_f32_16x16x32_bf16 v[124:127], v[188:191], a[36:39], v[124:127]
  ds_read_b64_tr_b16 v[176:177], v214 offset:32768
  buffer_load_dwordx4 a[20:23], v9, s[56:59], s70 offen sc1
  v_mfma_f32_16x16x32_bf16 v[128:131], v[192:195], a[36:39], v[128:131]
  v_mfma_f32_16x16x32_bf16 v[132:135], v[196:199], a[36:39], v[132:135]
  ds_read_b64_tr_b16 v[178:179], v214 offset:34816
  v_mfma_f32_16x16x32_bf16 v[136:139], v[184:187], a[40:43], v[136:139]
  ds_read_b64_tr_b16 v[180:181], v215 offset:32768
  buffer_load_dwordx4 a[24:27], v10, s[56:59], s70 offen sc1
  v_mfma_f32_16x16x32_bf16 v[140:143], v[188:191], a[40:43], v[140:143]
  v_mfma_f32_16x16x32_bf16 v[144:147], v[192:195], a[40:43], v[144:147]
  ds_read_b64_tr_b16 v[182:183], v215 offset:34816
  v_mfma_f32_16x16x32_bf16 v[148:151], v[196:199], a[40:43], v[148:151]
  buffer_load_dwordx4 a[28:31], v11, s[56:59], s70 offen sc1
  v_mfma_f32_16x16x32_bf16 v[152:155], v[184:187], a[44:47], v[152:155]
  v_mfma_f32_16x16x32_bf16 v[156:159], v[188:191], a[44:47], v[156:159]
  v_mfma_f32_16x16x32_bf16 v[160:163], v[192:195], a[44:47], v[160:163]
  v_mfma_f32_16x16x32_bf16 v[164:167], v[196:199], a[44:47], v[164:167]
  s_waitcnt vmcnt(20) lgkmcnt(0)
  s_barrier
  ds_read_b64_tr_b16 v[184:185], v212 offset:40960
  v_readlane_b32 s70, v39, 33
  v_mfma_f32_16x16x32_bf16 v[104:107], v[168:171], a[48:51], v[104:107]
  ds_read_b64_tr_b16 v[186:187], v212 offset:43008
  v_mfma_f32_16x16x32_bf16 v[108:111], v[172:175], a[48:51], v[108:111]
  v_mfma_f32_16x16x32_bf16 v[112:115], v[176:179], a[48:51], v[112:115]
  ds_read_b64_tr_b16 v[188:189], v213 offset:40960
  buffer_load_dwordx4 a[32:35], v8, s[56:59], s69 offen sc1
  v_mfma_f32_16x16x32_bf16 v[116:119], v[180:183], a[48:51], v[116:119]
  ds_read_b64_tr_b16 v[190:191], v213 offset:43008
L_pad45:
  s_cbranch_execz L_pad93
  v_mfma_f32_16x16x32_bf16 v[120:123], v[168:171], a[52:55], v[120:123]
  v_mfma_f32_16x16x32_bf16 v[124:127], v[172:175], a[52:55], v[124:127]
  ds_read_b64_tr_b16 v[192:193], v214 offset:40960
  buffer_load_dwordx4 a[36:39], v9, s[56:59], s69 offen sc1
  v_mfma_f32_16x16x32_bf16 v[128:131], v[176:179], a[52:55], v[128:131]
  v_mfma_f32_16x16x32_bf16 v[132:135], v[180:183], a[52:55], v[132:135]
  ds_read_b64_tr_b16 v[194:195], v214 offset:43008
  v_mfma_f32_16x16x32_bf16 v[136:139], v[168:171], a[56:59], v[136:139]
  ds_read_b64_tr_b16 v[196:197], v215 offset:40960
  buffer_load_dwordx4 a[40:43], v10, s[56:59], s69 offen sc1
  v_mfma_f32_16x16x32_bf16 v[140:143], v[172:175], a[56:59], v[140:143]
  v_mfma_f32_16x16x32_bf16 v[144:147], v[176:179], a[56:59], v[144:147]
  ds_read_b64_tr_b16 v[198:199], v215 offset:43008
  v_mfma_f32_16x16x32_bf16 v[148:151], v[180:183], a[56:59], v[148:151]
  buffer_load_dwordx4 a[44:47], v11, s[56:59], s69 offen sc1
  v_mfma_f32_16x16x32_bf16 v[152:155], v[168:171], a[60:63], v[152:155]
  v_mfma_f32_16x16x32_bf16 v[156:159], v[172:175], a[60:63], v[156:159]
  v_mfma_f32_16x16x32_bf16 v[160:163], v[176:179], a[60:63], v[160:163]
  v_mfma_f32_16x16x32_bf16 v[164:167], v[180:183], a[60:63], v[164:167]
  s_waitcnt vmcnt(14) lgkmcnt(0)
  ds_read_b64_tr_b16 v[168:169], v212 offset:49152
  v_readlane_b32 s69, v39, 34
  v_mfma_f32_16x16x32_bf16 v[104:107], v[184:187], a[64:67], v[104:107]
  ds_read_b64_tr_b16 v[170:171], v212 offset:51200
  v_mfma_f32_16x16x32_bf16 v[108:111], v[188:191], a[64:67], v[108:111]
  v_mfma_f32_16x16x32_bf16 v[112:115], v[192:195], a[64:67], v[112:115]
  ds_read_b64_tr_b16 v[172:173], v213 offset:49152
  buffer_load_dwordx4 a[48:51], v8, s[56:59], s70 offen sc1
  v_mfma_f32_16x16x32_bf16 v[116:119], v[196:199], a[64:67], v[116:119]
  ds_read_b64_tr_b16 v[174:175], v213 offset:51200
  v_mfma_f32_16x16x32_bf16 v[120:123], v[184:187], a[68:71], v[120:123]
  v_mfma_f32_16x16x32_bf16 v[124:127], v[188:191], a[68:71], v[124:127]
L_pad46:
  s_cbranch_execz L_pad94
  ds_read_b64_tr_b16 v[176:177], v214 offset:49152
  buffer_load_dwordx4 a[52:55], v9, s[56:59], s70 offen sc1
  v_mfma_f32_16x16x32_bf16 v[128:131], v[192:195], a[68:71], v[128:131]
  v_mfma_f32_16x16x32_bf16 v[132:135], v[196:199], a[68:71], v[132:135]
  ds_read_b64_tr_b16 v[178:179], v214 offset:51200
  v_mfma_f32_16x16x32_bf16 v[136:139], v[184:187], a[72:75], v[136:139]
  ds_read_b64_tr_b16 v[180:181], v215 offset:49152
  buffer_load_dwordx4 a[56:59], v10, s[56:59], s70 offen sc1
  v_mfma_f32_16x16x32_bf16 v[140:143], v[188:191], a[72:75], v[140:143]
  v_mfma_f32_16x16x32_bf16 v[144:147], v[192:195], a[72:75], v[144:147]
  ds_read_b64_tr_b16 v[182:183], v215 offset:51200
  v_mfma_f32_16x16x32_bf16 v[148:151], v[196:199], a[72:75], v[148:151]
  buffer_load_dwordx4 a[60:63], v11, s[56:59], s70 offen sc1
  v_mfma_f32_16x16x32_bf16 v[152:155], v[184:187], a[76:79], v[152:155]
  v_mfma_f32_16x16x32_bf16 v[156:159], v[188:191], a[76:79], v[156:159]
  v_mfma_f32_16x16x32_bf16 v[160:163], v[192:195], a[76:79], v[160:163]
  v_mfma_f32_16x16x32_bf16 v[164:167], v[196:199], a[76:79], v[164:167]
  s_waitcnt vmcnt(12) lgkmcnt(0)
  ds_read_b64_tr_b16 v[184:185], v212 offset:57344
  v_readlane_b32 s70, v39, 35
  v_mfma_f32_16x16x32_bf16 v[104:107], v[168:171], a[0:3], v[104:107]
  ds_read_b64_tr_b16 v[186:187], v212 offset:59392
  v_mfma_f32_16x16x32_bf16 v[108:111], v[172:175], a[0:3], v[108:111]
  v_mfma_f32_16x16x32_bf16 v[112:115], v[176:179], a[0:3], v[112:115]
  ds_read_b64_tr_b16 v[188:189], v213 offset:57344
  buffer_load_dwordx4 a[64:67], v8, s[56:59], s69 offen sc1
  v_mfma_f32_16x16x32_bf16 v[116:119], v[180:183], a[0:3], v[116:119]
  ds_read_b64_tr_b16 v[190:191], v213 offset:59392
  v_mfma_f32_16x16x32_bf16 v[120:123], v[168:171], a[4:7], v[120:123]
  v_mfma_f32_16x16x32_bf16 v[124:127], v[172:175], a[4:7], v[124:127]
  ds_read_b64_tr_b16 v[192:193], v214 offset:57344
  buffer_load_dwordx4 a[68:71], v9, s[56:59], s69 offen sc1
L_pad47:
  s_cbranch_execz L_warm_ret
  v_mfma_f32_16x16x32_bf16 v[128:131], v[176:179], a[4:7], v[128:131]
  v_mfma_f32_16x16x32_bf16 v[132:135], v[180:183], a[4:7], v[132:135]
  ds_read_b64_tr_b16 v[194:195], v214 offset:59392
  v_mfma_f32_16x16x32_bf16 v[136:139], v[168:171], a[8:11], v[136:139]
  ds_read_b64_tr_b16 v[196:197], v215 offset:57344
  buffer_load_dwordx4 a[72:75], v10, s[56:59], s69 offen sc1
  v_mfma_f32_16x16x32_bf16 v[140:143], v[172:175], a[8:11], v[140:143]
  v_mfma_f32_16x16x32_bf16 v[144:147], v[176:179], a[8:11], v[144:147]
  ds_read_b64_tr_b16 v[198:199], v215 offset:59392
  v_mfma_f32_16x16x32_bf16 v[148:151], v[180:183], a[8:11], v[148:151]
  buffer_load_dwordx4 a[76:79], v11, s[56:59], s69 offen sc1
  v_mfma_f32_16x16x32_bf16 v[152:155], v[168:171], a[12:15], v[152:155]
  v_mfma_f32_16x16x32_bf16 v[156:159], v[172:175], a[12:15], v[156:159]
  v_mfma_f32_16x16x32_bf16 v[160:163], v[176:179], a[12:15], v[160:163]
  v_mfma_f32_16x16x32_bf16 v[164:167], v[180:183], a[12:15], v[164:167]
  s_waitcnt vmcnt(12) lgkmcnt(0)
  ds_read_b64_tr_b16 v[168:169], v216 offset:0
  v_readlane_b32 s69, v39, 36
  v_mfma_f32_16x16x32_bf16 v[104:107], v[184:187], a[16:19], v[104:107]
  ds_read_b64_tr_b16 v[170:171], v216 offset:2048
  v_mfma_f32_16x16x32_bf16 v[108:111], v[188:191], a[16:19], v[108:111]
  v_mfma_f32_16x16x32_bf16 v[112:115], v[192:195], a[16:19], v[112:115]
  ds_read_b64_tr_b16 v[172:173], v217 offset:0
  buffer_load_dwordx4 a[0:3], v8, s[56:59], s70 offen sc1
  v_mfma_f32_16x16x32_bf16 v[116:119], v[196:199], a[16:19], v[116:119]
  ds_read_b64_tr_b16 v[174:175], v217 offset:2048
  v_mfma_f32_16x16x32_bf16 v[120:123], v[184:187], a[20:23], v[120:123]
  v_mfma_f32_16x16x32_bf16 v[124:127], v[188:191], a[20:23], v[124:127]
  ds_read_b64_tr_b16 v[176:177], v218 offset:0
  buffer_load_dwordx4 a[4:7], v9, s[56:59], s70 offen sc1
  v_mfma_f32_16x16x32_bf16 v[128:131], v[192:195], a[20:23], v[128:131]
  v_mfma_f32_16x16x32_bf16 v[132:135], v[196:199], a[20:23], v[132:135]
L_pad48:
  s_cbranch_execz L_warm_ret
  ds_read_b64_tr_b16 v[178:179], v218 offset:2048
  v_mfma_f32_16x16x32_bf16 v[136:139], v[184:187], a[24:27], v[136:139]
  ds_read_b64_tr_b16 v[180:181], v219 offset:0
  buffer_load_dwordx4 a[8:11], v10, s[56:59], s70 offen sc1
  v_mfma_f32_16x16x32_bf16 v[140:143], v[188:191], a[24:27], v[140:143]
  v_mfma_f32_16x16x32_bf16 v[144:147], v[192:195], a[24:27], v[144:147]
  ds_read_b64_tr_b16 v[182:183], v219 offset:2048
  v_mfma_f32_16x16x32_bf16 v[148:151], v[196:199], a[24:27], v[148:151]
  buffer_load_dwordx4 a[12:15], v11, s[56:59], s70 offen sc1
  v_mfma_f32_16x16x32_bf16 v[152:155], v[184:187], a[28:31], v[152:155]
  v_mfma_f32_16x16x32_bf16 v[156:159], v[188:191], a[28:31], v[156:159]
  v_mfma_f32_16x16x32_bf16 v[160:163], v[192:195], a[28:31], v[160:163]
  v_mfma_f32_16x16x32_bf16 v[164:167], v[196:199], a[28:31], v[164:167]
  s_waitcnt vmcnt(12) lgkmcnt(0)
  s_barrier
  ds_read_b64_tr_b16 v[184:185], v216 offset:8192
  v_readlane_b32 s70, v39, 37
  v_mfma_f32_16x16x32_bf16 v[104:107], v[168:171], a[32:35], v[104:107]
  ds_read_b64_tr_b16 v[186:187], v216 offset:10240
  v_mfma_f32_16x16x32_bf16 v[108:111], v[172:175], a[32:35], v[108:111]
  v_mfma_f32_16x16x32_bf16 v[112:115], v[176:179], a[32:35], v[112:115]
  ds_read_b64_tr_b16 v[188:189], v217 offset:8192
  buffer_load_dwordx4 a[16:19], v8, s[56:59], s69 offen sc1
  v_mfma_f32_16x16x32_bf16 v[116:119], v[180:183], a[32:35], v[116:119]
  ds_read_b64_tr_b16 v[190:191], v217 offset:10240
  v_mfma_f32_16x16x32_bf16 v[120:123], v[168:171], a[36:39], v[120:123]
  v_mfma_f32_16x16x32_bf16 v[124:127], v[172:175], a[36:39], v[124:127]
  ds_read_b64_tr_b16 v[192:193], v218 offset:8192
  buffer_load_dwordx4 a[20:23], v9, s[56:59], s69 offen sc1
  v_mfma_f32_16x16x32_bf16 v[128:131], v[176:179], a[36:39], v[128:131]
  v_mfma_f32_16x16x32_bf16 v[132:135], v[180:183], a[36:39], v[132:135]
  ds_read_b64_tr_b16 v[194:195], v218 offset:10240
  v_mfma_f32_16x16x32_bf16 v[136:139], v[168:171], a[40:43], v[136:139]
L_pad49:
  s_cbranch_execz L_warm_ret
  ds_read_b64_tr_b16 v[196:197], v219 offset:8192
  buffer_load_dwordx4 a[24:27], v10, s[56:59], s69 offen sc1
  v_mfma_f32_16x16x32_bf16 v[140:143], v[172:175], a[40:43], v[140:143]
  v_mfma_f32_16x16x32_bf16 v[144:147], v[176:179], a[40:43], v[144:147]
  ds_read_b64_tr_b16 v[198:199], v219 offset:10240
  v_mfma_f32_16x16x32_bf16 v[148:151], v[180:183], a[40:43], v[148:151]
  buffer_load_dwordx4 a[28:31], v11, s[56:59], s69 offen sc1
  v_mfma_f32_16x16x32_bf16 v[152:155], v[168:171], a[44:47], v[152:155]
  v_mfma_f32_16x16x32_bf16 v[156:159], v[172:175], a[44:47], v[156:159]
  v_mfma_f32_16x16x32_bf16 v[160:163], v[176:179], a[44:47], v[160:163]
  v_mfma_f32_16x16x32_bf16 v[164:167], v[180:183], a[44:47], v[164:167]
  s_waitcnt vmcnt(12) lgkmcnt(0)
  ds_read_b64_tr_b16 v[168:169], v216 offset:16384
  v_readlane_b32 s69, v39, 38
  v_mfma_f32_16x16x32_bf16 v[104:107], v[184:187], a[48:51], v[104:107]
  ds_read_b64_tr_b16 v[170:171], v216 offset:18432
  v_mfma_f32_16x16x32_bf16 v[108:111], v[188:191], a[48:51], v[108:111]
  v_mfma_f32_16x16x32_bf16 v[112:115], v[192:195], a[48:51], v[112:115]
  ds_read_b64_tr_b16 v[172:173], v217 offset:16384
  buffer_load_dwordx4 a[32:35], v8, s[56:59], s70 offen sc1
  v_mfma_f32_16x16x32_bf16 v[116:119], v[196:199], a[48:51], v[116:119]
  ds_read_b64_tr_b16 v[174:175], v217 offset:18432
  v_mfma_f32_16x16x32_bf16 v[120:123], v[184:187], a[52:55], v[120:123]
  v_mfma_f32_16x16x32_bf16 v[124:127], v[188:191], a[52:55], v[124:127]
  ds_read_b64_tr_b16 v[176:177], v218 offset:16384
  buffer_load_dwordx4 a[36:39], v9, s[56:59], s70 offen sc1
  v_mfma_f32_16x16x32_bf16 v[128:131], v[192:195], a[52:55], v[128:131]
  v_mfma_f32_16x16x32_bf16 v[132:135], v[196:199], a[52:55], v[132:135]
  ds_read_b64_tr_b16 v[178:179], v218 offset:18432
  v_mfma_f32_16x16x32_bf16 v[136:139], v[184:187], a[56:59], v[136:139]
  ds_read_b64_tr_b16 v[180:181], v219 offset:16384
  buffer_load_dwordx4 a[40:43], v10, s[56:59], s70 offen sc1
L_pad50:
  s_cbranch_execz L_warm_ret
  v_mfma_f32_16x16x32_bf16 v[140:143], v[188:191], a[56:59], v[140:143]
  v_mfma_f32_16x16x32_bf16 v[144:147], v[192:195], a[56:59], v[144:147]
  ds_read_b64_tr_b16 v[182:183], v219 offset:18432
  v_mfma_f32_16x16x32_bf16 v[148:151], v[196:199], a[56:59], v[148:151]
  buffer_load_dwordx4 a[44:47], v11, s[56:59], s70 offen sc1
  v_mfma_f32_16x16x32_bf16 v[152:155], v[184:187], a[60:63], v[152:155]
  v_mfma_f32_16x16x32_bf16 v[156:159], v[188:191], a[60:63], v[156:159]
  v_mfma_f32_16x16x32_bf16 v[160:163], v[192:195], a[60:63], v[160:163]
  v_mfma_f32_16x16x32_bf16 v[164:167], v[196:199], a[60:63], v[164:167]
  s_waitcnt vmcnt(12) lgkmcnt(0)
  ds_read_b64_tr_b16 v[184:185], v216 offset:24576
  v_readlane_b32 s70, v39, 39
  v_mfma_f32_16x16x32_bf16 v[104:107], v[168:171], a[64:67], v[104:107]
  ds_read_b64_tr_b16 v[186:187], v216 offset:26624
  buffer_load_dwordx4 a[48:51], v8, s[56:59], s69 offen sc1
  v_mfma_f32_16x16x32_bf16 v[108:111], v[172:175], a[64:67], v[108:111]
  buffer_load_dwordx4 a[52:55], v9, s[56:59], s69 offen sc1
  v_mfma_f32_16x16x32_bf16 v[112:115], v[176:179], a[64:67], v[112:115]
  ds_read_b64_tr_b16 v[188:189], v217 offset:24576
  buffer_load_dwordx4 a[56:59], v10, s[56:59], s69 offen sc1
  v_mfma_f32_16x16x32_bf16 v[116:119], v[180:183], a[64:67], v[116:119]
  ds_read_b64_tr_b16 v[190:191], v217 offset:26624
  buffer_load_dwordx4 a[60:63], v11, s[56:59], s69 offen sc1
  v_mfma_f32_16x16x32_bf16 v[120:123], v[168:171], a[68:71], v[120:123]
  v_mfma_f32_16x16x32_bf16 v[124:127], v[172:175], a[68:71], v[124:127]
  ds_read_b64_tr_b16 v[192:193], v218 offset:24576
  v_mul_f32 v40, v40, v200
  v_mfma_f32_16x16x32_bf16 v[128:131], v[176:179], a[68:71], v[128:131]
  v_mul_f32 v41, v41, v200
  v_mfma_f32_16x16x32_bf16 v[132:135], v[180:183], a[68:71], v[132:135]
  ds_read_b64_tr_b16 v[194:195], v218 offset:26624
  v_mul_f32 v42, v42, v200
  v_mfma_f32_16x16x32_bf16 v[136:139], v[168:171], a[72:75], v[136:139]
  ds_read_b64_tr_b16 v[196:197], v219 offset:24576
L_pad51:
  s_cbranch_execz L_warm_ret
  v_mul_f32 v43, v43, v200
  v_mfma_f32_16x16x32_bf16 v[140:143], v[172:175], a[72:75], v[140:143]
  v_mfma_f32_16x16x32_bf16 v[144:147], v[176:179], a[72:75], v[144:147]
  ds_read_b64_tr_b16 v[198:199], v219 offset:26624
  v_mul_f32 v44, v44, v200
  v_mfma_f32_16x16x32_bf16 v[148:151], v[180:183], a[72:75], v[148:151]
  v_mul_f32 v45, v45, v200
  v_mfma_f32_16x16x32_bf16 v[152:155], v[168:171], a[76:79], v[152:155]
  v_mul_f32 v46, v46, v200
  v_mfma_f32_16x16x32_bf16 v[156:159], v[172:175], a[76:79], v[156:159]
  v_mul_f32 v47, v47, v200
  v_mfma_f32_16x16x32_bf16 v[160:163], v[176:179], a[76:79], v[160:163]
  v_mfma_f32_16x16x32_bf16 v[164:167], v[180:183], a[76:79], v[164:167]
  s_waitcnt vmcnt(12) lgkmcnt(0)
  ds_read_b64_tr_b16 v[168:169], v216 offset:32768
  v_readlane_b32 s69, v39, 40
  v_mfma_f32_16x16x32_bf16 v[104:107], v[184:187], a[0:3], v[104:107]
  ds_read_b64_tr_b16 v[170:171], v216 offset:34816
  buffer_load_dwordx4 a[64:67], v8, s[56:59], s70 offen sc1
  v_mfma_f32_16x16x32_bf16 v[108:111], v[188:191], a[0:3], v[108:111]
  buffer_load_dwordx4 a[68:71], v9, s[56:59], s70 offen sc1
  v_mfma_f32_16x16x32_bf16 v[112:115], v[192:195], a[0:3], v[112:115]
  ds_read_b64_tr_b16 v[172:173], v217 offset:32768
  buffer_load_dwordx4 a[72:75], v10, s[56:59], s70 offen sc1
  v_mfma_f32_16x16x32_bf16 v[116:119], v[196:199], a[0:3], v[116:119]
  ds_read_b64_tr_b16 v[174:175], v217 offset:34816
  buffer_load_dwordx4 a[76:79], v11, s[56:59], s70 offen sc1
  v_mfma_f32_16x16x32_bf16 v[120:123], v[184:187], a[4:7], v[120:123]
  v_mfma_f32_16x16x32_bf16 v[124:127], v[188:191], a[4:7], v[124:127]
  ds_read_b64_tr_b16 v[176:177], v218 offset:32768
  v_mul_f32 v48, v48, v200
  v_mfma_f32_16x16x32_bf16 v[128:131], v[192:195], a[4:7], v[128:131]
  v_mul_f32 v49, v49, v200
  v_mfma_f32_16x16x32_bf16 v[132:135], v[196:199], a[4:7], v[132:135]
  ds_read_b64_tr_b16 v[178:179], v218 offset:34816
  v_mul_f32 v50, v50, v200
L_pad52:
  s_cbranch_execz L_warm_ret
  v_mfma_f32_16x16x32_bf16 v[136:139], v[184:187], a[8:11], v[136:139]
  ds_read_b64_tr_b16 v[180:181], v219 offset:32768
  v_mul_f32 v51, v51, v200
  v_mfma_f32_16x16x32_bf16 v[140:143], v[188:191], a[8:11], v[140:143]
  v_mfma_f32_16x16x32_bf16 v[144:147], v[192:195], a[8:11], v[144:147]
  ds_read_b64_tr_b16 v[182:183], v219 offset:34816
  v_mul_f32 v52, v52, v200
  v_mfma_f32_16x16x32_bf16 v[148:151], v[196:199], a[8:11], v[148:151]
  v_mul_f32 v53, v53, v200
  v_mfma_f32_16x16x32_bf16 v[152:155], v[184:187], a[12:15], v[152:155]
  v_mul_f32 v54, v54, v200
  v_mfma_f32_16x16x32_bf16 v[156:159], v[188:191], a[12:15], v[156:159]
  v_mul_f32 v55, v55, v200
  v_mfma_f32_16x16x32_bf16 v[160:163], v[192:195], a[12:15], v[160:163]
  v_mfma_f32_16x16x32_bf16 v[164:167], v[196:199], a[12:15], v[164:167]
  s_waitcnt vmcnt(12) lgkmcnt(0)
  s_barrier
  ds_read_b64_tr_b16 v[184:185], v216 offset:40960
  v_readlane_b32 s70, v39, 41
  v_mfma_f32_16x16x32_bf16 v[104:107], v[168:171], a[16:19], v[104:107]
  ds_read_b64_tr_b16 v[186:187], v216 offset:43008
  buffer_load_dwordx4 a[0:3], v8, s[56:59], s69 offen sc1
  v_mfma_f32_16x16x32_bf16 v[108:111], v[172:175], a[16:19], v[108:111]
  buffer_load_dwordx4 a[4:7], v9, s[56:59], s69 offen sc1
  v_mfma_f32_16x16x32_bf16 v[112:115], v[176:179], a[16:19], v[112:115]
  ds_read_b64_tr_b16 v[188:189], v217 offset:40960
  buffer_load_dwordx4 a[8:11], v10, s[56:59], s69 offen sc1
  v_mfma_f32_16x16x32_bf16 v[116:119], v[180:183], a[16:19], v[116:119]
  ds_read_b64_tr_b16 v[190:191], v217 offset:43008
  buffer_load_dwordx4 a[12:15], v11, s[56:59], s69 offen sc1
  v_mfma_f32_16x16x32_bf16 v[120:123], v[168:171], a[20:23], v[120:123]
  v_mfma_f32_16x16x32_bf16 v[124:127], v[172:175], a[20:23], v[124:127]
  ds_read_b64_tr_b16 v[192:193], v218 offset:40960
  v_mul_f32 v56, v56, v202
  v_mfma_f32_16x16x32_bf16 v[128:131], v[176:179], a[20:23], v[128:131]
  v_mul_f32 v57, v57, v202
L_pad53:
  s_cbranch_execz L_warm_ret
  v_mfma_f32_16x16x32_bf16 v[132:135], v[180:183], a[20:23], v[132:135]
  ds_read_b64_tr_b16 v[194:195], v218 offset:43008
  v_mul_f32 v58, v58, v202
  v_mfma_f32_16x16x32_bf16 v[136:139], v[168:171], a[24:27], v[136:139]
  ds_read_b64_tr_b16 v[196:197], v219 offset:40960
  v_mul_f32 v59, v59, v202
  v_mfma_f32_16x16x32_bf16 v[140:143], v[172:175], a[24:27], v[140:143]
  v_mfma_f32_16x16x32_bf16 v[144:147], v[176:179], a[24:27], v[144:147]
  ds_read_b64_tr_b16 v[198:199], v219 offset:43008
  v_mul_f32 v60, v60, v202
  v_mfma_f32_16x16x32_bf16 v[148:151], v[180:183], a[24:27], v[148:151]
  v_mul_f32 v61, v61, v202
  v_mfma_f32_16x16x32_bf16 v[152:155], v[168:171], a[28:31], v[152:155]
  v_mul_f32 v62, v62, v202
  v_mfma_f32_16x16x32_bf16 v[156:159], v[172:175], a[28:31], v[156:159]
  v_mul_f32 v63, v63, v202
  v_mfma_f32_16x16x32_bf16 v[160:163], v[176:179], a[28:31], v[160:163]
  v_mfma_f32_16x16x32_bf16 v[164:167], v[180:183], a[28:31], v[164:167]
  s_waitcnt vmcnt(12) lgkmcnt(0)
  ds_read_b64_tr_b16 v[168:169], v216 offset:49152
  v_readlane_b32 s69, v39, 42
  v_mfma_f32_16x16x32_bf16 v[104:107], v[184:187], a[32:35], v[104:107]
  ds_read_b64_tr_b16 v[170:171], v216 offset:51200
  buffer_load_dwordx4 a[16:19], v8, s[56:59], s70 offen sc1
  v_mfma_f32_16x16x32_bf16 v[108:111], v[188:191], a[32:35], v[108:111]
  buffer_load_dwordx4 a[20:23], v9, s[56:59], s70 offen sc1
  v_mfma_f32_16x16x32_bf16 v[112:115], v[192:195], a[32:35], v[112:115]
  ds_read_b64_tr_b16 v[172:173], v217 offset:49152
  buffer_load_dwordx4 a[24:27], v10, s[56:59], s70 offen sc1
  v_mfma_f32_16x16x32_bf16 v[116:119], v[196:199], a[32:35], v[116:119]
  ds_read_b64_tr_b16 v[174:175], v217 offset:51200
  buffer_load_dwordx4 a[28:31], v11, s[56:59], s70 offen sc1
  v_mfma_f32_16x16x32_bf16 v[120:123], v[184:187], a[36:39], v[120:123]
  v_mfma_f32_16x16x32_bf16 v[124:127], v[188:191], a[36:39], v[124:127]
  ds_read_b64_tr_b16 v[176:177], v218 offset:49152
L_pad54:
  s_cbranch_execz L_warm_ret
  v_mul_f32 v64, v64, v202
  v_mfma_f32_16x16x32_bf16 v[128:131], v[192:195], a[36:39], v[128:131]
  v_mul_f32 v65, v65, v202
  v_mfma_f32_16x16x32_bf16 v[132:135], v[196:199], a[36:39], v[132:135]
  ds_read_b64_tr_b16 v[178:179], v218 offset:51200
  v_mul_f32 v66, v66, v202
  v_mfma_f32_16x16x32_bf16 v[136:139], v[184:187], a[40:43], v[136:139]
  ds_read_b64_tr_b16 v[180:181], v219 offset:49152
  v_mul_f32 v67, v67, v202
  v_mfma_f32_16x16x32_bf16 v[140:143], v[188:191], a[40:43], v[140:143]
  v_mfma_f32_16x16x32_bf16 v[144:147], v[192:195], a[40:43], v[144:147]
  ds_read_b64_tr_b16 v[182:183], v219 offset:51200
  v_mul_f32 v68, v68, v202
  v_mfma_f32_16x16x32_bf16 v[148:151], v[196:199], a[40:43], v[148:151]
  v_mul_f32 v69, v69, v202
  v_mfma_f32_16x16x32_bf16 v[152:155], v[184:187], a[44:47], v[152:155]
  v_mul_f32 v70, v70, v202
  v_mfma_f32_16x16x32_bf16 v[156:159], v[188:191], a[44:47], v[156:159]
  v_mul_f32 v71, v71, v202
  v_mfma_f32_16x16x32_bf16 v[160:163], v[192:195], a[44:47], v[160:163]
  v_mfma_f32_16x16x32_bf16 v[164:167], v[196:199], a[44:47], v[164:167]
  s_waitcnt vmcnt(12) lgkmcnt(0)
  ds_read_b64_tr_b16 v[184:185], v216 offset:57344
  v_readlane_b32 s70, v39, 43
  v_mfma_f32_16x16x32_bf16 v[104:107], v[168:171], a[48:51], v[104:107]
  ds_read_b64_tr_b16 v[186:187], v216 offset:59392
  buffer_load_dwordx4 a[32:35], v8, s[56:59], s69 offen sc1
  v_mfma_f32_16x16x32_bf16 v[108:111], v[172:175], a[48:51], v[108:111]
  buffer_load_dwordx4 a[36:39], v9, s[56:59], s69 offen sc1
  v_mfma_f32_16x16x32_bf16 v[112:115], v[176:179], a[48:51], v[112:115]
  ds_read_b64_tr_b16 v[188:189], v217 offset:57344
  buffer_load_dwordx4 a[40:43], v10, s[56:59], s69 offen sc1
  v_mfma_f32_16x16x32_bf16 v[116:119], v[180:183], a[48:51], v[116:119]
  ds_read_b64_tr_b16 v[190:191], v217 offset:59392
  buffer_load_dwordx4 a[44:47], v11, s[56:59], s69 offen sc1
  v_mfma_f32_16x16x32_bf16 v[120:123], v[168:171], a[52:55], v[120:123]
L_pad55:
  s_cbranch_execz L_warm_ret
  v_mfma_f32_16x16x32_bf16 v[124:127], v[172:175], a[52:55], v[124:127]
  ds_read_b64_tr_b16 v[192:193], v218 offset:57344
  v_mul_f32 v72, v72, v204
  v_mfma_f32_16x16x32_bf16 v[128:131], v[176:179], a[52:55], v[128:131]
  v_mul_f32 v73, v73, v204
  v_mfma_f32_16x16x32_bf16 v[132:135], v[180:183], a[52:55], v[132:135]
  ds_read_b64_tr_b16 v[194:195], v218 offset:59392
  v_mul_f32 v74, v74, v204
  v_mfma_f32_16x16x32_bf16 v[136:139], v[168:171], a[56:59], v[136:139]
  ds_read_b64_tr_b16 v[196:197], v219 offset:57344
  v_mul_f32 v75, v75, v204
  v_mfma_f32_16x16x32_bf16 v[140:143], v[172:175], a[56:59], v[140:143]
  v_mfma_f32_16x16x32_bf16 v[144:147], v[176:179], a[56:59], v[144:147]
  ds_read_b64_tr_b16 v[198:199], v219 offset:59392
  v_mul_f32 v76, v76, v204
  v_mfma_f32_16x16x32_bf16 v[148:151], v[180:183], a[56:59], v[148:151]
  v_mul_f32 v77, v77, v204
  v_mfma_f32_16x16x32_bf16 v[152:155], v[168:171], a[60:63], v[152:155]
  v_mul_f32 v78, v78, v204
  v_mfma_f32_16x16x32_bf16 v[156:159], v[172:175], a[60:63], v[156:159]
  v_mul_f32 v79, v79, v204
  v_mfma_f32_16x16x32_bf16 v[160:163], v[176:179], a[60:63], v[160:163]
  v_mfma_f32_16x16x32_bf16 v[164:167], v[180:183], a[60:63], v[164:167]
  s_waitcnt vmcnt(12) lgkmcnt(0)
  ds_read_b64_tr_b16 v[168:169], v220 offset:0
  buffer_load_dwordx4 a[48:51], v8, s[56:59], s70 offen sc1
  v_mfma_f32_16x16x32_bf16 v[104:107], v[184:187], a[64:67], v[104:107]
  ds_read_b64_tr_b16 v[170:171], v220 offset:2048
  buffer_load_dwordx4 a[52:55], v9, s[56:59], s70 offen sc1
  v_mfma_f32_16x16x32_bf16 v[108:111], v[188:191], a[64:67], v[108:111]
  buffer_load_dwordx4 a[56:59], v10, s[56:59], s70 offen sc1
  v_mfma_f32_16x16x32_bf16 v[112:115], v[192:195], a[64:67], v[112:115]
  ds_read_b64_tr_b16 v[172:173], v221 offset:0
  v_mfma_f32_16x16x32_bf16 v[116:119], v[196:199], a[64:67], v[116:119]
  ds_read_b64_tr_b16 v[174:175], v221 offset:2048
  buffer_load_dwordx4 a[60:63], v11, s[56:59], s70 offen sc1
L_pad56:
  s_cbranch_execz L_warm_ret
  v_mfma_f32_16x16x32_bf16 v[120:123], v[184:187], a[68:71], v[120:123]
  v_mul_f32 v80, v80, v204
  v_mfma_f32_16x16x32_bf16 v[124:127], v[188:191], a[68:71], v[124:127]
  ds_read_b64_tr_b16 v[176:177], v222 offset:0
  v_mul_f32 v81, v81, v204
  v_mfma_f32_16x16x32_bf16 v[128:131], v[192:195], a[68:71], v[128:131]
  v_mfma_f32_16x16x32_bf16 v[132:135], v[196:199], a[68:71], v[132:135]
  ds_read_b64_tr_b16 v[178:179], v222 offset:2048
  v_mul_f32 v82, v82, v204
  v_mfma_f32_16x16x32_bf16 v[136:139], v[184:187], a[72:75], v[136:139]
  ds_read_b64_tr_b16 v[180:181], v223 offset:0
  v_mul_f32 v83, v83, v204
  v_mfma_f32_16x16x32_bf16 v[140:143], v[188:191], a[72:75], v[140:143]
  v_mul_f32 v84, v84, v204
  v_mfma_f32_16x16x32_bf16 v[144:147], v[192:195], a[72:75], v[144:147]
  ds_read_b64_tr_b16 v[182:183], v223 offset:2048
  v_mfma_f32_16x16x32_bf16 v[148:151], v[196:199], a[72:75], v[148:151]
  v_mul_f32 v85, v85, v204
  v_mfma_f32_16x16x32_bf16 v[152:155], v[184:187], a[76:79], v[152:155]
  v_mul_f32 v86, v86, v204
  v_mfma_f32_16x16x32_bf16 v[156:159], v[188:191], a[76:79], v[156:159]
  v_mul_f32 v87, v87, v204
  v_mfma_f32_16x16x32_bf16 v[160:163], v[192:195], a[76:79], v[160:163]
  v_mfma_f32_16x16x32_bf16 v[164:167], v[196:199], a[76:79], v[164:167]
  s_waitcnt vmcnt(12) lgkmcnt(0)
  s_barrier
  ds_read_b64_tr_b16 v[184:185], v220 offset:8192
  v_mul_f32 v88, v88, v206
  v_mfma_f32_16x16x32_bf16 v[104:107], v[168:171], a[0:3], v[104:107]
  ds_read_b64_tr_b16 v[186:187], v220 offset:10240
  v_mfma_f32_16x16x32_bf16 v[108:111], v[172:175], a[0:3], v[108:111]
  v_mul_f32 v89, v89, v206
  v_mfma_f32_16x16x32_bf16 v[112:115], v[176:179], a[0:3], v[112:115]
  ds_read_b64_tr_b16 v[188:189], v221 offset:8192
  v_mfma_f32_16x16x32_bf16 v[116:119], v[180:183], a[0:3], v[116:119]
  ds_read_b64_tr_b16 v[190:191], v221 offset:10240
  v_mul_f32 v90, v90, v206
  v_mfma_f32_16x16x32_bf16 v[120:123], v[168:171], a[4:7], v[120:123]
L_pad57:
  s_cbranch_execz L_warm_ret
  v_mfma_f32_16x16x32_bf16 v[124:127], v[172:175], a[4:7], v[124:127]
  ds_read_b64_tr_b16 v[192:193], v222 offset:8192
  v_mul_f32 v91, v91, v206
  v_mfma_f32_16x16x32_bf16 v[128:131], v[176:179], a[4:7], v[128:131]
  v_mfma_f32_16x16x32_bf16 v[132:135], v[180:183], a[4:7], v[132:135]
  ds_read_b64_tr_b16 v[194:195], v222 offset:10240
  v_mul_f32 v92, v92, v206
  v_mfma_f32_16x16x32_bf16 v[136:139], v[168:171], a[8:11], v[136:139]
  ds_read_b64_tr_b16 v[196:197], v223 offset:8192
  v_mfma_f32_16x16x32_bf16 v[140:143], v[172:175], a[8:11], v[140:143]
  v_mul_f32 v93, v93, v206
  v_mfma_f32_16x16x32_bf16 v[144:147], v[176:179], a[8:11], v[144:147]
  ds_read_b64_tr_b16 v[198:199], v223 offset:10240
  v_mfma_f32_16x16x32_bf16 v[148:151], v[180:183], a[8:11], v[148:151]
  v_mul_f32 v94, v94, v206
  v_mfma_f32_16x16x32_bf16 v[152:155], v[168:171], a[12:15], v[152:155]
  v_mfma_f32_16x16x32_bf16 v[156:159], v[172:175], a[12:15], v[156:159]
  v_mul_f32 v95, v95, v206
  v_mfma_f32_16x16x32_bf16 v[160:163], v[176:179], a[12:15], v[160:163]
  v_mfma_f32_16x16x32_bf16 v[164:167], v[180:183], a[12:15], v[164:167]
  s_waitcnt vmcnt(8) lgkmcnt(0)
  ds_read_b64_tr_b16 v[168:169], v220 offset:16384
  v_mul_f32 v96, v96, v206
  v_mfma_f32_16x16x32_bf16 v[104:107], v[184:187], a[16:19], v[104:107]
  ds_read_b64_tr_b16 v[170:171], v220 offset:18432
  v_mfma_f32_16x16x32_bf16 v[108:111], v[188:191], a[16:19], v[108:111]
  v_mul_f32 v97, v97, v206
  v_mfma_f32_16x16x32_bf16 v[112:115], v[192:195], a[16:19], v[112:115]
  ds_read_b64_tr_b16 v[172:173], v221 offset:16384
  v_mfma_f32_16x16x32_bf16 v[116:119], v[196:199], a[16:19], v[116:119]
  ds_read_b64_tr_b16 v[174:175], v221 offset:18432
  v_mul_f32 v98, v98, v206
  v_mfma_f32_16x16x32_bf16 v[120:123], v[184:187], a[20:23], v[120:123]
  v_mfma_f32_16x16x32_bf16 v[124:127], v[188:191], a[20:23], v[124:127]
  ds_read_b64_tr_b16 v[176:177], v222 offset:16384
  v_mul_f32 v99, v99, v206
  v_mfma_f32_16x16x32_bf16 v[128:131], v[192:195], a[20:23], v[128:131]
L_pad58:
  s_cbranch_execz L_warm_ret
  v_mfma_f32_16x16x32_bf16 v[132:135], v[196:199], a[20:23], v[132:135]
  ds_read_b64_tr_b16 v[178:179], v222 offset:18432
  v_mul_f32 v100, v100, v206
  v_mfma_f32_16x16x32_bf16 v[136:139], v[184:187], a[24:27], v[136:139]
  ds_read_b64_tr_b16 v[180:181], v223 offset:16384
  v_mfma_f32_16x16x32_bf16 v[140:143], v[188:191], a[24:27], v[140:143]
  v_mul_f32 v101, v101, v206
  v_mfma_f32_16x16x32_bf16 v[144:147], v[192:195], a[24:27], v[144:147]
  ds_read_b64_tr_b16 v[182:183], v223 offset:18432
  v_mfma_f32_16x16x32_bf16 v[148:151], v[196:199], a[24:27], v[148:151]
  v_mul_f32 v102, v102, v206
  v_mfma_f32_16x16x32_bf16 v[152:155], v[184:187], a[28:31], v[152:155]
  v_mfma_f32_16x16x32_bf16 v[156:159], v[188:191], a[28:31], v[156:159]
  v_mul_f32 v103, v103, v206
  v_mfma_f32_16x16x32_bf16 v[160:163], v[192:195], a[28:31], v[160:163]
  v_mfma_f32_16x16x32_bf16 v[164:167], v[196:199], a[28:31], v[164:167]
  s_waitcnt vmcnt(4) lgkmcnt(0)
  ds_read_b64_tr_b16 v[184:185], v220 offset:24576
  v_mfma_f32_16x16x32_bf16 v[104:107], v[168:171], a[32:35], v[104:107]
  ds_read_b64_tr_b16 v[186:187], v220 offset:26624
  v_mfma_f32_16x16x32_bf16 v[108:111], v[172:175], a[32:35], v[108:111]
  v_mfma_f32_16x16x32_bf16 v[112:115], v[176:179], a[32:35], v[112:115]
  ds_read_b64_tr_b16 v[188:189], v221 offset:24576
  v_mfma_f32_16x16x32_bf16 v[116:119], v[180:183], a[32:35], v[116:119]
  ds_read_b64_tr_b16 v[190:191], v221 offset:26624
  v_mfma_f32_16x16x32_bf16 v[120:123], v[168:171], a[36:39], v[120:123]
  v_mfma_f32_16x16x32_bf16 v[124:127], v[172:175], a[36:39], v[124:127]
  ds_read_b64_tr_b16 v[192:193], v222 offset:24576
  v_mfma_f32_16x16x32_bf16 v[128:131], v[176:179], a[36:39], v[128:131]
  v_mfma_f32_16x16x32_bf16 v[132:135], v[180:183], a[36:39], v[132:135]
  ds_read_b64_tr_b16 v[194:195], v222 offset:26624
  v_mfma_f32_16x16x32_bf16 v[136:139], v[168:171], a[40:43], v[136:139]
  ds_read_b64_tr_b16 v[196:197], v223 offset:24576
  v_mfma_f32_16x16x32_bf16 v[140:143], v[172:175], a[40:43], v[140:143]
L_pad59:
  s_cbranch_execz L_warm_ret
  v_mfma_f32_16x16x32_bf16 v[144:147], v[176:179], a[40:43], v[144:147]
  ds_read_b64_tr_b16 v[198:199], v223 offset:26624
  v_mfma_f32_16x16x32_bf16 v[148:151], v[180:183], a[40:43], v[148:151]
  v_mfma_f32_16x16x32_bf16 v[152:155], v[168:171], a[44:47], v[152:155]
  v_mfma_f32_16x16x32_bf16 v[156:159], v[172:175], a[44:47], v[156:159]
  v_mfma_f32_16x16x32_bf16 v[160:163], v[176:179], a[44:47], v[160:163]
  v_mfma_f32_16x16x32_bf16 v[164:167], v[180:183], a[44:47], v[164:167]
  s_waitcnt vmcnt(0) lgkmcnt(0)
  v_mfma_f32_16x16x32_bf16 v[104:107], v[184:187], a[48:51], v[104:107]
  v_mfma_f32_16x16x32_bf16 v[108:111], v[188:191], a[48:51], v[108:111]
  v_mfma_f32_16x16x32_bf16 v[112:115], v[192:195], a[48:51], v[112:115]
  v_mfma_f32_16x16x32_bf16 v[116:119], v[196:199], a[48:51], v[116:119]
  v_mfma_f32_16x16x32_bf16 v[120:123], v[184:187], a[52:55], v[120:123]
  v_mfma_f32_16x16x32_bf16 v[124:127], v[188:191], a[52:55], v[124:127]
  v_mfma_f32_16x16x32_bf16 v[128:131], v[192:195], a[52:55], v[128:131]
  v_mfma_f32_16x16x32_bf16 v[132:135], v[196:199], a[52:55], v[132:135]
  v_mfma_f32_16x16x32_bf16 v[136:139], v[184:187], a[56:59], v[136:139]
  v_mfma_f32_16x16x32_bf16 v[140:143], v[188:191], a[56:59], v[140:143]
  v_mfma_f32_16x16x32_bf16 v[144:147], v[192:195], a[56:59], v[144:147]
  v_mfma_f32_16x16x32_bf16 v[148:151], v[196:199], a[56:59], v[148:151]
  v_mfma_f32_16x16x32_bf16 v[152:155], v[184:187], a[60:63], v[152:155]
  v_mfma_f32_16x16x32_bf16 v[156:159], v[188:191], a[60:63], v[156:159]
  v_mfma_f32_16x16x32_bf16 v[160:163], v[192:195], a[60:63], v[160:163]
  v_mfma_f32_16x16x32_bf16 v[164:167], v[196:199], a[60:63], v[164:167]
  s_nop 7
  v_pk_fma_f32 v[40:41], v[104:105], v[200:201], v[40:41] op_sel:[0,1,0] op_sel_hi:[1,1,1]
  v_pk_fma_f32 v[42:43], v[106:107], v[200:201], v[42:43] op_sel:[0,1,0] op_sel_hi:[1,1,1]
  v_pk_fma_f32 v[44:45], v[108:109], v[200:201], v[44:45] op_sel:[0,1,0] op_sel_hi:[1,1,1]
  v_pk_fma_f32 v[46:47], v[110:111], v[200:201], v[46:47] op_sel:[0,1,0] op_sel_hi:[1,1,1]
  v_pk_fma_f32 v[48:49], v[112:113], v[200:201], v[48:49] op_sel:[0,1,0] op_sel_hi:[1,1,1]
  v_pk_fma_f32 v[50:51], v[114:115], v[200:201], v[50:51] op_sel:[0,1,0] op_sel_hi:[1,1,1]
  v_pk_fma_f32 v[52:53], v[116:117], v[200:201], v[52:53] op_sel:[0,1,0] op_sel_hi:[1,1,1]
  v_pk_fma_f32 v[54:55], v[118:119], v[200:201], v[54:55] op_sel:[0,1,0] op_sel_hi:[1,1,1]
L_pad60:
  s_cbranch_execz L_warm_ret
  v_pk_fma_f32 v[56:57], v[120:121], v[202:203], v[56:57] op_sel:[0,1,0] op_sel_hi:[1,1,1]
  v_pk_fma_f32 v[58:59], v[122:123], v[202:203], v[58:59] op_sel:[0,1,0] op_sel_hi:[1,1,1]
  v_pk_fma_f32 v[60:61], v[124:125], v[202:203], v[60:61] op_sel:[0,1,0] op_sel_hi:[1,1,1]
  v_pk_fma_f32 v[62:63], v[126:127], v[202:203], v[62:63] op_sel:[0,1,0] op_sel_hi:[1,1,1]
  v_pk_fma_f32 v[64:65], v[128:129], v[202:203], v[64:65] op_sel:[0,1,0] op_sel_hi:[1,1,1]
  v_pk_fma_f32 v[66:67], v[130:131], v[202:203], v[66:67] op_sel:[0,1,0] op_sel_hi:[1,1,1]
  v_pk_fma_f32 v[68:69], v[132:133], v[202:203], v[68:69] op_sel:[0,1,0] op_sel_hi:[1,1,1]
  v_pk_fma_f32 v[70:71], v[134:135], v[202:203], v[70:71] op_sel:[0,1,0] op_sel_hi:[1,1,1]
  v_pk_fma_f32 v[72:73], v[136:137], v[204:205], v[72:73] op_sel:[0,1,0] op_sel_hi:[1,1,1]
  v_pk_fma_f32 v[74:75], v[138:139], v[204:205], v[74:75] op_sel:[0,1,0] op_sel_hi:[1,1,1]
  v_pk_fma_f32 v[76:77], v[140:141], v[204:205], v[76:77] op_sel:[0,1,0] op_sel_hi:[1,1,1]
  v_pk_fma_f32 v[78:79], v[142:143], v[204:205], v[78:79] op_sel:[0,1,0] op_sel_hi:[1,1,1]
  v_pk_fma_f32 v[80:81], v[144:145], v[204:205], v[80:81] op_sel:[0,1,0] op_sel_hi:[1,1,1]
  v_pk_fma_f32 v[82:83], v[146:147], v[204:205], v[82:83] op_sel:[0,1,0] op_sel_hi:[1,1,1]
  v_pk_fma_f32 v[84:85], v[148:149], v[204:205], v[84:85] op_sel:[0,1,0] op_sel_hi:[1,1,1]
  v_pk_fma_f32 v[86:87], v[150:151], v[204:205], v[86:87] op_sel:[0,1,0] op_sel_hi:[1,1,1]
  v_pk_fma_f32 v[88:89], v[152:153], v[206:207], v[88:89] op_sel:[0,1,0] op_sel_hi:[1,1,1]
  v_pk_fma_f32 v[90:91], v[154:155], v[206:207], v[90:91] op_sel:[0,1,0] op_sel_hi:[1,1,1]
  v_pk_fma_f32 v[92:93], v[156:157], v[206:207], v[92:93] op_sel:[0,1,0] op_sel_hi:[1,1,1]
  v_pk_fma_f32 v[94:95], v[158:159], v[206:207], v[94:95] op_sel:[0,1,0] op_sel_hi:[1,1,1]
  v_pk_fma_f32 v[96:97], v[160:161], v[206:207], v[96:97] op_sel:[0,1,0] op_sel_hi:[1,1,1]
  v_pk_fma_f32 v[98:99], v[162:163], v[206:207], v[98:99] op_sel:[0,1,0] op_sel_hi:[1,1,1]
  v_pk_fma_f32 v[100:101], v[164:165], v[206:207], v[100:101] op_sel:[0,1,0] op_sel_hi:[1,1,1]
  v_pk_fma_f32 v[102:103], v[166:167], v[206:207], v[102:103] op_sel:[0,1,0] op_sel_hi:[1,1,1]
  v_lshlrev_b32 v4, 4, v1
  s_lshl_b32 s72, s4, 13
  v_add_u32 v5, s72, v4
  s_xor_b32 s72, s72, 8192
  v_add_u32 v6, s72, v4
  s_barrier
  s_bitcmp1_b32 s4, 0
  s_cbranch_scc1 L_ek1q
  ds_write_b128 v5, v[48:51] offset:0
  ds_write_b128 v5, v[52:55] offset:1024
L_pad61:
  s_cbranch_execz L_warm_ret
  ds_write_b128 v5, v[64:67] offset:2048
  ds_write_b128 v5, v[68:71] offset:3072
  ds_write_b128 v5, v[80:83] offset:4096
  ds_write_b128 v5, v[84:87] offset:5120
  ds_write_b128 v5, v[96:99] offset:6144
  ds_write_b128 v5, v[100:103] offset:7168
  s_waitcnt lgkmcnt(0)
  s_barrier
  ds_read_b128 v[104:107], v6 offset:0
  ds_read_b128 v[108:111], v6 offset:1024
  ds_read_b128 v[112:115], v6 offset:2048
  ds_read_b128 v[116:119], v6 offset:3072
  ds_read_b128 v[120:123], v6 offset:4096
  ds_read_b128 v[124:127], v6 offset:5120
  ds_read_b128 v[128:131], v6 offset:6144
  ds_read_b128 v[132:135], v6 offset:7168
  s_waitcnt lgkmcnt(6)
  v_pk_add_f32 v[40:41], v[40:41], v[104:105]
  v_pk_add_f32 v[42:43], v[42:43], v[106:107]
  v_pk_add_f32 v[44:45], v[44:45], v[108:109]
  v_pk_add_f32 v[46:47], v[46:47], v[110:111]
  v_cvt_pk_bf16_f32 v168, v40, v41
  v_cvt_pk_bf16_f32 v169, v42, v43
  v_cvt_pk_bf16_f32 v170, v44, v45
  v_cvt_pk_bf16_f32 v171, v46, v47
  s_nop 1
  v_permlane32_swap_b32 v168, v170
  v_permlane32_swap_b32 v169, v171
  s_nop 1
  v_permlane16_swap_b32 v168, v170
  v_permlane16_swap_b32 v169, v171
  s_movk_i32 s72, 0
  buffer_store_dwordx4 v[168:171], v3, s[44:47], s72 offen
  s_waitcnt lgkmcnt(4)
  v_pk_add_f32 v[56:57], v[56:57], v[112:113]
L_pad62:
  s_cbranch_execz L_warm_ret
  v_pk_add_f32 v[58:59], v[58:59], v[114:115]
  v_pk_add_f32 v[60:61], v[60:61], v[116:117]
  v_pk_add_f32 v[62:63], v[62:63], v[118:119]
  v_cvt_pk_bf16_f32 v172, v56, v57
  v_cvt_pk_bf16_f32 v173, v58, v59
  v_cvt_pk_bf16_f32 v174, v60, v61
  v_cvt_pk_bf16_f32 v175, v62, v63
  s_nop 1
  v_permlane32_swap_b32 v172, v174
  v_permlane32_swap_b32 v173, v175
  s_nop 1
  v_permlane16_swap_b32 v172, v174
  v_permlane16_swap_b32 v173, v175
  s_movk_i32 s72, 20480
  buffer_store_dwordx4 v[172:175], v3, s[44:47], s72 offen
  s_waitcnt lgkmcnt(2)
  v_pk_add_f32 v[72:73], v[72:73], v[120:121]
  v_pk_add_f32 v[74:75], v[74:75], v[122:123]
  v_pk_add_f32 v[76:77], v[76:77], v[124:125]
  v_pk_add_f32 v[78:79], v[78:79], v[126:127]
  v_cvt_pk_bf16_f32 v176, v72, v73
  v_cvt_pk_bf16_f32 v177, v74, v75
  v_cvt_pk_bf16_f32 v178, v76, v77
  v_cvt_pk_bf16_f32 v179, v78, v79
  s_nop 1
  v_permlane32_swap_b32 v176, v178
  v_permlane32_swap_b32 v177, v179
  s_nop 1
  v_permlane16_swap_b32 v176, v178
  v_permlane16_swap_b32 v177, v179
  s_movk_i32 s72, 0
  s_mov_b32 s72, 40960
  buffer_store_dwordx4 v[176:179], v3, s[44:47], s72 offen
  s_waitcnt lgkmcnt(0)
  v_pk_add_f32 v[88:89], v[88:89], v[128:129]
L_pad63:
  s_cbranch_execz L_warm_ret
  v_pk_add_f32 v[90:91], v[90:91], v[130:131]
  v_pk_add_f32 v[92:93], v[92:93], v[132:133]
  v_pk_add_f32 v[94:95], v[94:95], v[134:135]
  v_cvt_pk_bf16_f32 v180, v88, v89
  v_cvt_pk_bf16_f32 v181, v90, v91
  v_cvt_pk_bf16_f32 v182, v92, v93
  v_cvt_pk_bf16_f32 v183, v94, v95
  s_nop 1
  v_permlane32_swap_b32 v180, v182
  v_permlane32_swap_b32 v181, v183
  s_nop 1
  v_permlane16_swap_b32 v180, v182
  v_permlane16_swap_b32 v181, v183
  s_movk_i32 s72, 0
  s_mov_b32 s72, 61440
  buffer_store_dwordx4 v[180:183], v3, s[44:47], s72 offen
  s_branch L_efinq
L_ek1q:
  ds_write_b128 v5, v[40:43] offset:0
  ds_write_b128 v5, v[44:47] offset:1024
  ds_write_b128 v5, v[56:59] offset:2048
  ds_write_b128 v5, v[60:63] offset:3072
  ds_write_b128 v5, v[72:75] offset:4096
  ds_write_b128 v5, v[76:79] offset:5120
  ds_write_b128 v5, v[88:91] offset:6144
  ds_write_b128 v5, v[92:95] offset:7168
  s_waitcnt lgkmcnt(0)
  s_barrier
  ds_read_b128 v[104:107], v6 offset:0
  ds_read_b128 v[108:111], v6 offset:1024
  ds_read_b128 v[112:115], v6 offset:2048
  ds_read_b128 v[116:119], v6 offset:3072
  ds_read_b128 v[120:123], v6 offset:4096
  ds_read_b128 v[124:127], v6 offset:5120
  ds_read_b128 v[128:131], v6 offset:6144
  ds_read_b128 v[132:135], v6 offset:7168
L_pad64:
  s_cbranch_execz L_warm_ret
  s_waitcnt lgkmcnt(6)
  v_pk_add_f32 v[48:49], v[48:49], v[104:105]
  v_pk_add_f32 v[50:51], v[50:51], v[106:107]
  v_pk_add_f32 v[52:53], v[52:53], v[108:109]
  v_pk_add_f32 v[54:55], v[54:55], v[110:111]
  v_cvt_pk_bf16_f32 v168, v48, v49
  v_cvt_pk_bf16_f32 v169, v50, v51
  v_cvt_pk_bf16_f32 v170, v52, v53
  v_cvt_pk_bf16_f32 v171, v54, v55
  s_nop 1
  v_permlane32_swap_b32 v168, v170
  v_permlane32_swap_b32 v169, v171
  s_nop 1
  v_permlane16_swap_b32 v168, v170
  v_permlane16_swap_b32 v169, v171
  s_movk_i32 s72, 0
  buffer_store_dwordx4 v[168:171], v3, s[44:47], s72 offen
  s_waitcnt lgkmcnt(4)
  v_pk_add_f32 v[64:65], v[64:65], v[112:113]
  v_pk_add_f32 v[66:67], v[66:67], v[114:115]
  v_pk_add_f32 v[68:69], v[68:69], v[116:117]
  v_pk_add_f32 v[70:71], v[70:71], v[118:119]
  v_cvt_pk_bf16_f32 v172, v64, v65
  v_cvt_pk_bf16_f32 v173, v66, v67
  v_cvt_pk_bf16_f32 v174, v68, v69
  v_cvt_pk_bf16_f32 v175, v70, v71
  s_nop 1
  v_permlane32_swap_b32 v172, v174
  v_permlane32_swap_b32 v173, v175
  s_nop 1
  v_permlane16_swap_b32 v172, v174
  v_permlane16_swap_b32 v173, v175
  s_movk_i32 s72, 20480
  buffer_store_dwordx4 v[172:175], v3, s[44:47], s72 offen
  s_waitcnt lgkmcnt(2)
  v_pk_add_f32 v[80:81], v[80:81], v[120:121]
L_pad65:
  s_cbranch_execz L_warm_ret
  v_pk_add_f32 v[82:83], v[82:83], v[122:123]
  v_pk_add_f32 v[84:85], v[84:85], v[124:125]
  v_pk_add_f32 v[86:87], v[86:87], v[126:127]
  v_cvt_pk_bf16_f32 v176, v80, v81
  v_cvt_pk_bf16_f32 v177, v82, v83
  v_cvt_pk_bf16_f32 v178, v84, v85
  v_cvt_pk_bf16_f32 v179, v86, v87
  s_nop 1
  v_permlane32_swap_b32 v176, v178
  v_permlane32_swap_b32 v177, v179
  s_nop 1
  v_permlane16_swap_b32 v176, v178
  v_permlane16_swap_b32 v177, v179
  s_movk_i32 s72, 0
  s_mov_b32 s72, 40960
  buffer_store_dwordx4 v[176:179], v3, s[44:47], s72 offen
  s_waitcnt lgkmcnt(0)
  v_pk_add_f32 v[96:97], v[96:97], v[128:129]
  v_pk_add_f32 v[98:99], v[98:99], v[130:131]
  v_pk_add_f32 v[100:101], v[100:101], v[132:133]
  v_pk_add_f32 v[102:103], v[102:103], v[134:135]
  v_cvt_pk_bf16_f32 v180, v96, v97
  v_cvt_pk_bf16_f32 v181, v98, v99
  v_cvt_pk_bf16_f32 v182, v100, v101
  v_cvt_pk_bf16_f32 v183, v102, v103
  s_nop 1
  v_permlane32_swap_b32 v180, v182
  v_permlane32_swap_b32 v181, v183
  s_nop 1
  v_permlane16_swap_b32 v180, v182
  v_permlane16_swap_b32 v181, v183
  s_movk_i32 s72, 0
  s_mov_b32 s72, 61440
  buffer_store_dwordx4 v[180:183], v3, s[44:47], s72 offen
L_efinq:
  s_endpgm
L_gu:
  s_mul_i32 s73, s6, 171
  s_lshr_b32 s73, s73, 9
  s_mul_i32 s74, s73, 3
  s_sub_u32 s74, s6, s74
  s_mul_i32 s8, s73, 320
  s_add_u32 s8, s8, 100
  s_lshr_b32 s8, s8, 8
  s_mul_i32 s75, s74, 426
  s_add_u32 s75, s75, 128
  s_lshr_b32 s75, s75, 8
  s_add_u32 s8, s8, s75
  s_and_b32 s75, s5, 1
  s_lshl_b32 s75, s75, 2
  s_add_u32 s76, s75, s73
  s_lshr_b32 s75, s5, 1
  s_mul_i32 s75, s75, 3
  s_add_u32 s74, s74, s75
  s_and_b32 s7, s74, 7
  s_cmp_ge_u32 s8, 5
  s_cselect_b32 s75, 5, 0
  s_sub_u32 s8, s8, s75
  s_lshr_b32 s9, s5, 1
  s_xor_b32 s9, s9, s5
  s_and_b32 s9, s9, 1
  s_mul_i32 s9, s9, 5
  s_mov_b32 s10, s8
  s_mov_b32 s11, s9
  s_add_u32 s69, s8, s9
  s_mul_i32 s70, s69, 196608
  s_lshl_b32 s69, s69, 7
  s_mov_b32 s71, s69
  s_lshr_b32 s72, s4, 1
  s_and_b32 s73, s4, 1
  v_lshrrev_b32 v20, 4, v1
  v_lshlrev_b32 v24, 4, v20
  s_lshl_b32 s77, s4, 2
  v_add_u32 v21, s77, v20
  v_mul_u32_u24 v10, 3072, v21
  s_lshl_b32 s77, s72, 2
  v_or_b32 v20, s77, v20
  v_bfe_u32 v21, v1, 1, 3
  v_xor_b32 v20, v20, v21
  v_lshl_add_u32 v10, v20, 5, v10
  v_and_b32 v20, 1, v1
  v_lshl_add_u32 v10, v20, 4, v10
  s_lshl_b32 s77, s74, 8
  v_add_u32 v10, s77, v10
  v_add_u32 v11, 49152, v10
  v_lshrrev_b32 v21, 4, v1
  s_lshl_b32 s77, s73, 2
  v_add_u32 v21, s77, v21
  v_and_b32 v20, 7, v1
  v_xor_b32 v21, v21, v20
  v_lshlrev_b32 v21, 4, v21
  s_mul_i32 s77, s76, 327680
  v_add_u32 v21, s77, v21
  v_lshrrev_b32 v20, 3, v1
  s_lshl_b32 s77, s4, 3
  s_lshl_b32 s75, s7, 4
  s_xor_b32 s77, s77, s75
  v_add_u32 v20, s77, v20
  s_movk_i32 s75, 1280
  v_mad_u32_u24 v2, v20, s75, v21
  v_xor_b32 v3, 32, v20
  v_mad_u32_u24 v3, v3, s75, v21
  v_xor_b32 v4, 64, v20
  v_mad_u32_u24 v4, v4, s75, v21
  v_xor_b32 v5, 96, v20
  v_mad_u32_u24 v5, v5, s75, v21
  v_xor_b32 v6, 128, v20
  v_mad_u32_u24 v6, v6, s75, v21
  v_xor_b32 v7, 160, v20
  v_mad_u32_u24 v7, v7, s75, v21
  v_xor_b32 v8, 192, v20
  v_mad_u32_u24 v8, v8, s75, v21
  v_xor_b32 v9, 224, v20
  v_mad_u32_u24 v9, v9, s75, v21
  s_waitcnt lgkmcnt(0)
  s_mov_b32 s48, s28
  s_mov_b32 s49, s29
  s_mov_b32 s50, 1966080
  s_mov_b32 s51, 0x20000
  s_mov_b32 s52, s30
  s_mov_b32 s53, s31
  s_mov_b32 s54, 1966080
  s_mov_b32 s55, 0x20000
  s_mov_b32 s40, s16
  s_mov_b32 s41, s17
  s_mov_b32 s42, 2621440
  s_mov_b32 s43, 0x20000
  s_mov_b32 s64, s34
  s_mov_b32 s65, s35
  s_mov_b32 s66, 1280
  s_mov_b32 s67, 0x20000
  s_add_u32 m0, s68, 98304
  s_nop 0
  buffer_load_dwordx4 v10, s[48:51], s70 offen lds
  s_add_u32 m0, s68, 102400
  s_nop 0
  buffer_load_dwordx4 v11, s[48:51], s70 offen lds
  s_add_u32 m0, s68, 106496
  s_nop 0
  buffer_load_dwordx4 v10, s[52:55], s70 offen lds
  s_add_u32 m0, s68, 110592
  s_nop 0
  buffer_load_dwordx4 v11, s[52:55], s70 offen lds
  buffer_load_dwordx4 a[164:167], v24, s[64:67], s71 offen offset:0
  s_add_u32 s70, s70, 98304
  s_add_u32 m0, s68, 0
  s_nop 0
  buffer_load_dwordx4 v2, s[40:43], s69 offen lds
  s_add_u32 m0, s68, 4096
  s_nop 0
  buffer_load_dwordx4 v3, s[40:43], s69 offen lds
  s_add_u32 m0, s68, 8192
  s_nop 0
  buffer_load_dwordx4 v4, s[40:43], s69 offen lds
  s_add_u32 m0, s68, 12288
  s_nop 0
  buffer_load_dwordx4 v5, s[40:43], s69 offen lds
  s_add_u32 m0, s68, 16384
  s_nop 0
  buffer_load_dwordx4 v6, s[40:43], s69 offen lds
  s_add_u32 m0, s68, 20480
  s_nop 0
  buffer_load_dwordx4 v7, s[40:43], s69 offen lds
  s_add_u32 m0, s68, 24576
  s_nop 0
  buffer_load_dwordx4 v8, s[40:43], s69 offen lds
  s_add_u32 m0, s68, 28672
  s_nop 0
  buffer_load_dwordx4 v9, s[40:43], s69 offen lds
  s_add_u32 s8, s8, 1
  s_cmp_eq_u32 s8, 5
  s_cselect_b32 s8, 0, s8
  s_add_u32 s69, s8, s9
  s_lshl_b32 s69, s69, 7
  s_mov_b32 s56, s14
  s_mov_b32 s57, s15
  s_mov_b32 s58, 21037056
  s_mov_b32 s59, 0x20000
  s_mov_b32 s96, s38
  s_mov_b32 s97, s39
  s_mov_b32 s98, 256
  s_mov_b32 s99, 0x20000
  s_add_u32 s75, s76, 16
  s_mul_i32 s75, s75, 512
  s_lshl_b32 s77, s74, 3
  s_add_u32 s75, s75, s77
  s_add_u32 s75, s75, 15745024
  v_lshlrev_b32 v20, 7, v1
  v_add_u32 v0, s75, v20
  v_mov_b32 v20, 2147483632
  v_cmp_gt_u32 vcc, 4, v1
  s_nop 1
  v_cndmask_b32 v0, v20, v0, vcc
  s_lshl_b32 s80, s76, 8
  s_lshl_b32 s75, s72, 7
  s_add_u32 s80, s80, s75
  s_lshl_b32 s75, s7, 4
  s_add_u32 s80, s80, s75
  s_lshl_b32 s78, s80, 3
  s_add_u32 s78, s78, 15728640
  s_lshl_b32 s76, s76, 4
  s_lshl_b32 s75, s72, 3
  s_add_u32 s76, s76, s75
  s_mul_i32 s76, s76, 88
  s_add_u32 s76, s76, 40
  s_lshl_b32 s74, s74, 2
  s_add_u32 s76, s76, s74
  s_lshl_b32 s74, s73, 1
  s_add_u32 s76, s76, s74
  s_lshl_b32 s81, s76, 10
  v_and_b32 v20, 15, v1
  s_lshl_b32 s74, s72, 7
  v_add_u32 v20, s74, v20
  v_lshlrev_b32 v20, 7, v20
  v_lshrrev_b32 v21, 4, v1
  v_bfe_u32 v12, v1, 1, 3
  v_xor_b32 v21, v21, v12
  v_lshl_add_u32 v12, v21, 4, v20
  v_xor_b32 v13, 64, v12
  v_add_u32 v14, 65536, v12
  v_add_u32 v15, 65536, v13
  v_lshrrev_b32 v20, 4, v1
  v_bfe_u32 v21, v1, 2, 2
  v_lshl_add_u32 v16, v20, 3, v21
  v_lshlrev_b32 v16, 8, v16
  v_and_b32 v20, 1, v20
  v_lshl_or_b32 v20, v20, 2, v21
  s_lshl_b32 s74, s73, 2
  v_xor_b32 v20, s74, v20
  v_lshl_add_u32 v16, v20, 5, v16
  v_and_b32 v20, 3, v1
  v_lshl_add_u32 v16, v20, 3, v16
  v_add_u32 v16, 98304, v16
  v_xor_b32 v17, 32, v16
  v_xor_b32 v18, 64, v16
  v_xor_b32 v19, 96, v16
  s_lshl_b32 s77, s2, 2
  s_add_u32 s77, s77, s4
  s_cmp_lg_u32 s77, 0
  s_cbranch_scc1 L_nonce_skip
  s_memrealtime s[74:75]
  s_waitcnt lgkmcnt(0)
  s_lshl_b64 s[74:75], s[74:75], 1
  s_or_b32 s74, s74, 1
  v_mov_b32 v40, s74
  v_mov_b32 v41, s75
  v_lshlrev_b32 v42, 12, v1
  buffer_store_dwordx2 v[40:41], v42, s[96:99], 0 offen sc1
  s_waitcnt vmcnt(0)
L_nonce_skip:
  s_lshl_b32 s74, s6, 2
  s_add_u32 s74, s74, s4
  s_cmp_ge_u32 s74, 24
  s_cselect_b32 s60, s24, s22
  s_cselect_b32 s61, s25, s23
  s_cselect_b32 s75, 24, 0
  s_mov_b32 s62, 819200
  s_mov_b32 s63, 0x20000
  s_sub_u32 s75, s74, s75
  s_mul_i32 s79, s75, 34816
  s_mul_i32 s80, s74, 40960
  s_mov_b32 s44, s32
  s_mov_b32 s45, s33
  s_mov_b32 s46, 1966080
  s_mov_b32 s47, 0x20000
  v_lshlrev_b32 v20, 4, v1
  s_mov_b32 s72, 0xbfb8aa3b
  s_mov_b32 s73, 0xbfb8aa3b
  s_add_u32 m0, s68, 114688
  s_nop 0
  buffer_load_dwordx4 v10, s[48:51], s70 offen lds
  s_add_u32 m0, s68, 118784
  s_nop 0
  buffer_load_dwordx4 v11, s[48:51], s70 offen lds
  s_add_u32 m0, s68, 122880
  s_nop 0
  buffer_load_dwordx4 v10, s[52:55], s70 offen lds
  s_add_u32 m0, s68, 126976
  s_nop 0
  buffer_load_dwordx4 v11, s[52:55], s70 offen lds
  buffer_load_dwordx4 a[168:171], v24, s[64:67], s71 offen offset:64
  s_add_u32 s10, s10, 1
  s_cmp_eq_u32 s10, 5
  s_cselect_b32 s10, 0, s10
  s_add_u32 s71, s10, s11
  s_mul_i32 s70, s71, 196608
  s_lshl_b32 s71, s71, 7
  s_lshl_b32 s77, s6, 2
  s_add_u32 s77, s77, s4
  s_mov_b64 exec, 0
  s_cmp_eq_u32 s77, 0
  s_cbranch_scc1 L_pad0
  s_cmp_eq_u32 s77, 1
  s_cbranch_scc1 L_pad1
  s_cmp_eq_u32 s77, 2
  s_cbranch_scc1 L_pad2
  s_cmp_eq_u32 s77, 3
  s_cbranch_scc1 L_pad3
  s_cmp_eq_u32 s77, 4
  s_cbranch_scc1 L_pad4
  s_cmp_eq_u32 s77, 5
  s_cbranch_scc1 L_pad5
  s_cmp_eq_u32 s77, 6
  s_cbranch_scc1 L_pad6
  s_cmp_eq_u32 s77, 7
  s_cbranch_scc1 L_pad7
  s_cmp_eq_u32 s77, 8
  s_cbranch_scc1 L_pad8
  s_cmp_eq_u32 s77, 9
  s_cbranch_scc1 L_pad9
  s_cmp_eq_u32 s77, 10
  s_cbranch_scc1 L_pad10
  s_cmp_eq_u32 s77, 11
  s_cbranch_scc1 L_pad11
  s_cmp_eq_u32 s77, 12
  s_cbranch_scc1 L_pad12
  s_cmp_eq_u32 s77, 13
  s_cbranch_scc1 L_pad13
  s_cmp_eq_u32 s77, 14
  s_cbranch_scc1 L_pad14
  s_cmp_eq_u32 s77, 15
  s_cbranch_scc1 L_pad15
  s_cmp_eq_u32 s77, 16
  s_cbranch_scc1 L_pad16
  s_cmp_eq_u32 s77, 17
  s_cbranch_scc1 L_pad17
  s_cmp_eq_u32 s77, 18
  s_cbranch_scc1 L_pad18
  s_cmp_eq_u32 s77, 19
  s_cbranch_scc1 L_pad19
  s_cmp_eq_u32 s77, 20
  s_cbranch_scc1 L_pad20
  s_cmp_eq_u32 s77, 21
  s_cbranch_scc1 L_pad21
  s_cmp_eq_u32 s77, 22
  s_cbranch_scc1 L_pad22
  s_cmp_eq_u32 s77, 23
  s_cbranch_scc1 L_pad23
  s_cmp_eq_u32 s77, 24
  s_cbranch_scc1 L_pad24
  s_cmp_eq_u32 s77, 25
  s_cbranch_scc1 L_pad25
  s_cmp_eq_u32 s77, 26
  s_cbranch_scc1 L_pad26
  s_cmp_eq_u32 s77, 27
  s_cbranch_scc1 L_pad27
  s_cmp_eq_u32 s77, 28
  s_cbranch_scc1 L_pad28
  s_cmp_eq_u32 s77, 29
  s_cbranch_scc1 L_pad29
  s_cmp_eq_u32 s77, 30
  s_cbranch_scc1 L_pad30
  s_cmp_eq_u32 s77, 31
  s_cbranch_scc1 L_pad31
  s_cmp_eq_u32 s77, 32
  s_cbranch_scc1 L_pad32
  s_cmp_eq_u32 s77, 33
  s_cbranch_scc1 L_pad33
  s_cmp_eq_u32 s77, 34
  s_cbranch_scc1 L_pad34
  s_cmp_eq_u32 s77, 35
  s_cbranch_scc1 L_pad35
  s_cmp_eq_u32 s77, 36
  s_cbranch_scc1 L_pad36
  s_cmp_eq_u32 s77, 37
  s_cbranch_scc1 L_pad37
  s_cmp_eq_u32 s77, 38
  s_cbranch_scc1 L_pad38
  s_cmp_eq_u32 s77, 39
  s_cbranch_scc1 L_pad39
  s_cmp_eq_u32 s77, 40
  s_cbranch_scc1 L_pad40
  s_cmp_eq_u32 s77, 41
  s_cbranch_scc1 L_pad41
  s_cmp_eq_u32 s77, 42
  s_cbranch_scc1 L_pad42
  s_cmp_eq_u32 s77, 43
  s_cbranch_scc1 L_pad43
  s_cmp_eq_u32 s77, 44
  s_cbranch_scc1 L_pad44
  s_cmp_eq_u32 s77, 45
  s_cbranch_scc1 L_pad45
  s_cmp_eq_u32 s77, 46
  s_cbranch_scc1 L_pad46
  s_cmp_eq_u32 s77, 47
  s_cbranch_scc1 L_pad47
L_warm_ret:
  s_mov_b64 exec, -1
  s_cmp_lt_u32 s6, 12
  s_cbranch_scc0 L_end
  s_waitcnt vmcnt(5)
  s_barrier
  ds_read_b64_tr_b16 a[32:33], v16 offset:0
  ds_read_b64_tr_b16 a[34:35], v16 offset:1024
  ds_read_b128 a[0:3], v12 offset:0
  ds_read_b64_tr_b16 a[36:37], v17 offset:0
  ds_read_b64_tr_b16 a[38:39], v17 offset:1024
  ds_read_b128 a[4:7], v12 offset:2048
  ds_read_b64_tr_b16 a[40:41], v18 offset:0
  ds_read_b64_tr_b16 a[42:43], v18 offset:1024
  ds_read_b128 a[8:11], v12 offset:4096
  ds_read_b64_tr_b16 a[44:45], v19 offset:0
  ds_read_b64_tr_b16 a[46:47], v19 offset:1024
  ds_read_b128 a[12:15], v12 offset:6144
  ds_read_b64_tr_b16 a[48:49], v16 offset:8192
  ds_read_b64_tr_b16 a[50:51], v16 offset:9216
  ds_read_b128 a[16:19], v12 offset:8192
  ds_read_b64_tr_b16 a[52:53], v17 offset:8192
  ds_read_b64_tr_b16 a[54:55], v17 offset:9216
  ds_read_b128 a[20:23], v12 offset:10240
  ds_read_b64_tr_b16 a[56:57], v18 offset:8192
  ds_read_b64_tr_b16 a[58:59], v18 offset:9216
  ds_read_b128 a[24:27], v12 offset:12288
  ds_read_b64_tr_b16 a[60:61], v19 offset:8192
  ds_read_b64_tr_b16 a[62:63], v19 offset:9216
  ds_read_b128 a[28:31], v12 offset:14336
  s_waitcnt lgkmcnt(0)
  v_mfma_f32_16x16x32_bf16 v[32:35], a[32:35], a[0:3], 0
  v_mfma_f32_16x16x32_bf16 v[36:39], a[36:39], a[0:3], 0
  v_mfma_f32_16x16x32_bf16 v[40:43], a[40:43], a[0:3], 0
  v_mfma_f32_16x16x32_bf16 v[44:47], a[44:47], a[0:3], 0
  s_waitcnt vmcnt(0)
  s_barrier
  ds_read_b64_tr_b16 a[96:97], v16 offset:16384
  v_mfma_f32_16x16x32_bf16 v[48:51], a[48:51], a[0:3], 0
  ds_read_b64_tr_b16 a[98:99], v16 offset:17408
  v_mfma_f32_16x16x32_bf16 v[52:55], a[52:55], a[0:3], 0
  ds_read_b128 a[64:67], v13 offset:0
  v_mfma_f32_16x16x32_bf16 v[56:59], a[56:59], a[0:3], 0
  ds_read_b64_tr_b16 a[100:101], v17 offset:16384
  v_mfma_f32_16x16x32_bf16 v[60:63], a[60:63], a[0:3], 0
  v_mfma_f32_16x16x32_bf16 v[92:95], a[60:63], a[4:7], 0
  ds_read_b64_tr_b16 a[102:103], v17 offset:17408
  v_mfma_f32_16x16x32_bf16 v[88:91], a[56:59], a[4:7], 0
  ds_read_b128 a[68:71], v13 offset:2048
  v_mfma_f32_16x16x32_bf16 v[84:87], a[52:55], a[4:7], 0
  ds_read_b64_tr_b16 a[104:105], v18 offset:16384
  v_mfma_f32_16x16x32_bf16 v[80:83], a[48:51], a[4:7], 0
  s_add_u32 m0, s68, 131072
  v_mfma_f32_16x16x32_bf16 v[76:79], a[44:47], a[4:7], 0
  ds_read_b64_tr_b16 a[106:107], v18 offset:17408
  buffer_load_dwordx4 v10, s[48:51], s70 offen lds
  v_mfma_f32_16x16x32_bf16 v[72:75], a[40:43], a[4:7], 0
  ds_read_b128 a[72:75], v13 offset:4096
  v_mfma_f32_16x16x32_bf16 v[68:71], a[36:39], a[4:7], 0
  ds_read_b64_tr_b16 a[108:109], v19 offset:16384
  s_add_u32 m0, s68, 135168
  v_mfma_f32_16x16x32_bf16 v[64:67], a[32:35], a[4:7], 0
  ds_read_b64_tr_b16 a[110:111], v19 offset:17408
  v_mfma_f32_16x16x32_bf16 v[96:99], a[32:35], a[8:11], 0
  buffer_load_dwordx4 v11, s[48:51], s70 offen lds
  v_mfma_f32_16x16x32_bf16 v[100:103], a[36:39], a[8:11], 0
  ds_read_b128 a[76:79], v13 offset:6144
  s_add_u32 m0, s68, 139264
  v_mfma_f32_16x16x32_bf16 v[104:107], a[40:43], a[8:11], 0
  ds_read_b64_tr_b16 a[112:113], v16 offset:24576
  v_mfma_f32_16x16x32_bf16 v[108:111], a[44:47], a[8:11], 0
  ds_read_b64_tr_b16 a[114:115], v16 offset:25600
  buffer_load_dwordx4 v10, s[52:55], s70 offen lds
  v_mfma_f32_16x16x32_bf16 v[112:115], a[48:51], a[8:11], 0
  v_mfma_f32_16x16x32_bf16 v[116:119], a[52:55], a[8:11], 0
  ds_read_b128 a[80:83], v13 offset:8192
  s_add_u32 m0, s68, 143360
  v_mfma_f32_16x16x32_bf16 v[120:123], a[56:59], a[8:11], 0
  ds_read_b64_tr_b16 a[116:117], v17 offset:24576
  buffer_load_dwordx4 v11, s[52:55], s70 offen lds
  v_mfma_f32_16x16x32_bf16 v[124:127], a[60:63], a[8:11], 0
  ds_read_b64_tr_b16 a[118:119], v17 offset:25600
  v_mfma_f32_16x16x32_bf16 v[156:159], a[60:63], a[12:15], 0
  ds_read_b128 a[84:87], v13 offset:10240
  buffer_load_dwordx4 a[172:175], v24, s[64:67], s71 offen offset:0
  v_mfma_f32_16x16x32_bf16 v[152:155], a[56:59], a[12:15], 0
  v_mfma_f32_16x16x32_bf16 v[148:151], a[52:55], a[12:15], 0
  ds_read_b64_tr_b16 a[120:121], v18 offset:24576
  s_add_u32 s70, s70, 98304
  v_mfma_f32_16x16x32_bf16 v[144:147], a[48:51], a[12:15], 0
  ds_read_b64_tr_b16 a[122:123], v18 offset:25600
  v_mfma_f32_16x16x32_bf16 v[140:143], a[44:47], a[12:15], 0
  ds_read_b128 a[88:91], v13 offset:12288
  s_add_u32 m0, s68, 32768
  v_mfma_f32_16x16x32_bf16 v[136:139], a[40:43], a[12:15], 0
  buffer_load_dwordx4 v2, s[40:43], s69 offen lds
  v_mfma_f32_16x16x32_bf16 v[132:135], a[36:39], a[12:15], 0
  ds_read_b64_tr_b16 a[124:125], v19 offset:24576
  v_mfma_f32_16x16x32_bf16 v[128:131], a[32:35], a[12:15], 0
  ds_read_b64_tr_b16 a[126:127], v19 offset:25600
  s_add_u32 m0, s68, 36864
  v_mfma_f32_16x16x32_bf16 v[160:163], a[32:35], a[16:19], 0
  ds_read_b128 a[92:95], v13 offset:14336
  v_mfma_f32_16x16x32_bf16 v[164:167], a[36:39], a[16:19], 0
  buffer_load_dwordx4 v3, s[40:43], s69 offen lds
  v_mfma_f32_16x16x32_bf16 v[168:171], a[40:43], a[16:19], 0
  s_add_u32 m0, s68, 40960
  v_mfma_f32_16x16x32_bf16 v[172:175], a[44:47], a[16:19], 0
  v_mfma_f32_16x16x32_bf16 v[176:179], a[48:51], a[16:19], 0
  buffer_load_dwordx4 v4, s[40:43], s69 offen lds
  v_mfma_f32_16x16x32_bf16 v[180:183], a[52:55], a[16:19], 0
  v_mfma_f32_16x16x32_bf16 v[184:187], a[56:59], a[16:19], 0
  s_add_u32 m0, s68, 45056
  v_mfma_f32_16x16x32_bf16 v[188:191], a[60:63], a[16:19], 0
  v_mfma_f32_16x16x32_bf16 v[220:223], a[60:63], a[20:23], 0
  buffer_load_dwordx4 v5, s[40:43], s69 offen lds
  v_mfma_f32_16x16x32_bf16 v[216:219], a[56:59], a[20:23], 0
  s_add_u32 m0, s68, 49152
  v_mfma_f32_16x16x32_bf16 v[212:215], a[52:55], a[20:23], 0
  v_mfma_f32_16x16x32_bf16 v[208:211], a[48:51], a[20:23], 0
  buffer_load_dwordx4 v6, s[40:43], s69 offen lds
  v_mfma_f32_16x16x32_bf16 v[204:207], a[44:47], a[20:23], 0
  v_mfma_f32_16x16x32_bf16 v[200:203], a[40:43], a[20:23], 0
  s_add_u32 m0, s68, 53248
  v_mfma_f32_16x16x32_bf16 v[196:199], a[36:39], a[20:23], 0
  buffer_load_dwordx4 v7, s[40:43], s69 offen lds
  v_mfma_f32_16x16x32_bf16 v[192:195], a[32:35], a[20:23], 0
  v_mfma_f32_16x16x32_bf16 v[224:227], a[32:35], a[24:27], 0
  s_add_u32 m0, s68, 57344
  v_mfma_f32_16x16x32_bf16 v[228:231], a[36:39], a[24:27], 0
  v_mfma_f32_16x16x32_bf16 v[232:235], a[40:43], a[24:27], 0
  buffer_load_dwordx4 v8, s[40:43], s69 offen lds
  v_mfma_f32_16x16x32_bf16 v[236:239], a[44:47], a[24:27], 0
  v_mfma_f32_16x16x32_bf16 a[128:131], a[48:51], a[24:27], 0
  s_add_u32 m0, s68, 61440
  v_mfma_f32_16x16x32_bf16 a[132:135], a[52:55], a[24:27], 0
  buffer_load_dwordx4 v9, s[40:43], s69 offen lds
  v_mfma_f32_16x16x32_bf16 a[136:139], a[56:59], a[24:27], 0
  v_mfma_f32_16x16x32_bf16 a[140:143], a[60:63], a[24:27], 0
  s_add_u32 s8, s8, 1
  v_mfma_f32_16x16x32_bf16 a[156:159], a[60:63], a[28:31], 0
  v_mfma_f32_16x16x32_bf16 a[152:155], a[56:59], a[28:31], 0
  s_cmp_eq_u32 s8, 5
  v_mfma_f32_16x16x32_bf16 a[148:151], a[52:55], a[28:31], 0
  s_cselect_b32 s8, 0, s8
  v_mfma_f32_16x16x32_bf16 a[144:147], a[48:51], a[28:31], 0
  v_mfma_f32_16x16x32_bf16 v[252:255], a[44:47], a[28:31], 0
  s_add_u32 s69, s8, s9
  v_mfma_f32_16x16x32_bf16 v[248:251], a[40:43], a[28:31], 0
  v_mfma_f32_16x16x32_bf16 v[244:247], a[36:39], a[28:31], 0
  s_lshl_b32 s69, s69, 7
  v_mfma_f32_16x16x32_bf16 v[240:243], a[32:35], a[28:31], 0
  v_mfma_f32_16x16x32_bf16 a[160:163], a[164:167], a[0:3], 0
  s_waitcnt lgkmcnt(0)
  v_mfma_f32_16x16x32_bf16 v[32:35], a[96:99], a[64:67], v[32:35]
  v_mfma_f32_16x16x32_bf16 v[36:39], a[100:103], a[64:67], v[36:39]
  v_mfma_f32_16x16x32_bf16 v[40:43], a[104:107], a[64:67], v[40:43]
  v_mfma_f32_16x16x32_bf16 v[44:47], a[108:111], a[64:67], v[44:47]
  s_waitcnt vmcnt(0)
  s_barrier
  ds_read_b64_tr_b16 a[32:33], v16 offset:32768
  v_mfma_f32_16x16x32_bf16 v[48:51], a[112:115], a[64:67], v[48:51]
  ds_read_b64_tr_b16 a[34:35], v16 offset:33792
  v_mfma_f32_16x16x32_bf16 v[52:55], a[116:119], a[64:67], v[52:55]
  ds_read_b128 a[0:3], v12 offset:32768
  v_mfma_f32_16x16x32_bf16 v[56:59], a[120:123], a[64:67], v[56:59]
  ds_read_b64_tr_b16 a[36:37], v17 offset:32768
  v_mfma_f32_16x16x32_bf16 v[60:63], a[124:127], a[64:67], v[60:63]
  s_add_u32 m0, s68, 147456
  v_mfma_f32_16x16x32_bf16 v[92:95], a[124:127], a[68:71], v[92:95]
  ds_read_b64_tr_b16 a[38:39], v17 offset:33792
  buffer_load_dwordx4 v10, s[48:51], s70 offen lds
  v_mfma_f32_16x16x32_bf16 v[88:91], a[120:123], a[68:71], v[88:91]
  ds_read_b128 a[4:7], v12 offset:34816
  v_mfma_f32_16x16x32_bf16 v[84:87], a[116:119], a[68:71], v[84:87]
  ds_read_b64_tr_b16 a[40:41], v18 offset:32768
  s_add_u32 m0, s68, 151552
  v_mfma_f32_16x16x32_bf16 v[80:83], a[112:115], a[68:71], v[80:83]
  buffer_load_dwordx4 v11, s[48:51], s70 offen lds
  v_mfma_f32_16x16x32_bf16 v[76:79], a[108:111], a[68:71], v[76:79]
  ds_read_b64_tr_b16 a[42:43], v18 offset:33792
  v_mfma_f32_16x16x32_bf16 v[72:75], a[104:107], a[68:71], v[72:75]
  ds_read_b128 a[8:11], v12 offset:36864
  s_add_u32 m0, s68, 155648
  v_mfma_f32_16x16x32_bf16 v[68:71], a[100:103], a[68:71], v[68:71]
  ds_read_b64_tr_b16 a[44:45], v19 offset:32768
  buffer_load_dwordx4 v10, s[52:55], s70 offen lds
  v_mfma_f32_16x16x32_bf16 v[64:67], a[96:99], a[68:71], v[64:67]
  ds_read_b64_tr_b16 a[46:47], v19 offset:33792
  v_mfma_f32_16x16x32_bf16 v[96:99], a[96:99], a[72:75], v[96:99]
  s_add_u32 m0, s68, 159744
  v_mfma_f32_16x16x32_bf16 v[100:103], a[100:103], a[72:75], v[100:103]
  ds_read_b128 a[12:15], v12 offset:38912
  v_mfma_f32_16x16x32_bf16 v[104:107], a[104:107], a[72:75], v[104:107]
  ds_read_b64_tr_b16 a[48:49], v16 offset:40960
  buffer_load_dwordx4 v11, s[52:55], s70 offen lds
  v_mfma_f32_16x16x32_bf16 v[108:111], a[108:111], a[72:75], v[108:111]
  ds_read_b64_tr_b16 a[50:51], v16 offset:41984
  buffer_load_dwordx4 a[176:179], v24, s[64:67], s71 offen offset:64
  v_mfma_f32_16x16x32_bf16 v[112:115], a[112:115], a[72:75], v[112:115]
  v_mfma_f32_16x16x32_bf16 v[116:119], a[116:119], a[72:75], v[116:119]
  ds_read_b128 a[16:19], v12 offset:40960
  s_add_u32 s10, s10, 1
  v_mfma_f32_16x16x32_bf16 v[120:123], a[120:123], a[72:75], v[120:123]
  ds_read_b64_tr_b16 a[52:53], v17 offset:40960
  s_cmp_eq_u32 s10, 5
  v_mfma_f32_16x16x32_bf16 v[124:127], a[124:127], a[72:75], v[124:127]
  ds_read_b64_tr_b16 a[54:55], v17 offset:41984
  v_mfma_f32_16x16x32_bf16 v[156:159], a[124:127], a[76:79], v[156:159]
  ds_read_b128 a[20:23], v12 offset:43008
  s_cselect_b32 s10, 0, s10
  v_mfma_f32_16x16x32_bf16 v[152:155], a[120:123], a[76:79], v[152:155]
  v_mfma_f32_16x16x32_bf16 v[148:151], a[116:119], a[76:79], v[148:151]
  ds_read_b64_tr_b16 a[56:57], v18 offset:40960
  s_add_u32 s71, s10, s11
  v_mfma_f32_16x16x32_bf16 v[144:147], a[112:115], a[76:79], v[144:147]
  ds_read_b64_tr_b16 a[58:59], v18 offset:41984
  s_mul_i32 s70, s71, 196608
  v_mfma_f32_16x16x32_bf16 v[140:143], a[108:111], a[76:79], v[140:143]
  ds_read_b128 a[24:27], v12 offset:45056
  v_mfma_f32_16x16x32_bf16 v[136:139], a[104:107], a[76:79], v[136:139]
  s_lshl_b32 s71, s71, 7
  v_mfma_f32_16x16x32_bf16 v[132:135], a[100:103], a[76:79], v[132:135]
  ds_read_b64_tr_b16 a[60:61], v19 offset:40960
  s_add_u32 m0, s68, 65536
  v_mfma_f32_16x16x32_bf16 v[128:131], a[96:99], a[76:79], v[128:131]
  ds_read_b64_tr_b16 a[62:63], v19 offset:41984
  v_mfma_f32_16x16x32_bf16 v[160:163], a[96:99], a[80:83], v[160:163]
  ds_read_b128 a[28:31], v12 offset:47104
  buffer_load_dwordx4 v2, s[40:43], s69 offen lds
  v_mfma_f32_16x16x32_bf16 v[164:167], a[100:103], a[80:83], v[164:167]
  s_add_u32 m0, s68, 69632
  v_mfma_f32_16x16x32_bf16 v[168:171], a[104:107], a[80:83], v[168:171]
  v_mfma_f32_16x16x32_bf16 v[172:175], a[108:111], a[80:83], v[172:175]
  buffer_load_dwordx4 v3, s[40:43], s69 offen lds
  v_mfma_f32_16x16x32_bf16 v[176:179], a[112:115], a[80:83], v[176:179]
  v_mfma_f32_16x16x32_bf16 v[180:183], a[116:119], a[80:83], v[180:183]
  s_add_u32 m0, s68, 73728
  v_mfma_f32_16x16x32_bf16 v[184:187], a[120:123], a[80:83], v[184:187]
L_pad66:
  s_cbranch_execz L_warm_ret
  buffer_load_dwordx4 v4, s[40:43], s69 offen lds
  v_mfma_f32_16x16x32_bf16 v[188:191], a[124:127], a[80:83], v[188:191]
  v_mfma_f32_16x16x32_bf16 v[220:223], a[124:127], a[84:87], v[220:223]
  s_add_u32 m0, s68, 77824
  v_mfma_f32_16x16x32_bf16 v[216:219], a[120:123], a[84:87], v[216:219]
  buffer_load_dwordx4 v5, s[40:43], s69 offen lds
  v_mfma_f32_16x16x32_bf16 v[212:215], a[116:119], a[84:87], v[212:215]
  v_mfma_f32_16x16x32_bf16 v[208:211], a[112:115], a[84:87], v[208:211]
  s_add_u32 m0, s68, 81920
  v_mfma_f32_16x16x32_bf16 v[204:207], a[108:111], a[84:87], v[204:207]
  v_mfma_f32_16x16x32_bf16 v[200:203], a[104:107], a[84:87], v[200:203]
  buffer_load_dwordx4 v6, s[40:43], s69 offen lds
  v_mfma_f32_16x16x32_bf16 v[196:199], a[100:103], a[84:87], v[196:199]
  s_add_u32 m0, s68, 86016
  v_mfma_f32_16x16x32_bf16 v[192:195], a[96:99], a[84:87], v[192:195]
  v_mfma_f32_16x16x32_bf16 v[224:227], a[96:99], a[88:91], v[224:227]
  buffer_load_dwordx4 v7, s[40:43], s69 offen lds
  v_mfma_f32_16x16x32_bf16 v[228:231], a[100:103], a[88:91], v[228:231]
  s_add_u32 m0, s68, 90112
  v_mfma_f32_16x16x32_bf16 v[232:235], a[104:107], a[88:91], v[232:235]
  v_mfma_f32_16x16x32_bf16 v[236:239], a[108:111], a[88:91], v[236:239]
  buffer_load_dwordx4 v8, s[40:43], s69 offen lds
  v_mfma_f32_16x16x32_bf16 a[128:131], a[112:115], a[88:91], a[128:131]
  s_add_u32 m0, s68, 94208
  v_mfma_f32_16x16x32_bf16 a[132:135], a[116:119], a[88:91], a[132:135]
  v_mfma_f32_16x16x32_bf16 a[136:139], a[120:123], a[88:91], a[136:139]
  buffer_load_dwordx4 v9, s[40:43], s69 offen lds
  v_mfma_f32_16x16x32_bf16 a[140:143], a[124:127], a[88:91], a[140:143]
  v_mfma_f32_16x16x32_bf16 a[156:159], a[124:127], a[92:95], a[156:159]
  s_add_u32 s8, s8, 1
  v_mfma_f32_16x16x32_bf16 a[152:155], a[120:123], a[92:95], a[152:155]
  s_cmp_eq_u32 s8, 5
  v_mfma_f32_16x16x32_bf16 a[148:151], a[116:119], a[92:95], a[148:151]
  v_mfma_f32_16x16x32_bf16 a[144:147], a[112:115], a[92:95], a[144:147]
  s_cselect_b32 s8, 0, s8
  v_mfma_f32_16x16x32_bf16 v[252:255], a[108:111], a[92:95], v[252:255]
  s_add_u32 s69, s8, s9
  v_mfma_f32_16x16x32_bf16 v[248:251], a[104:107], a[92:95], v[248:251]
  v_mfma_f32_16x16x32_bf16 v[244:247], a[100:103], a[92:95], v[244:247]
  s_lshl_b32 s69, s69, 7
  v_mfma_f32_16x16x32_bf16 v[240:243], a[96:99], a[92:95], v[240:243]
  v_mfma_f32_16x16x32_bf16 a[160:163], a[168:171], a[64:67], a[160:163]
  s_waitcnt lgkmcnt(0)
  v_mfma_f32_16x16x32_bf16 v[32:35], a[32:35], a[0:3], v[32:35]
  v_mfma_f32_16x16x32_bf16 v[36:39], a[36:39], a[0:3], v[36:39]
  v_mfma_f32_16x16x32_bf16 v[40:43], a[40:43], a[0:3], v[40:43]
  v_mfma_f32_16x16x32_bf16 v[44:47], a[44:47], a[0:3], v[44:47]
  s_waitcnt vmcnt(8)
  s_barrier
  ds_read_b64_tr_b16 a[96:97], v16 offset:49152
  v_mfma_f32_16x16x32_bf16 v[48:51], a[48:51], a[0:3], v[48:51]
  ds_read_b64_tr_b16 a[98:99], v16 offset:50176
  v_mfma_f32_16x16x32_bf16 v[52:55], a[52:55], a[0:3], v[52:55]
  ds_read_b128 a[64:67], v13 offset:32768
  v_mfma_f32_16x16x32_bf16 v[56:59], a[56:59], a[0:3], v[56:59]
  ds_read_b64_tr_b16 a[100:101], v17 offset:49152
  v_mfma_f32_16x16x32_bf16 v[60:63], a[60:63], a[0:3], v[60:63]
  v_mfma_f32_16x16x32_bf16 v[92:95], a[60:63], a[4:7], v[92:95]
  ds_read_b64_tr_b16 a[102:103], v17 offset:50176
  v_mfma_f32_16x16x32_bf16 v[88:91], a[56:59], a[4:7], v[88:91]
  ds_read_b128 a[68:71], v13 offset:34816
  v_mfma_f32_16x16x32_bf16 v[84:87], a[52:55], a[4:7], v[84:87]
  ds_read_b64_tr_b16 a[104:105], v18 offset:49152
  v_mfma_f32_16x16x32_bf16 v[80:83], a[48:51], a[4:7], v[80:83]
  s_add_u32 m0, s68, 98304
  v_mfma_f32_16x16x32_bf16 v[76:79], a[44:47], a[4:7], v[76:79]
  ds_read_b64_tr_b16 a[106:107], v18 offset:50176
  buffer_load_dwordx4 v10, s[48:51], s70 offen lds
  v_mfma_f32_16x16x32_bf16 v[72:75], a[40:43], a[4:7], v[72:75]
  ds_read_b128 a[72:75], v13 offset:36864
  v_mfma_f32_16x16x32_bf16 v[68:71], a[36:39], a[4:7], v[68:71]
  ds_read_b64_tr_b16 a[108:109], v19 offset:49152
  s_add_u32 m0, s68, 102400
  v_mfma_f32_16x16x32_bf16 v[64:67], a[32:35], a[4:7], v[64:67]
  ds_read_b64_tr_b16 a[110:111], v19 offset:50176
  v_mfma_f32_16x16x32_bf16 v[96:99], a[32:35], a[8:11], v[96:99]
  buffer_load_dwordx4 v11, s[48:51], s70 offen lds
  v_mfma_f32_16x16x32_bf16 v[100:103], a[36:39], a[8:11], v[100:103]
  ds_read_b128 a[76:79], v13 offset:38912
  s_add_u32 m0, s68, 106496
  v_mfma_f32_16x16x32_bf16 v[104:107], a[40:43], a[8:11], v[104:107]
  ds_read_b64_tr_b16 a[112:113], v16 offset:57344
  v_mfma_f32_16x16x32_bf16 v[108:111], a[44:47], a[8:11], v[108:111]
  ds_read_b64_tr_b16 a[114:115], v16 offset:58368
  buffer_load_dwordx4 v10, s[52:55], s70 offen lds
  v_mfma_f32_16x16x32_bf16 v[112:115], a[48:51], a[8:11], v[112:115]
  v_mfma_f32_16x16x32_bf16 v[116:119], a[52:55], a[8:11], v[116:119]
  ds_read_b128 a[80:83], v13 offset:40960
  s_add_u32 m0, s68, 110592
  v_mfma_f32_16x16x32_bf16 v[120:123], a[56:59], a[8:11], v[120:123]
  ds_read_b64_tr_b16 a[116:117], v17 offset:57344
  buffer_load_dwordx4 v11, s[52:55], s70 offen lds
  v_mfma_f32_16x16x32_bf16 v[124:127], a[60:63], a[8:11], v[124:127]
  ds_read_b64_tr_b16 a[118:119], v17 offset:58368
  v_mfma_f32_16x16x32_bf16 v[156:159], a[60:63], a[12:15], v[156:159]
  ds_read_b128 a[84:87], v13 offset:43008
  buffer_load_dwordx4 a[180:183], v24, s[64:67], s71 offen offset:0
  v_mfma_f32_16x16x32_bf16 v[152:155], a[56:59], a[12:15], v[152:155]
  v_mfma_f32_16x16x32_bf16 v[148:151], a[52:55], a[12:15], v[148:151]
  ds_read_b64_tr_b16 a[120:121], v18 offset:57344
  s_add_u32 s70, s70, 98304
  v_mfma_f32_16x16x32_bf16 v[144:147], a[48:51], a[12:15], v[144:147]
  ds_read_b64_tr_b16 a[122:123], v18 offset:58368
  v_mfma_f32_16x16x32_bf16 v[140:143], a[44:47], a[12:15], v[140:143]
  ds_read_b128 a[88:91], v13 offset:45056
  s_add_u32 m0, s68, 114688
  v_mfma_f32_16x16x32_bf16 v[136:139], a[40:43], a[12:15], v[136:139]
  buffer_load_dwordx4 v10, s[48:51], s70 offen lds
  v_mfma_f32_16x16x32_bf16 v[132:135], a[36:39], a[12:15], v[132:135]
  ds_read_b64_tr_b16 a[124:125], v19 offset:57344
  v_mfma_f32_16x16x32_bf16 v[128:131], a[32:35], a[12:15], v[128:131]
  ds_read_b64_tr_b16 a[126:127], v19 offset:58368
  s_add_u32 m0, s68, 118784
  v_mfma_f32_16x16x32_bf16 v[160:163], a[32:35], a[16:19], v[160:163]
  ds_read_b128 a[92:95], v13 offset:47104
  v_mfma_f32_16x16x32_bf16 v[164:167], a[36:39], a[16:19], v[164:167]
  buffer_load_dwordx4 v11, s[48:51], s70 offen lds
  v_mfma_f32_16x16x32_bf16 v[168:171], a[40:43], a[16:19], v[168:171]
  s_add_u32 m0, s68, 122880
  v_mfma_f32_16x16x32_bf16 v[172:175], a[44:47], a[16:19], v[172:175]
  v_mfma_f32_16x16x32_bf16 v[176:179], a[48:51], a[16:19], v[176:179]
  buffer_load_dwordx4 v10, s[52:55], s70 offen lds
  v_mfma_f32_16x16x32_bf16 v[180:183], a[52:55], a[16:19], v[180:183]
  v_mfma_f32_16x16x32_bf16 v[184:187], a[56:59], a[16:19], v[184:187]
  s_add_u32 m0, s68, 126976
  v_mfma_f32_16x16x32_bf16 v[188:191], a[60:63], a[16:19], v[188:191]
  v_mfma_f32_16x16x32_bf16 v[220:223], a[60:63], a[20:23], v[220:223]
  buffer_load_dwordx4 v11, s[52:55], s70 offen lds
  v_mfma_f32_16x16x32_bf16 v[216:219], a[56:59], a[20:23], v[216:219]
  buffer_load_dwordx4 a[184:187], v24, s[64:67], s71 offen offset:64
  v_mfma_f32_16x16x32_bf16 v[212:215], a[52:55], a[20:23], v[212:215]
  v_mfma_f32_16x16x32_bf16 v[208:211], a[48:51], a[20:23], v[208:211]
  s_add_u32 s10, s10, 1
  v_mfma_f32_16x16x32_bf16 v[204:207], a[44:47], a[20:23], v[204:207]
  v_mfma_f32_16x16x32_bf16 v[200:203], a[40:43], a[20:23], v[200:203]
  s_cmp_eq_u32 s10, 5
  v_mfma_f32_16x16x32_bf16 v[196:199], a[36:39], a[20:23], v[196:199]
  s_cselect_b32 s10, 0, s10
  v_mfma_f32_16x16x32_bf16 v[192:195], a[32:35], a[20:23], v[192:195]
  v_mfma_f32_16x16x32_bf16 v[224:227], a[32:35], a[24:27], v[224:227]
  s_add_u32 s71, s10, s11
  v_mfma_f32_16x16x32_bf16 v[228:231], a[36:39], a[24:27], v[228:231]
  v_mfma_f32_16x16x32_bf16 v[232:235], a[40:43], a[24:27], v[232:235]
  s_mul_i32 s70, s71, 196608
  v_mfma_f32_16x16x32_bf16 v[236:239], a[44:47], a[24:27], v[236:239]
  v_mfma_f32_16x16x32_bf16 a[128:131], a[48:51], a[24:27], a[128:131]
  s_lshl_b32 s71, s71, 7
  v_mfma_f32_16x16x32_bf16 a[132:135], a[52:55], a[24:27], a[132:135]
  s_add_u32 m0, s68, 0
  v_mfma_f32_16x16x32_bf16 a[136:139], a[56:59], a[24:27], a[136:139]
  v_mfma_f32_16x16x32_bf16 a[140:143], a[60:63], a[24:27], a[140:143]
  buffer_load_dwordx4 v2, s[40:43], s69 offen lds
  v_mfma_f32_16x16x32_bf16 a[156:159], a[60:63], a[28:31], a[156:159]
  v_mfma_f32_16x16x32_bf16 a[152:155], a[56:59], a[28:31], a[152:155]
  s_add_u32 m0, s68, 4096
  v_mfma_f32_16x16x32_bf16 a[148:151], a[52:55], a[28:31], a[148:151]
  buffer_load_dwordx4 v3, s[40:43], s69 offen lds
  v_mfma_f32_16x16x32_bf16 a[144:147], a[48:51], a[28:31], a[144:147]
  v_mfma_f32_16x16x32_bf16 v[252:255], a[44:47], a[28:31], v[252:255]
  s_add_u32 m0, s68, 8192
  v_mfma_f32_16x16x32_bf16 v[248:251], a[40:43], a[28:31], v[248:251]
  v_mfma_f32_16x16x32_bf16 v[244:247], a[36:39], a[28:31], v[244:247]
  buffer_load_dwordx4 v4, s[40:43], s69 offen lds
  v_mfma_f32_16x16x32_bf16 v[240:243], a[32:35], a[28:31], v[240:243]
  v_mfma_f32_16x16x32_bf16 a[160:163], a[172:175], a[0:3], a[160:163]
  s_waitcnt lgkmcnt(0)
  v_mfma_f32_16x16x32_bf16 v[32:35], a[96:99], a[64:67], v[32:35]
  v_mfma_f32_16x16x32_bf16 v[36:39], a[100:103], a[64:67], v[36:39]
  v_mfma_f32_16x16x32_bf16 v[40:43], a[104:107], a[64:67], v[40:43]
  v_mfma_f32_16x16x32_bf16 v[44:47], a[108:111], a[64:67], v[44:47]
  s_waitcnt vmcnt(8)
  s_barrier
  ds_read_b64_tr_b16 a[32:33], v16 offset:0
  v_mfma_f32_16x16x32_bf16 v[48:51], a[112:115], a[64:67], v[48:51]
  ds_read_b64_tr_b16 a[34:35], v16 offset:1024
  v_mfma_f32_16x16x32_bf16 v[52:55], a[116:119], a[64:67], v[52:55]
  ds_read_b128 a[0:3], v14 offset:0
  v_mfma_f32_16x16x32_bf16 v[56:59], a[120:123], a[64:67], v[56:59]
  ds_read_b64_tr_b16 a[36:37], v17 offset:0
  v_mfma_f32_16x16x32_bf16 v[60:63], a[124:127], a[64:67], v[60:63]
  v_mfma_f32_16x16x32_bf16 v[92:95], a[124:127], a[68:71], v[92:95]
  ds_read_b64_tr_b16 a[38:39], v17 offset:1024
  v_mfma_f32_16x16x32_bf16 v[88:91], a[120:123], a[68:71], v[88:91]
  ds_read_b128 a[4:7], v14 offset:2048
  v_mfma_f32_16x16x32_bf16 v[84:87], a[116:119], a[68:71], v[84:87]
  ds_read_b64_tr_b16 a[40:41], v18 offset:0
  v_mfma_f32_16x16x32_bf16 v[80:83], a[112:115], a[68:71], v[80:83]
  s_add_u32 m0, s68, 12288
  v_mfma_f32_16x16x32_bf16 v[76:79], a[108:111], a[68:71], v[76:79]
  ds_read_b64_tr_b16 a[42:43], v18 offset:1024
  buffer_load_dwordx4 v5, s[40:43], s69 offen lds
  v_mfma_f32_16x16x32_bf16 v[72:75], a[104:107], a[68:71], v[72:75]
  ds_read_b128 a[8:11], v14 offset:4096
  v_mfma_f32_16x16x32_bf16 v[68:71], a[100:103], a[68:71], v[68:71]
  ds_read_b64_tr_b16 a[44:45], v19 offset:0
  s_add_u32 m0, s68, 131072
  v_mfma_f32_16x16x32_bf16 v[64:67], a[96:99], a[68:71], v[64:67]
  ds_read_b64_tr_b16 a[46:47], v19 offset:1024
  v_mfma_f32_16x16x32_bf16 v[96:99], a[96:99], a[72:75], v[96:99]
  buffer_load_dwordx4 v10, s[48:51], s70 offen lds
  v_mfma_f32_16x16x32_bf16 v[100:103], a[100:103], a[72:75], v[100:103]
  ds_read_b128 a[12:15], v14 offset:6144
  s_add_u32 m0, s68, 135168
  v_mfma_f32_16x16x32_bf16 v[104:107], a[104:107], a[72:75], v[104:107]
  ds_read_b64_tr_b16 a[48:49], v16 offset:8192
  v_mfma_f32_16x16x32_bf16 v[108:111], a[108:111], a[72:75], v[108:111]
  ds_read_b64_tr_b16 a[50:51], v16 offset:9216
  buffer_load_dwordx4 v11, s[48:51], s70 offen lds
  v_mfma_f32_16x16x32_bf16 v[112:115], a[112:115], a[72:75], v[112:115]
  v_mfma_f32_16x16x32_bf16 v[116:119], a[116:119], a[72:75], v[116:119]
  ds_read_b128 a[16:19], v14 offset:8192
  s_add_u32 m0, s68, 139264
  v_mfma_f32_16x16x32_bf16 v[120:123], a[120:123], a[72:75], v[120:123]
  ds_read_b64_tr_b16 a[52:53], v17 offset:8192
  buffer_load_dwordx4 v10, s[52:55], s70 offen lds
  v_mfma_f32_16x16x32_bf16 v[124:127], a[124:127], a[72:75], v[124:127]
  ds_read_b64_tr_b16 a[54:55], v17 offset:9216
  v_mfma_f32_16x16x32_bf16 v[156:159], a[124:127], a[76:79], v[156:159]
  ds_read_b128 a[20:23], v14 offset:10240
  s_add_u32 m0, s68, 143360
  v_mfma_f32_16x16x32_bf16 v[152:155], a[120:123], a[76:79], v[152:155]
  v_mfma_f32_16x16x32_bf16 v[148:151], a[116:119], a[76:79], v[148:151]
  ds_read_b64_tr_b16 a[56:57], v18 offset:8192
  buffer_load_dwordx4 v11, s[52:55], s70 offen lds
  v_mfma_f32_16x16x32_bf16 v[144:147], a[112:115], a[76:79], v[144:147]
  ds_read_b64_tr_b16 a[58:59], v18 offset:9216
  v_mfma_f32_16x16x32_bf16 v[140:143], a[108:111], a[76:79], v[140:143]
  ds_read_b128 a[24:27], v14 offset:12288
  buffer_load_dwordx4 a[164:167], v24, s[64:67], s71 offen offset:0
  v_mfma_f32_16x16x32_bf16 v[136:139], a[104:107], a[76:79], v[136:139]
  s_add_u32 s70, s70, 98304
  v_mfma_f32_16x16x32_bf16 v[132:135], a[100:103], a[76:79], v[132:135]
  ds_read_b64_tr_b16 a[60:61], v19 offset:8192
  v_mfma_f32_16x16x32_bf16 v[128:131], a[96:99], a[76:79], v[128:131]
  ds_read_b64_tr_b16 a[62:63], v19 offset:9216
  s_add_u32 m0, s68, 16384
  v_mfma_f32_16x16x32_bf16 v[160:163], a[96:99], a[80:83], v[160:163]
  ds_read_b128 a[28:31], v14 offset:14336
  v_mfma_f32_16x16x32_bf16 v[164:167], a[100:103], a[80:83], v[164:167]
  buffer_load_dwordx4 v6, s[40:43], s69 offen lds
  v_mfma_f32_16x16x32_bf16 v[168:171], a[104:107], a[80:83], v[168:171]
  s_add_u32 m0, s68, 20480
  v_mfma_f32_16x16x32_bf16 v[172:175], a[108:111], a[80:83], v[172:175]
  v_mfma_f32_16x16x32_bf16 v[176:179], a[112:115], a[80:83], v[176:179]
  buffer_load_dwordx4 v7, s[40:43], s69 offen lds
  v_mfma_f32_16x16x32_bf16 v[180:183], a[116:119], a[80:83], v[180:183]
  v_mfma_f32_16x16x32_bf16 v[184:187], a[120:123], a[80:83], v[184:187]
  s_add_u32 m0, s68, 24576
  v_mfma_f32_16x16x32_bf16 v[188:191], a[124:127], a[80:83], v[188:191]
  v_mfma_f32_16x16x32_bf16 v[220:223], a[124:127], a[84:87], v[220:223]
  buffer_load_dwordx4 v8, s[40:43], s69 offen lds
  v_mfma_f32_16x16x32_bf16 v[216:219], a[120:123], a[84:87], v[216:219]
  s_add_u32 m0, s68, 28672
  v_mfma_f32_16x16x32_bf16 v[212:215], a[116:119], a[84:87], v[212:215]
  v_mfma_f32_16x16x32_bf16 v[208:211], a[112:115], a[84:87], v[208:211]
  buffer_load_dwordx4 v9, s[40:43], s69 offen lds
  v_mfma_f32_16x16x32_bf16 v[204:207], a[108:111], a[84:87], v[204:207]
  v_mfma_f32_16x16x32_bf16 v[200:203], a[104:107], a[84:87], v[200:203]
  s_add_u32 s8, s8, 1
  v_mfma_f32_16x16x32_bf16 v[196:199], a[100:103], a[84:87], v[196:199]
  s_cmp_eq_u32 s8, 5
  v_mfma_f32_16x16x32_bf16 v[192:195], a[96:99], a[84:87], v[192:195]
  v_mfma_f32_16x16x32_bf16 v[224:227], a[96:99], a[88:91], v[224:227]
  s_cselect_b32 s8, 0, s8
  v_mfma_f32_16x16x32_bf16 v[228:231], a[100:103], a[88:91], v[228:231]
  v_mfma_f32_16x16x32_bf16 v[232:235], a[104:107], a[88:91], v[232:235]
L_pad67:
  s_cbranch_execz L_warm_ret
  s_add_u32 s69, s8, s9
  v_mfma_f32_16x16x32_bf16 v[236:239], a[108:111], a[88:91], v[236:239]
  v_mfma_f32_16x16x32_bf16 a[128:131], a[112:115], a[88:91], a[128:131]
  s_lshl_b32 s69, s69, 7
  v_mfma_f32_16x16x32_bf16 a[132:135], a[116:119], a[88:91], a[132:135]
  s_add_u32 m0, s68, 147456
  v_mfma_f32_16x16x32_bf16 a[136:139], a[120:123], a[88:91], a[136:139]
  v_mfma_f32_16x16x32_bf16 a[140:143], a[124:127], a[88:91], a[140:143]
  buffer_load_dwordx4 v10, s[48:51], s70 offen lds
  v_mfma_f32_16x16x32_bf16 a[156:159], a[124:127], a[92:95], a[156:159]
  v_mfma_f32_16x16x32_bf16 a[152:155], a[120:123], a[92:95], a[152:155]
  s_add_u32 m0, s68, 151552
  v_mfma_f32_16x16x32_bf16 a[148:151], a[116:119], a[92:95], a[148:151]
  buffer_load_dwordx4 v11, s[48:51], s70 offen lds
  v_mfma_f32_16x16x32_bf16 a[144:147], a[112:115], a[92:95], a[144:147]
  v_mfma_f32_16x16x32_bf16 v[252:255], a[108:111], a[92:95], v[252:255]
  s_add_u32 m0, s68, 155648
  v_mfma_f32_16x16x32_bf16 v[248:251], a[104:107], a[92:95], v[248:251]
  v_mfma_f32_16x16x32_bf16 v[244:247], a[100:103], a[92:95], v[244:247]
  buffer_load_dwordx4 v10, s[52:55], s70 offen lds
  v_mfma_f32_16x16x32_bf16 v[240:243], a[96:99], a[92:95], v[240:243]
  v_mfma_f32_16x16x32_bf16 a[160:163], a[176:179], a[64:67], a[160:163]
  s_waitcnt lgkmcnt(0)
  v_mfma_f32_16x16x32_bf16 v[32:35], a[32:35], a[0:3], v[32:35]
  v_mfma_f32_16x16x32_bf16 v[36:39], a[36:39], a[0:3], v[36:39]
  v_mfma_f32_16x16x32_bf16 v[40:43], a[40:43], a[0:3], v[40:43]
  v_mfma_f32_16x16x32_bf16 v[44:47], a[44:47], a[0:3], v[44:47]
  s_waitcnt vmcnt(16)
  s_barrier
  ds_read_b64_tr_b16 a[96:97], v16 offset:16384
  v_mfma_f32_16x16x32_bf16 v[48:51], a[48:51], a[0:3], v[48:51]
  ds_read_b64_tr_b16 a[98:99], v16 offset:17408
  v_mfma_f32_16x16x32_bf16 v[52:55], a[52:55], a[0:3], v[52:55]
  ds_read_b128 a[64:67], v15 offset:0
  v_mfma_f32_16x16x32_bf16 v[56:59], a[56:59], a[0:3], v[56:59]
  ds_read_b64_tr_b16 a[100:101], v17 offset:16384
  v_mfma_f32_16x16x32_bf16 v[60:63], a[60:63], a[0:3], v[60:63]
  v_mfma_f32_16x16x32_bf16 v[92:95], a[60:63], a[4:7], v[92:95]
  ds_read_b64_tr_b16 a[102:103], v17 offset:17408
  v_mfma_f32_16x16x32_bf16 v[88:91], a[56:59], a[4:7], v[88:91]
  ds_read_b128 a[68:71], v15 offset:2048
  v_mfma_f32_16x16x32_bf16 v[84:87], a[52:55], a[4:7], v[84:87]
  ds_read_b64_tr_b16 a[104:105], v18 offset:16384
  v_mfma_f32_16x16x32_bf16 v[80:83], a[48:51], a[4:7], v[80:83]
  s_add_u32 m0, s68, 159744
  v_mfma_f32_16x16x32_bf16 v[76:79], a[44:47], a[4:7], v[76:79]
  ds_read_b64_tr_b16 a[106:107], v18 offset:17408
  buffer_load_dwordx4 v11, s[52:55], s70 offen lds
  v_mfma_f32_16x16x32_bf16 v[72:75], a[40:43], a[4:7], v[72:75]
  ds_read_b128 a[72:75], v15 offset:4096
  v_mfma_f32_16x16x32_bf16 v[68:71], a[36:39], a[4:7], v[68:71]
  ds_read_b64_tr_b16 a[108:109], v19 offset:16384
  buffer_load_dwordx4 a[168:171], v24, s[64:67], s71 offen offset:64
  v_mfma_f32_16x16x32_bf16 v[64:67], a[32:35], a[4:7], v[64:67]
  ds_read_b64_tr_b16 a[110:111], v19 offset:17408
  v_mfma_f32_16x16x32_bf16 v[96:99], a[32:35], a[8:11], v[96:99]
  s_add_u32 s10, s10, 1
  v_mfma_f32_16x16x32_bf16 v[100:103], a[36:39], a[8:11], v[100:103]
  ds_read_b128 a[76:79], v15 offset:6144
  s_cmp_eq_u32 s10, 5
  v_mfma_f32_16x16x32_bf16 v[104:107], a[40:43], a[8:11], v[104:107]
  ds_read_b64_tr_b16 a[112:113], v16 offset:24576
  v_mfma_f32_16x16x32_bf16 v[108:111], a[44:47], a[8:11], v[108:111]
  ds_read_b64_tr_b16 a[114:115], v16 offset:25600
  s_cselect_b32 s10, 0, s10
  v_mfma_f32_16x16x32_bf16 v[112:115], a[48:51], a[8:11], v[112:115]
  v_mfma_f32_16x16x32_bf16 v[116:119], a[52:55], a[8:11], v[116:119]
  ds_read_b128 a[80:83], v15 offset:8192
  s_add_u32 s71, s10, s11
  v_mfma_f32_16x16x32_bf16 v[120:123], a[56:59], a[8:11], v[120:123]
  ds_read_b64_tr_b16 a[116:117], v17 offset:24576
  s_mul_i32 s70, s71, 196608
  v_mfma_f32_16x16x32_bf16 v[124:127], a[60:63], a[8:11], v[124:127]
  ds_read_b64_tr_b16 a[118:119], v17 offset:25600
  v_mfma_f32_16x16x32_bf16 v[156:159], a[60:63], a[12:15], v[156:159]
  ds_read_b128 a[84:87], v15 offset:10240
  s_lshl_b32 s71, s71, 7
  v_mfma_f32_16x16x32_bf16 v[152:155], a[56:59], a[12:15], v[152:155]
  v_mfma_f32_16x16x32_bf16 v[148:151], a[52:55], a[12:15], v[148:151]
  ds_read_b64_tr_b16 a[120:121], v18 offset:24576
  s_add_u32 m0, s68, 32768
  v_mfma_f32_16x16x32_bf16 v[144:147], a[48:51], a[12:15], v[144:147]
  ds_read_b64_tr_b16 a[122:123], v18 offset:25600
  v_mfma_f32_16x16x32_bf16 v[140:143], a[44:47], a[12:15], v[140:143]
  ds_read_b128 a[88:91], v15 offset:12288
  buffer_load_dwordx4 v2, s[40:43], s69 offen lds
  v_mfma_f32_16x16x32_bf16 v[136:139], a[40:43], a[12:15], v[136:139]
  s_add_u32 m0, s68, 36864
  v_mfma_f32_16x16x32_bf16 v[132:135], a[36:39], a[12:15], v[132:135]
  ds_read_b64_tr_b16 a[124:125], v19 offset:24576
  v_mfma_f32_16x16x32_bf16 v[128:131], a[32:35], a[12:15], v[128:131]
  ds_read_b64_tr_b16 a[126:127], v19 offset:25600
  buffer_load_dwordx4 v3, s[40:43], s69 offen lds
  v_mfma_f32_16x16x32_bf16 v[160:163], a[32:35], a[16:19], v[160:163]
  ds_read_b128 a[92:95], v15 offset:14336
  v_mfma_f32_16x16x32_bf16 v[164:167], a[36:39], a[16:19], v[164:167]
  s_add_u32 m0, s68, 40960
  v_mfma_f32_16x16x32_bf16 v[168:171], a[40:43], a[16:19], v[168:171]
  buffer_load_dwordx4 v4, s[40:43], s69 offen lds
  v_mfma_f32_16x16x32_bf16 v[172:175], a[44:47], a[16:19], v[172:175]
  v_mfma_f32_16x16x32_bf16 v[176:179], a[48:51], a[16:19], v[176:179]
  s_add_u32 m0, s68, 45056
  v_mfma_f32_16x16x32_bf16 v[180:183], a[52:55], a[16:19], v[180:183]
  v_mfma_f32_16x16x32_bf16 v[184:187], a[56:59], a[16:19], v[184:187]
  buffer_load_dwordx4 v5, s[40:43], s69 offen lds
  v_mfma_f32_16x16x32_bf16 v[188:191], a[60:63], a[16:19], v[188:191]
  v_mfma_f32_16x16x32_bf16 v[220:223], a[60:63], a[20:23], v[220:223]
  s_add_u32 m0, s68, 98304
  v_mfma_f32_16x16x32_bf16 v[216:219], a[56:59], a[20:23], v[216:219]
  buffer_load_dwordx4 v10, s[48:51], s70 offen lds
  v_mfma_f32_16x16x32_bf16 v[212:215], a[52:55], a[20:23], v[212:215]
  v_mfma_f32_16x16x32_bf16 v[208:211], a[48:51], a[20:23], v[208:211]
  s_add_u32 m0, s68, 102400
  v_mfma_f32_16x16x32_bf16 v[204:207], a[44:47], a[20:23], v[204:207]
  v_mfma_f32_16x16x32_bf16 v[200:203], a[40:43], a[20:23], v[200:203]
  buffer_load_dwordx4 v11, s[48:51], s70 offen lds
  v_mfma_f32_16x16x32_bf16 v[196:199], a[36:39], a[20:23], v[196:199]
  s_add_u32 m0, s68, 106496
  v_mfma_f32_16x16x32_bf16 v[192:195], a[32:35], a[20:23], v[192:195]
  v_mfma_f32_16x16x32_bf16 v[224:227], a[32:35], a[24:27], v[224:227]
  buffer_load_dwordx4 v10, s[52:55], s70 offen lds
  v_mfma_f32_16x16x32_bf16 v[228:231], a[36:39], a[24:27], v[228:231]
  v_mfma_f32_16x16x32_bf16 v[232:235], a[40:43], a[24:27], v[232:235]
  s_add_u32 m0, s68, 110592
  v_mfma_f32_16x16x32_bf16 v[236:239], a[44:47], a[24:27], v[236:239]
  v_mfma_f32_16x16x32_bf16 a[128:131], a[48:51], a[24:27], a[128:131]
  buffer_load_dwordx4 v11, s[52:55], s70 offen lds
  v_mfma_f32_16x16x32_bf16 a[132:135], a[52:55], a[24:27], a[132:135]
  buffer_load_dwordx4 a[172:175], v24, s[64:67], s71 offen offset:0
  v_mfma_f32_16x16x32_bf16 a[136:139], a[56:59], a[24:27], a[136:139]
  v_mfma_f32_16x16x32_bf16 a[140:143], a[60:63], a[24:27], a[140:143]
  s_add_u32 s70, s70, 98304
  v_mfma_f32_16x16x32_bf16 a[156:159], a[60:63], a[28:31], a[156:159]
  v_mfma_f32_16x16x32_bf16 a[152:155], a[56:59], a[28:31], a[152:155]
  s_add_u32 m0, s68, 49152
  v_mfma_f32_16x16x32_bf16 a[148:151], a[52:55], a[28:31], a[148:151]
  buffer_load_dwordx4 v6, s[40:43], s69 offen lds
  v_mfma_f32_16x16x32_bf16 a[144:147], a[48:51], a[28:31], a[144:147]
  v_mfma_f32_16x16x32_bf16 v[252:255], a[44:47], a[28:31], v[252:255]
  s_add_u32 m0, s68, 53248
  v_mfma_f32_16x16x32_bf16 v[248:251], a[40:43], a[28:31], v[248:251]
  v_mfma_f32_16x16x32_bf16 v[244:247], a[36:39], a[28:31], v[244:247]
  buffer_load_dwordx4 v7, s[40:43], s69 offen lds
  v_mfma_f32_16x16x32_bf16 v[240:243], a[32:35], a[28:31], v[240:243]
  v_mfma_f32_16x16x32_bf16 a[160:163], a[180:183], a[0:3], a[160:163]
  s_waitcnt lgkmcnt(0)
  v_mfma_f32_16x16x32_bf16 v[32:35], a[96:99], a[64:67], v[32:35]
  v_mfma_f32_16x16x32_bf16 v[36:39], a[100:103], a[64:67], v[36:39]
  v_mfma_f32_16x16x32_bf16 v[40:43], a[104:107], a[64:67], v[40:43]
  v_mfma_f32_16x16x32_bf16 v[44:47], a[108:111], a[64:67], v[44:47]
  s_waitcnt vmcnt(16)
  s_barrier
  ds_read_b64_tr_b16 a[32:33], v16 offset:32768
  v_mfma_f32_16x16x32_bf16 v[48:51], a[112:115], a[64:67], v[48:51]
  ds_read_b64_tr_b16 a[34:35], v16 offset:33792
  v_mfma_f32_16x16x32_bf16 v[52:55], a[116:119], a[64:67], v[52:55]
  ds_read_b128 a[0:3], v12 offset:0
  v_mfma_f32_16x16x32_bf16 v[56:59], a[120:123], a[64:67], v[56:59]
  ds_read_b64_tr_b16 a[36:37], v17 offset:32768
  v_mfma_f32_16x16x32_bf16 v[60:63], a[124:127], a[64:67], v[60:63]
  s_add_u32 m0, s68, 57344
  v_mfma_f32_16x16x32_bf16 v[92:95], a[124:127], a[68:71], v[92:95]
  ds_read_b64_tr_b16 a[38:39], v17 offset:33792
  buffer_load_dwordx4 v8, s[40:43], s69 offen lds
  v_mfma_f32_16x16x32_bf16 v[88:91], a[120:123], a[68:71], v[88:91]
  ds_read_b128 a[4:7], v12 offset:2048
  v_mfma_f32_16x16x32_bf16 v[84:87], a[116:119], a[68:71], v[84:87]
  ds_read_b64_tr_b16 a[40:41], v18 offset:32768
  s_add_u32 m0, s68, 61440
  v_mfma_f32_16x16x32_bf16 v[80:83], a[112:115], a[68:71], v[80:83]
  buffer_load_dwordx4 v9, s[40:43], s69 offen lds
  v_mfma_f32_16x16x32_bf16 v[76:79], a[108:111], a[68:71], v[76:79]
  ds_read_b64_tr_b16 a[42:43], v18 offset:33792
  v_mfma_f32_16x16x32_bf16 v[72:75], a[104:107], a[68:71], v[72:75]
  ds_read_b128 a[8:11], v12 offset:4096
  s_add_u32 s8, s8, 1
  v_mfma_f32_16x16x32_bf16 v[68:71], a[100:103], a[68:71], v[68:71]
  ds_read_b64_tr_b16 a[44:45], v19 offset:32768
  s_cmp_eq_u32 s8, 5
  v_mfma_f32_16x16x32_bf16 v[64:67], a[96:99], a[68:71], v[64:67]
  ds_read_b64_tr_b16 a[46:47], v19 offset:33792
  v_mfma_f32_16x16x32_bf16 v[96:99], a[96:99], a[72:75], v[96:99]
  s_cselect_b32 s8, 0, s8
  v_mfma_f32_16x16x32_bf16 v[100:103], a[100:103], a[72:75], v[100:103]
  ds_read_b128 a[12:15], v12 offset:6144
  s_add_u32 s9, s9, 5
  v_mfma_f32_16x16x32_bf16 v[104:107], a[104:107], a[72:75], v[104:107]
  ds_read_b64_tr_b16 a[48:49], v16 offset:40960
  v_mfma_f32_16x16x32_bf16 v[108:111], a[108:111], a[72:75], v[108:111]
  ds_read_b64_tr_b16 a[50:51], v16 offset:41984
  s_cmp_eq_u32 s9, 10
  v_mfma_f32_16x16x32_bf16 v[112:115], a[112:115], a[72:75], v[112:115]
  s_cselect_b32 s9, 0, s9
  v_mfma_f32_16x16x32_bf16 v[116:119], a[116:119], a[72:75], v[116:119]
  ds_read_b128 a[16:19], v12 offset:8192
  v_mfma_f32_16x16x32_bf16 v[120:123], a[120:123], a[72:75], v[120:123]
  ds_read_b64_tr_b16 a[52:53], v17 offset:40960
  s_add_u32 s69, s8, s9
  v_mfma_f32_16x16x32_bf16 v[124:127], a[124:127], a[72:75], v[124:127]
  ds_read_b64_tr_b16 a[54:55], v17 offset:41984
  s_lshl_b32 s69, s69, 7
  v_mfma_f32_16x16x32_bf16 v[156:159], a[124:127], a[76:79], v[156:159]
  ds_read_b128 a[20:23], v12 offset:10240
  v_mfma_f32_16x16x32_bf16 v[152:155], a[120:123], a[76:79], v[152:155]
  s_add_u32 m0, s68, 114688
  v_mfma_f32_16x16x32_bf16 v[148:151], a[116:119], a[76:79], v[148:151]
  ds_read_b64_tr_b16 a[56:57], v18 offset:40960
  buffer_load_dwordx4 v10, s[48:51], s70 offen lds
  v_mfma_f32_16x16x32_bf16 v[144:147], a[112:115], a[76:79], v[144:147]
  ds_read_b64_tr_b16 a[58:59], v18 offset:41984
  v_mfma_f32_16x16x32_bf16 v[140:143], a[108:111], a[76:79], v[140:143]
  ds_read_b128 a[24:27], v12 offset:12288
  s_add_u32 m0, s68, 118784
  v_mfma_f32_16x16x32_bf16 v[136:139], a[104:107], a[76:79], v[136:139]
  buffer_load_dwordx4 v11, s[48:51], s70 offen lds
  v_mfma_f32_16x16x32_bf16 v[132:135], a[100:103], a[76:79], v[132:135]
  ds_read_b64_tr_b16 a[60:61], v19 offset:40960
  v_mfma_f32_16x16x32_bf16 v[128:131], a[96:99], a[76:79], v[128:131]
  ds_read_b64_tr_b16 a[62:63], v19 offset:41984
  s_add_u32 m0, s68, 122880
  v_mfma_f32_16x16x32_bf16 v[160:163], a[96:99], a[80:83], v[160:163]
  ds_read_b128 a[28:31], v12 offset:14336
  buffer_load_dwordx4 v10, s[52:55], s70 offen lds
  v_mfma_f32_16x16x32_bf16 v[164:167], a[100:103], a[80:83], v[164:167]
  v_mfma_f32_16x16x32_bf16 v[168:171], a[104:107], a[80:83], v[168:171]
  s_add_u32 m0, s68, 126976
  v_mfma_f32_16x16x32_bf16 v[172:175], a[108:111], a[80:83], v[172:175]
  buffer_load_dwordx4 v11, s[52:55], s70 offen lds
  v_mfma_f32_16x16x32_bf16 v[176:179], a[112:115], a[80:83], v[176:179]
  v_mfma_f32_16x16x32_bf16 v[180:183], a[116:119], a[80:83], v[180:183]
  buffer_load_dwordx4 a[176:179], v24, s[64:67], s71 offen offset:64
  v_mfma_f32_16x16x32_bf16 v[184:187], a[120:123], a[80:83], v[184:187]
  s_add_u32 s10, s10, 1
  v_mfma_f32_16x16x32_bf16 v[188:191], a[124:127], a[80:83], v[188:191]
  v_mfma_f32_16x16x32_bf16 v[220:223], a[124:127], a[84:87], v[220:223]
  s_cmp_eq_u32 s10, 5
  v_mfma_f32_16x16x32_bf16 v[216:219], a[120:123], a[84:87], v[216:219]
  s_cselect_b32 s10, 0, s10
  v_mfma_f32_16x16x32_bf16 v[212:215], a[116:119], a[84:87], v[212:215]
  v_mfma_f32_16x16x32_bf16 v[208:211], a[112:115], a[84:87], v[208:211]
  s_add_u32 s11, s11, 5
  v_mfma_f32_16x16x32_bf16 v[204:207], a[108:111], a[84:87], v[204:207]
  s_cmp_eq_u32 s11, 10
  v_mfma_f32_16x16x32_bf16 v[200:203], a[104:107], a[84:87], v[200:203]
  v_mfma_f32_16x16x32_bf16 v[196:199], a[100:103], a[84:87], v[196:199]
  s_cselect_b32 s11, 0, s11
  v_mfma_f32_16x16x32_bf16 v[192:195], a[96:99], a[84:87], v[192:195]
  s_add_u32 s71, s10, s11
  v_mfma_f32_16x16x32_bf16 v[224:227], a[96:99], a[88:91], v[224:227]
  v_mfma_f32_16x16x32_bf16 v[228:231], a[100:103], a[88:91], v[228:231]
  s_mul_i32 s70, s71, 196608
  v_mfma_f32_16x16x32_bf16 v[232:235], a[104:107], a[88:91], v[232:235]
  s_lshl_b32 s71, s71, 7
  v_mfma_f32_16x16x32_bf16 v[236:239], a[108:111], a[88:91], v[236:239]
  v_mfma_f32_16x16x32_bf16 a[128:131], a[112:115], a[88:91], a[128:131]
  s_add_u32 m0, s68, 65536
  v_mfma_f32_16x16x32_bf16 a[132:135], a[116:119], a[88:91], a[132:135]
  buffer_load_dwordx4 v2, s[40:43], s69 offen lds
  v_mfma_f32_16x16x32_bf16 a[136:139], a[120:123], a[88:91], a[136:139]
  v_mfma_f32_16x16x32_bf16 a[140:143], a[124:127], a[88:91], a[140:143]
  s_add_u32 m0, s68, 69632
  v_mfma_f32_16x16x32_bf16 a[156:159], a[124:127], a[92:95], a[156:159]
  buffer_load_dwordx4 v3, s[40:43], s69 offen lds
  v_mfma_f32_16x16x32_bf16 a[152:155], a[120:123], a[92:95], a[152:155]
  v_mfma_f32_16x16x32_bf16 a[148:151], a[116:119], a[92:95], a[148:151]
  s_add_u32 m0, s68, 73728
  v_mfma_f32_16x16x32_bf16 a[144:147], a[112:115], a[92:95], a[144:147]
  buffer_load_dwordx4 v4, s[40:43], s69 offen lds
  v_mfma_f32_16x16x32_bf16 v[252:255], a[108:111], a[92:95], v[252:255]
  v_mfma_f32_16x16x32_bf16 v[248:251], a[104:107], a[92:95], v[248:251]
L_pad68:
  s_cbranch_execz L_warm_ret
  s_add_u32 m0, s68, 77824
  v_mfma_f32_16x16x32_bf16 v[244:247], a[100:103], a[92:95], v[244:247]
  buffer_load_dwordx4 v5, s[40:43], s69 offen lds
  v_mfma_f32_16x16x32_bf16 v[240:243], a[96:99], a[92:95], v[240:243]
  v_mfma_f32_16x16x32_bf16 a[160:163], a[184:187], a[64:67], a[160:163]
  s_waitcnt lgkmcnt(0)
  v_mfma_f32_16x16x32_bf16 v[32:35], a[32:35], a[0:3], v[32:35]
  v_mfma_f32_16x16x32_bf16 v[36:39], a[36:39], a[0:3], v[36:39]
  v_mfma_f32_16x16x32_bf16 v[40:43], a[40:43], a[0:3], v[40:43]
  v_mfma_f32_16x16x32_bf16 v[44:47], a[44:47], a[0:3], v[44:47]
  s_waitcnt vmcnt(22)
  s_barrier
  ds_read_b64_tr_b16 a[96:97], v16 offset:49152
  v_mfma_f32_16x16x32_bf16 v[48:51], a[48:51], a[0:3], v[48:51]
  ds_read_b64_tr_b16 a[98:99], v16 offset:50176
  v_mfma_f32_16x16x32_bf16 v[52:55], a[52:55], a[0:3], v[52:55]
  ds_read_b128 a[64:67], v13 offset:0
  v_mfma_f32_16x16x32_bf16 v[56:59], a[56:59], a[0:3], v[56:59]
  ds_read_b64_tr_b16 a[100:101], v17 offset:49152
  v_mfma_f32_16x16x32_bf16 v[60:63], a[60:63], a[0:3], v[60:63]
  v_mfma_f32_16x16x32_bf16 v[92:95], a[60:63], a[4:7], v[92:95]
  ds_read_b64_tr_b16 a[102:103], v17 offset:50176
  v_mfma_f32_16x16x32_bf16 v[88:91], a[56:59], a[4:7], v[88:91]
  ds_read_b128 a[68:71], v13 offset:2048
  v_mfma_f32_16x16x32_bf16 v[84:87], a[52:55], a[4:7], v[84:87]
  ds_read_b64_tr_b16 a[104:105], v18 offset:49152
  v_mfma_f32_16x16x32_bf16 v[80:83], a[48:51], a[4:7], v[80:83]
  s_add_u32 m0, s68, 131072
  v_mfma_f32_16x16x32_bf16 v[76:79], a[44:47], a[4:7], v[76:79]
  ds_read_b64_tr_b16 a[106:107], v18 offset:50176
  v_mfma_f32_16x16x32_bf16 v[72:75], a[40:43], a[4:7], v[72:75]
  ds_read_b128 a[72:75], v13 offset:4096
  buffer_load_dwordx4 v10, s[48:51], s70 offen lds
  v_mfma_f32_16x16x32_bf16 v[68:71], a[36:39], a[4:7], v[68:71]
  ds_read_b64_tr_b16 a[108:109], v19 offset:49152
  v_mfma_f32_16x16x32_bf16 v[64:67], a[32:35], a[4:7], v[64:67]
  ds_read_b64_tr_b16 a[110:111], v19 offset:50176
  s_add_u32 m0, s68, 135168
  v_mfma_f32_16x16x32_bf16 v[96:99], a[32:35], a[8:11], v[96:99]
  v_mfma_f32_16x16x32_bf16 v[100:103], a[36:39], a[8:11], v[100:103]
  ds_read_b128 a[76:79], v13 offset:6144
  buffer_load_dwordx4 v11, s[48:51], s70 offen lds
  v_mfma_f32_16x16x32_bf16 v[104:107], a[40:43], a[8:11], v[104:107]
  ds_read_b64_tr_b16 a[112:113], v16 offset:57344
  v_mfma_f32_16x16x32_bf16 v[108:111], a[44:47], a[8:11], v[108:111]
  ds_read_b64_tr_b16 a[114:115], v16 offset:58368
  v_mfma_f32_16x16x32_bf16 v[112:115], a[48:51], a[8:11], v[112:115]
  s_add_u32 m0, s68, 139264
  v_mfma_f32_16x16x32_bf16 v[116:119], a[52:55], a[8:11], v[116:119]
  ds_read_b128 a[80:83], v13 offset:8192
  v_mfma_f32_16x16x32_bf16 v[120:123], a[56:59], a[8:11], v[120:123]
  ds_read_b64_tr_b16 a[116:117], v17 offset:57344
  buffer_load_dwordx4 v10, s[52:55], s70 offen lds
  v_mfma_f32_16x16x32_bf16 v[124:127], a[60:63], a[8:11], v[124:127]
  ds_read_b64_tr_b16 a[118:119], v17 offset:58368
  v_mfma_f32_16x16x32_bf16 v[156:159], a[60:63], a[12:15], v[156:159]
  ds_read_b128 a[84:87], v13 offset:10240
  s_add_u32 m0, s68, 143360
  v_mfma_f32_16x16x32_bf16 v[152:155], a[56:59], a[12:15], v[152:155]
  v_mfma_f32_16x16x32_bf16 v[148:151], a[52:55], a[12:15], v[148:151]
  ds_read_b64_tr_b16 a[120:121], v18 offset:57344
  v_mfma_f32_16x16x32_bf16 v[144:147], a[48:51], a[12:15], v[144:147]
  ds_read_b64_tr_b16 a[122:123], v18 offset:58368
  buffer_load_dwordx4 v11, s[52:55], s70 offen lds
  v_mfma_f32_16x16x32_bf16 v[140:143], a[44:47], a[12:15], v[140:143]
  ds_read_b128 a[88:91], v13 offset:12288
  v_mfma_f32_16x16x32_bf16 v[136:139], a[40:43], a[12:15], v[136:139]
  buffer_load_dwordx4 a[180:183], v24, s[64:67], s71 offen offset:0
  v_mfma_f32_16x16x32_bf16 v[132:135], a[36:39], a[12:15], v[132:135]
  ds_read_b64_tr_b16 a[124:125], v19 offset:57344
  v_mfma_f32_16x16x32_bf16 v[128:131], a[32:35], a[12:15], v[128:131]
  ds_read_b64_tr_b16 a[126:127], v19 offset:58368
  s_add_u32 s70, s70, 98304
  v_mfma_f32_16x16x32_bf16 v[160:163], a[32:35], a[16:19], v[160:163]
  ds_read_b128 a[92:95], v13 offset:14336
  v_mfma_f32_16x16x32_bf16 v[164:167], a[36:39], a[16:19], v[164:167]
  v_mfma_f32_16x16x32_bf16 v[168:171], a[40:43], a[16:19], v[168:171]
  s_add_u32 m0, s68, 81920
  v_mfma_f32_16x16x32_bf16 v[172:175], a[44:47], a[16:19], v[172:175]
  v_mfma_f32_16x16x32_bf16 v[176:179], a[48:51], a[16:19], v[176:179]
  buffer_load_dwordx4 v6, s[40:43], s69 offen lds
  v_mfma_f32_16x16x32_bf16 v[180:183], a[52:55], a[16:19], v[180:183]
  v_mfma_f32_16x16x32_bf16 v[184:187], a[56:59], a[16:19], v[184:187]
  s_add_u32 m0, s68, 86016
  v_mfma_f32_16x16x32_bf16 v[188:191], a[60:63], a[16:19], v[188:191]
  v_mfma_f32_16x16x32_bf16 v[220:223], a[60:63], a[20:23], v[220:223]
  buffer_load_dwordx4 v7, s[40:43], s69 offen lds
  v_mfma_f32_16x16x32_bf16 v[216:219], a[56:59], a[20:23], v[216:219]
  v_mfma_f32_16x16x32_bf16 v[212:215], a[52:55], a[20:23], v[212:215]
  v_mfma_f32_16x16x32_bf16 v[208:211], a[48:51], a[20:23], v[208:211]
  s_add_u32 m0, s68, 90112
  v_mfma_f32_16x16x32_bf16 v[204:207], a[44:47], a[20:23], v[204:207]
  v_mfma_f32_16x16x32_bf16 v[200:203], a[40:43], a[20:23], v[200:203]
  buffer_load_dwordx4 v8, s[40:43], s69 offen lds
  v_mfma_f32_16x16x32_bf16 v[196:199], a[36:39], a[20:23], v[196:199]
  v_mfma_f32_16x16x32_bf16 v[192:195], a[32:35], a[20:23], v[192:195]
  s_add_u32 m0, s68, 94208
  v_mfma_f32_16x16x32_bf16 v[224:227], a[32:35], a[24:27], v[224:227]
  v_mfma_f32_16x16x32_bf16 v[228:231], a[36:39], a[24:27], v[228:231]
  v_mfma_f32_16x16x32_bf16 v[232:235], a[40:43], a[24:27], v[232:235]
  buffer_load_dwordx4 v9, s[40:43], s69 offen lds
  v_mfma_f32_16x16x32_bf16 v[236:239], a[44:47], a[24:27], v[236:239]
  v_mfma_f32_16x16x32_bf16 a[128:131], a[48:51], a[24:27], a[128:131]
  s_add_u32 s8, s8, 1
  v_mfma_f32_16x16x32_bf16 a[132:135], a[52:55], a[24:27], a[132:135]
  v_mfma_f32_16x16x32_bf16 a[136:139], a[56:59], a[24:27], a[136:139]
  s_cmp_eq_u32 s8, 5
  v_mfma_f32_16x16x32_bf16 a[140:143], a[60:63], a[24:27], a[140:143]
  v_mfma_f32_16x16x32_bf16 a[156:159], a[60:63], a[28:31], a[156:159]
  v_mfma_f32_16x16x32_bf16 a[152:155], a[56:59], a[28:31], a[152:155]
  s_cselect_b32 s8, 0, s8
  v_mfma_f32_16x16x32_bf16 a[148:151], a[52:55], a[28:31], a[148:151]
  v_mfma_f32_16x16x32_bf16 a[144:147], a[48:51], a[28:31], a[144:147]
  s_add_u32 s69, s8, s9
  v_mfma_f32_16x16x32_bf16 v[252:255], a[44:47], a[28:31], v[252:255]
  v_mfma_f32_16x16x32_bf16 v[248:251], a[40:43], a[28:31], v[248:251]
  s_lshl_b32 s69, s69, 7
  v_mfma_f32_16x16x32_bf16 v[244:247], a[36:39], a[28:31], v[244:247]
  v_mfma_f32_16x16x32_bf16 v[240:243], a[32:35], a[28:31], v[240:243]
  v_mfma_f32_16x16x32_bf16 a[160:163], a[164:167], a[0:3], a[160:163]
  s_waitcnt lgkmcnt(0)
  v_mfma_f32_16x16x32_bf16 v[32:35], a[96:99], a[64:67], v[32:35]
  v_mfma_f32_16x16x32_bf16 v[36:39], a[100:103], a[64:67], v[36:39]
  v_mfma_f32_16x16x32_bf16 v[40:43], a[104:107], a[64:67], v[40:43]
  v_mfma_f32_16x16x32_bf16 v[44:47], a[108:111], a[64:67], v[44:47]
  s_waitcnt vmcnt(18)
  s_barrier
  ds_read_b64_tr_b16 a[32:33], v16 offset:0
  v_mfma_f32_16x16x32_bf16 v[48:51], a[112:115], a[64:67], v[48:51]
  ds_read_b64_tr_b16 a[34:35], v16 offset:1024
  v_mfma_f32_16x16x32_bf16 v[52:55], a[116:119], a[64:67], v[52:55]
  ds_read_b128 a[0:3], v12 offset:32768
  v_mfma_f32_16x16x32_bf16 v[56:59], a[120:123], a[64:67], v[56:59]
  ds_read_b64_tr_b16 a[36:37], v17 offset:0
  v_mfma_f32_16x16x32_bf16 v[60:63], a[124:127], a[64:67], v[60:63]
  v_mfma_f32_16x16x32_bf16 v[92:95], a[124:127], a[68:71], v[92:95]
  ds_read_b64_tr_b16 a[38:39], v17 offset:1024
  v_mfma_f32_16x16x32_bf16 v[88:91], a[120:123], a[68:71], v[88:91]
  ds_read_b128 a[4:7], v12 offset:34816
  v_mfma_f32_16x16x32_bf16 v[84:87], a[116:119], a[68:71], v[84:87]
  ds_read_b64_tr_b16 a[40:41], v18 offset:0
  v_mfma_f32_16x16x32_bf16 v[80:83], a[112:115], a[68:71], v[80:83]
  s_add_u32 m0, s68, 147456
  v_mfma_f32_16x16x32_bf16 v[76:79], a[108:111], a[68:71], v[76:79]
  ds_read_b64_tr_b16 a[42:43], v18 offset:1024
  v_mfma_f32_16x16x32_bf16 v[72:75], a[104:107], a[68:71], v[72:75]
  ds_read_b128 a[8:11], v12 offset:36864
  buffer_load_dwordx4 v10, s[48:51], s70 offen lds
  v_mfma_f32_16x16x32_bf16 v[68:71], a[100:103], a[68:71], v[68:71]
  ds_read_b64_tr_b16 a[44:45], v19 offset:0
  v_mfma_f32_16x16x32_bf16 v[64:67], a[96:99], a[68:71], v[64:67]
  ds_read_b64_tr_b16 a[46:47], v19 offset:1024
  s_add_u32 m0, s68, 151552
  v_mfma_f32_16x16x32_bf16 v[96:99], a[96:99], a[72:75], v[96:99]
  v_mfma_f32_16x16x32_bf16 v[100:103], a[100:103], a[72:75], v[100:103]
  ds_read_b128 a[12:15], v12 offset:38912
  buffer_load_dwordx4 v11, s[48:51], s70 offen lds
  v_mfma_f32_16x16x32_bf16 v[104:107], a[104:107], a[72:75], v[104:107]
  ds_read_b64_tr_b16 a[48:49], v16 offset:8192
  v_mfma_f32_16x16x32_bf16 v[108:111], a[108:111], a[72:75], v[108:111]
  ds_read_b64_tr_b16 a[50:51], v16 offset:9216
  v_mfma_f32_16x16x32_bf16 v[112:115], a[112:115], a[72:75], v[112:115]
  s_add_u32 m0, s68, 155648
  v_mfma_f32_16x16x32_bf16 v[116:119], a[116:119], a[72:75], v[116:119]
  ds_read_b128 a[16:19], v12 offset:40960
  v_mfma_f32_16x16x32_bf16 v[120:123], a[120:123], a[72:75], v[120:123]
  ds_read_b64_tr_b16 a[52:53], v17 offset:8192
  buffer_load_dwordx4 v10, s[52:55], s70 offen lds
  v_mfma_f32_16x16x32_bf16 v[124:127], a[124:127], a[72:75], v[124:127]
  ds_read_b64_tr_b16 a[54:55], v17 offset:9216
  v_mfma_f32_16x16x32_bf16 v[156:159], a[124:127], a[76:79], v[156:159]
  ds_read_b128 a[20:23], v12 offset:43008
  s_add_u32 m0, s68, 159744
  v_mfma_f32_16x16x32_bf16 v[152:155], a[120:123], a[76:79], v[152:155]
  v_mfma_f32_16x16x32_bf16 v[148:151], a[116:119], a[76:79], v[148:151]
  ds_read_b64_tr_b16 a[56:57], v18 offset:8192
  v_mfma_f32_16x16x32_bf16 v[144:147], a[112:115], a[76:79], v[144:147]
  ds_read_b64_tr_b16 a[58:59], v18 offset:9216
  buffer_load_dwordx4 v11, s[52:55], s70 offen lds
  v_mfma_f32_16x16x32_bf16 v[140:143], a[108:111], a[76:79], v[140:143]
  ds_read_b128 a[24:27], v12 offset:45056
  v_mfma_f32_16x16x32_bf16 v[136:139], a[104:107], a[76:79], v[136:139]
  buffer_load_dwordx4 a[184:187], v24, s[64:67], s71 offen offset:64
  v_mfma_f32_16x16x32_bf16 v[132:135], a[100:103], a[76:79], v[132:135]
  ds_read_b64_tr_b16 a[60:61], v19 offset:8192
  v_mfma_f32_16x16x32_bf16 v[128:131], a[96:99], a[76:79], v[128:131]
  ds_read_b64_tr_b16 a[62:63], v19 offset:9216
  s_add_u32 s10, s10, 1
  v_mfma_f32_16x16x32_bf16 v[160:163], a[96:99], a[80:83], v[160:163]
  ds_read_b128 a[28:31], v12 offset:47104
  v_mfma_f32_16x16x32_bf16 v[164:167], a[100:103], a[80:83], v[164:167]
  v_mfma_f32_16x16x32_bf16 v[168:171], a[104:107], a[80:83], v[168:171]
  s_cmp_eq_u32 s10, 5
  v_mfma_f32_16x16x32_bf16 v[172:175], a[108:111], a[80:83], v[172:175]
  v_mfma_f32_16x16x32_bf16 v[176:179], a[112:115], a[80:83], v[176:179]
  s_cselect_b32 s10, 0, s10
  v_mfma_f32_16x16x32_bf16 v[180:183], a[116:119], a[80:83], v[180:183]
  v_mfma_f32_16x16x32_bf16 v[184:187], a[120:123], a[80:83], v[184:187]
  s_add_u32 s71, s10, s11
  v_mfma_f32_16x16x32_bf16 v[188:191], a[124:127], a[80:83], v[188:191]
  v_mfma_f32_16x16x32_bf16 v[220:223], a[124:127], a[84:87], v[220:223]
  s_mul_i32 s70, s71, 196608
  v_mfma_f32_16x16x32_bf16 v[216:219], a[120:123], a[84:87], v[216:219]
  v_mfma_f32_16x16x32_bf16 v[212:215], a[116:119], a[84:87], v[212:215]
  v_mfma_f32_16x16x32_bf16 v[208:211], a[112:115], a[84:87], v[208:211]
  s_lshl_b32 s71, s71, 7
  v_mfma_f32_16x16x32_bf16 v[204:207], a[108:111], a[84:87], v[204:207]
  v_mfma_f32_16x16x32_bf16 v[200:203], a[104:107], a[84:87], v[200:203]
  s_add_u32 m0, s68, 0
  v_mfma_f32_16x16x32_bf16 v[196:199], a[100:103], a[84:87], v[196:199]
  v_mfma_f32_16x16x32_bf16 v[192:195], a[96:99], a[84:87], v[192:195]
  buffer_load_dwordx4 v2, s[40:43], s69 offen lds
  v_mfma_f32_16x16x32_bf16 v[224:227], a[96:99], a[88:91], v[224:227]
  v_mfma_f32_16x16x32_bf16 v[228:231], a[100:103], a[88:91], v[228:231]
  v_mfma_f32_16x16x32_bf16 v[232:235], a[104:107], a[88:91], v[232:235]
  s_add_u32 m0, s68, 4096
  v_mfma_f32_16x16x32_bf16 v[236:239], a[108:111], a[88:91], v[236:239]
  v_mfma_f32_16x16x32_bf16 a[128:131], a[112:115], a[88:91], a[128:131]
  buffer_load_dwordx4 v3, s[40:43], s69 offen lds
  v_mfma_f32_16x16x32_bf16 a[132:135], a[116:119], a[88:91], a[132:135]
  v_mfma_f32_16x16x32_bf16 a[136:139], a[120:123], a[88:91], a[136:139]
  s_add_u32 m0, s68, 8192
  v_mfma_f32_16x16x32_bf16 a[140:143], a[124:127], a[88:91], a[140:143]
  v_mfma_f32_16x16x32_bf16 a[156:159], a[124:127], a[92:95], a[156:159]
  v_mfma_f32_16x16x32_bf16 a[152:155], a[120:123], a[92:95], a[152:155]
  buffer_load_dwordx4 v4, s[40:43], s69 offen lds
  v_mfma_f32_16x16x32_bf16 a[148:151], a[116:119], a[92:95], a[148:151]
  v_mfma_f32_16x16x32_bf16 a[144:147], a[112:115], a[92:95], a[144:147]
  s_add_u32 m0, s68, 12288
  v_mfma_f32_16x16x32_bf16 v[252:255], a[108:111], a[92:95], v[252:255]
  v_mfma_f32_16x16x32_bf16 v[248:251], a[104:107], a[92:95], v[248:251]
  buffer_load_dwordx4 v5, s[40:43], s69 offen lds
  v_mfma_f32_16x16x32_bf16 v[244:247], a[100:103], a[92:95], v[244:247]
  v_mfma_f32_16x16x32_bf16 v[240:243], a[96:99], a[92:95], v[240:243]
  v_mfma_f32_16x16x32_bf16 a[160:163], a[168:171], a[64:67], a[160:163]
  s_waitcnt lgkmcnt(0)
  v_mfma_f32_16x16x32_bf16 v[32:35], a[32:35], a[0:3], v[32:35]
  v_mfma_f32_16x16x32_bf16 v[36:39], a[36:39], a[0:3], v[36:39]
  v_mfma_f32_16x16x32_bf16 v[40:43], a[40:43], a[0:3], v[40:43]
  v_mfma_f32_16x16x32_bf16 v[44:47], a[44:47], a[0:3], v[44:47]
  s_waitcnt vmcnt(22)
  s_barrier
  ds_read_b64_tr_b16 a[96:97], v16 offset:16384
  v_mfma_f32_16x16x32_bf16 v[48:51], a[48:51], a[0:3], v[48:51]
  ds_read_b64_tr_b16 a[98:99], v16 offset:17408
  v_mfma_f32_16x16x32_bf16 v[52:55], a[52:55], a[0:3], v[52:55]
  ds_read_b128 a[64:67], v13 offset:32768
  v_mfma_f32_16x16x32_bf16 v[56:59], a[56:59], a[0:3], v[56:59]
  ds_read_b64_tr_b16 a[100:101], v17 offset:16384
  v_mfma_f32_16x16x32_bf16 v[60:63], a[60:63], a[0:3], v[60:63]
  v_mfma_f32_16x16x32_bf16 v[92:95], a[60:63], a[4:7], v[92:95]
  ds_read_b64_tr_b16 a[102:103], v17 offset:17408
  v_mfma_f32_16x16x32_bf16 v[88:91], a[56:59], a[4:7], v[88:91]
  ds_read_b128 a[68:71], v13 offset:34816
  v_mfma_f32_16x16x32_bf16 v[84:87], a[52:55], a[4:7], v[84:87]
  ds_read_b64_tr_b16 a[104:105], v18 offset:16384
  v_mfma_f32_16x16x32_bf16 v[80:83], a[48:51], a[4:7], v[80:83]
  s_add_u32 m0, s68, 98304
  v_mfma_f32_16x16x32_bf16 v[76:79], a[44:47], a[4:7], v[76:79]
  ds_read_b64_tr_b16 a[106:107], v18 offset:17408
  v_mfma_f32_16x16x32_bf16 v[72:75], a[40:43], a[4:7], v[72:75]
  ds_read_b128 a[72:75], v13 offset:36864
  buffer_load_dwordx4 v10, s[48:51], s70 offen lds
  v_mfma_f32_16x16x32_bf16 v[68:71], a[36:39], a[4:7], v[68:71]
  ds_read_b64_tr_b16 a[108:109], v19 offset:16384
  v_mfma_f32_16x16x32_bf16 v[64:67], a[32:35], a[4:7], v[64:67]
L_pad69:
  s_cbranch_execz L_warm_ret
  ds_read_b64_tr_b16 a[110:111], v19 offset:17408
  s_add_u32 m0, s68, 102400
  v_mfma_f32_16x16x32_bf16 v[96:99], a[32:35], a[8:11], v[96:99]
  v_mfma_f32_16x16x32_bf16 v[100:103], a[36:39], a[8:11], v[100:103]
  ds_read_b128 a[76:79], v13 offset:38912
  buffer_load_dwordx4 v11, s[48:51], s70 offen lds
  v_mfma_f32_16x16x32_bf16 v[104:107], a[40:43], a[8:11], v[104:107]
  ds_read_b64_tr_b16 a[112:113], v16 offset:24576
  v_mfma_f32_16x16x32_bf16 v[108:111], a[44:47], a[8:11], v[108:111]
  ds_read_b64_tr_b16 a[114:115], v16 offset:25600
  v_mfma_f32_16x16x32_bf16 v[112:115], a[48:51], a[8:11], v[112:115]
  s_add_u32 m0, s68, 106496
  v_mfma_f32_16x16x32_bf16 v[116:119], a[52:55], a[8:11], v[116:119]
  ds_read_b128 a[80:83], v13 offset:40960
  v_mfma_f32_16x16x32_bf16 v[120:123], a[56:59], a[8:11], v[120:123]
  ds_read_b64_tr_b16 a[116:117], v17 offset:24576
  buffer_load_dwordx4 v10, s[52:55], s70 offen lds
  v_mfma_f32_16x16x32_bf16 v[124:127], a[60:63], a[8:11], v[124:127]
  ds_read_b64_tr_b16 a[118:119], v17 offset:25600
  v_mfma_f32_16x16x32_bf16 v[156:159], a[60:63], a[12:15], v[156:159]
  ds_read_b128 a[84:87], v13 offset:43008
  s_add_u32 m0, s68, 110592
  v_mfma_f32_16x16x32_bf16 v[152:155], a[56:59], a[12:15], v[152:155]
  v_mfma_f32_16x16x32_bf16 v[148:151], a[52:55], a[12:15], v[148:151]
  ds_read_b64_tr_b16 a[120:121], v18 offset:24576
  v_mfma_f32_16x16x32_bf16 v[144:147], a[48:51], a[12:15], v[144:147]
  ds_read_b64_tr_b16 a[122:123], v18 offset:25600
  buffer_load_dwordx4 v11, s[52:55], s70 offen lds
  v_mfma_f32_16x16x32_bf16 v[140:143], a[44:47], a[12:15], v[140:143]
  ds_read_b128 a[88:91], v13 offset:45056
  v_mfma_f32_16x16x32_bf16 v[136:139], a[40:43], a[12:15], v[136:139]
  buffer_load_dwordx4 a[164:167], v24, s[64:67], s71 offen offset:0
  v_mfma_f32_16x16x32_bf16 v[132:135], a[36:39], a[12:15], v[132:135]
  ds_read_b64_tr_b16 a[124:125], v19 offset:24576
  v_mfma_f32_16x16x32_bf16 v[128:131], a[32:35], a[12:15], v[128:131]
  ds_read_b64_tr_b16 a[126:127], v19 offset:25600
  s_add_u32 s70, s70, 98304
  v_mfma_f32_16x16x32_bf16 v[160:163], a[32:35], a[16:19], v[160:163]
  ds_read_b128 a[92:95], v13 offset:47104
  v_mfma_f32_16x16x32_bf16 v[164:167], a[36:39], a[16:19], v[164:167]
  v_mfma_f32_16x16x32_bf16 v[168:171], a[40:43], a[16:19], v[168:171]
  s_add_u32 m0, s68, 16384
  v_mfma_f32_16x16x32_bf16 v[172:175], a[44:47], a[16:19], v[172:175]
  v_mfma_f32_16x16x32_bf16 v[176:179], a[48:51], a[16:19], v[176:179]
  buffer_load_dwordx4 v6, s[40:43], s69 offen lds
  v_mfma_f32_16x16x32_bf16 v[180:183], a[52:55], a[16:19], v[180:183]
  v_mfma_f32_16x16x32_bf16 v[184:187], a[56:59], a[16:19], v[184:187]
  s_add_u32 m0, s68, 20480
  v_mfma_f32_16x16x32_bf16 v[188:191], a[60:63], a[16:19], v[188:191]
  v_mfma_f32_16x16x32_bf16 v[220:223], a[60:63], a[20:23], v[220:223]
  buffer_load_dwordx4 v7, s[40:43], s69 offen lds
  v_mfma_f32_16x16x32_bf16 v[216:219], a[56:59], a[20:23], v[216:219]
  v_mfma_f32_16x16x32_bf16 v[212:215], a[52:55], a[20:23], v[212:215]
  v_mfma_f32_16x16x32_bf16 v[208:211], a[48:51], a[20:23], v[208:211]
  s_add_u32 m0, s68, 24576
  v_mfma_f32_16x16x32_bf16 v[204:207], a[44:47], a[20:23], v[204:207]
  v_mfma_f32_16x16x32_bf16 v[200:203], a[40:43], a[20:23], v[200:203]
  buffer_load_dwordx4 v8, s[40:43], s69 offen lds
  v_mfma_f32_16x16x32_bf16 v[196:199], a[36:39], a[20:23], v[196:199]
  v_mfma_f32_16x16x32_bf16 v[192:195], a[32:35], a[20:23], v[192:195]
  s_add_u32 m0, s68, 28672
  v_mfma_f32_16x16x32_bf16 v[224:227], a[32:35], a[24:27], v[224:227]
  v_mfma_f32_16x16x32_bf16 v[228:231], a[36:39], a[24:27], v[228:231]
  v_mfma_f32_16x16x32_bf16 v[232:235], a[40:43], a[24:27], v[232:235]
  buffer_load_dwordx4 v9, s[40:43], s69 offen lds
  v_mfma_f32_16x16x32_bf16 v[236:239], a[44:47], a[24:27], v[236:239]
  v_mfma_f32_16x16x32_bf16 a[128:131], a[48:51], a[24:27], a[128:131]
  s_add_u32 s8, s8, 1
  v_mfma_f32_16x16x32_bf16 a[132:135], a[52:55], a[24:27], a[132:135]
  v_mfma_f32_16x16x32_bf16 a[136:139], a[56:59], a[24:27], a[136:139]
  s_cmp_eq_u32 s8, 5
  v_mfma_f32_16x16x32_bf16 a[140:143], a[60:63], a[24:27], a[140:143]
  v_mfma_f32_16x16x32_bf16 a[156:159], a[60:63], a[28:31], a[156:159]
  v_mfma_f32_16x16x32_bf16 a[152:155], a[56:59], a[28:31], a[152:155]
  s_cselect_b32 s8, 0, s8
  v_mfma_f32_16x16x32_bf16 a[148:151], a[52:55], a[28:31], a[148:151]
  v_mfma_f32_16x16x32_bf16 a[144:147], a[48:51], a[28:31], a[144:147]
  s_add_u32 s69, s8, s9
  v_mfma_f32_16x16x32_bf16 v[252:255], a[44:47], a[28:31], v[252:255]
  v_mfma_f32_16x16x32_bf16 v[248:251], a[40:43], a[28:31], v[248:251]
  s_lshl_b32 s69, s69, 7
  v_mfma_f32_16x16x32_bf16 v[244:247], a[36:39], a[28:31], v[244:247]
  v_mfma_f32_16x16x32_bf16 v[240:243], a[32:35], a[28:31], v[240:243]
  v_mfma_f32_16x16x32_bf16 a[160:163], a[172:175], a[0:3], a[160:163]
  s_waitcnt lgkmcnt(0)
  v_mfma_f32_16x16x32_bf16 v[32:35], a[96:99], a[64:67], v[32:35]
  v_mfma_f32_16x16x32_bf16 v[36:39], a[100:103], a[64:67], v[36:39]
  v_mfma_f32_16x16x32_bf16 v[40:43], a[104:107], a[64:67], v[40:43]
  v_mfma_f32_16x16x32_bf16 v[44:47], a[108:111], a[64:67], v[44:47]
  s_waitcnt vmcnt(18)
  s_barrier
  ds_read_b64_tr_b16 a[32:33], v16 offset:32768
  v_mfma_f32_16x16x32_bf16 v[48:51], a[112:115], a[64:67], v[48:51]
  ds_read_b64_tr_b16 a[34:35], v16 offset:33792
  v_mfma_f32_16x16x32_bf16 v[52:55], a[116:119], a[64:67], v[52:55]
  ds_read_b128 a[0:3], v14 offset:0
  v_mfma_f32_16x16x32_bf16 v[56:59], a[120:123], a[64:67], v[56:59]
  ds_read_b64_tr_b16 a[36:37], v17 offset:32768
  v_mfma_f32_16x16x32_bf16 v[60:63], a[124:127], a[64:67], v[60:63]
  v_mfma_f32_16x16x32_bf16 v[92:95], a[124:127], a[68:71], v[92:95]
  ds_read_b64_tr_b16 a[38:39], v17 offset:33792
  v_mfma_f32_16x16x32_bf16 v[88:91], a[120:123], a[68:71], v[88:91]
  ds_read_b128 a[4:7], v14 offset:2048
  v_mfma_f32_16x16x32_bf16 v[84:87], a[116:119], a[68:71], v[84:87]
  ds_read_b64_tr_b16 a[40:41], v18 offset:32768
  v_mfma_f32_16x16x32_bf16 v[80:83], a[112:115], a[68:71], v[80:83]
  s_add_u32 m0, s68, 114688
  v_mfma_f32_16x16x32_bf16 v[76:79], a[108:111], a[68:71], v[76:79]
  ds_read_b64_tr_b16 a[42:43], v18 offset:33792
  v_mfma_f32_16x16x32_bf16 v[72:75], a[104:107], a[68:71], v[72:75]
  ds_read_b128 a[8:11], v14 offset:4096
  buffer_load_dwordx4 v10, s[48:51], s70 offen lds
  v_mfma_f32_16x16x32_bf16 v[68:71], a[100:103], a[68:71], v[68:71]
  ds_read_b64_tr_b16 a[44:45], v19 offset:32768
  v_mfma_f32_16x16x32_bf16 v[64:67], a[96:99], a[68:71], v[64:67]
  ds_read_b64_tr_b16 a[46:47], v19 offset:33792
  s_add_u32 m0, s68, 118784
  v_mfma_f32_16x16x32_bf16 v[96:99], a[96:99], a[72:75], v[96:99]
  v_mfma_f32_16x16x32_bf16 v[100:103], a[100:103], a[72:75], v[100:103]
  ds_read_b128 a[12:15], v14 offset:6144
  buffer_load_dwordx4 v11, s[48:51], s70 offen lds
  v_mfma_f32_16x16x32_bf16 v[104:107], a[104:107], a[72:75], v[104:107]
  ds_read_b64_tr_b16 a[48:49], v16 offset:40960
  v_mfma_f32_16x16x32_bf16 v[108:111], a[108:111], a[72:75], v[108:111]
  ds_read_b64_tr_b16 a[50:51], v16 offset:41984
  v_mfma_f32_16x16x32_bf16 v[112:115], a[112:115], a[72:75], v[112:115]
  s_add_u32 m0, s68, 122880
  v_mfma_f32_16x16x32_bf16 v[116:119], a[116:119], a[72:75], v[116:119]
  ds_read_b128 a[16:19], v14 offset:8192
  v_mfma_f32_16x16x32_bf16 v[120:123], a[120:123], a[72:75], v[120:123]
  ds_read_b64_tr_b16 a[52:53], v17 offset:40960
  buffer_load_dwordx4 v10, s[52:55], s70 offen lds
  v_mfma_f32_16x16x32_bf16 v[124:127], a[124:127], a[72:75], v[124:127]
  ds_read_b64_tr_b16 a[54:55], v17 offset:41984
  v_mfma_f32_16x16x32_bf16 v[156:159], a[124:127], a[76:79], v[156:159]
  ds_read_b128 a[20:23], v14 offset:10240
  s_add_u32 m0, s68, 126976
  v_mfma_f32_16x16x32_bf16 v[152:155], a[120:123], a[76:79], v[152:155]
  v_mfma_f32_16x16x32_bf16 v[148:151], a[116:119], a[76:79], v[148:151]
  ds_read_b64_tr_b16 a[56:57], v18 offset:40960
  v_mfma_f32_16x16x32_bf16 v[144:147], a[112:115], a[76:79], v[144:147]
  ds_read_b64_tr_b16 a[58:59], v18 offset:41984
  buffer_load_dwordx4 v11, s[52:55], s70 offen lds
  v_mfma_f32_16x16x32_bf16 v[140:143], a[108:111], a[76:79], v[140:143]
  ds_read_b128 a[24:27], v14 offset:12288
  v_mfma_f32_16x16x32_bf16 v[136:139], a[104:107], a[76:79], v[136:139]
  buffer_load_dwordx4 a[168:171], v24, s[64:67], s71 offen offset:64
  v_mfma_f32_16x16x32_bf16 v[132:135], a[100:103], a[76:79], v[132:135]
  ds_read_b64_tr_b16 a[60:61], v19 offset:40960
  v_mfma_f32_16x16x32_bf16 v[128:131], a[96:99], a[76:79], v[128:131]
  ds_read_b64_tr_b16 a[62:63], v19 offset:41984
  s_add_u32 s10, s10, 1
  v_mfma_f32_16x16x32_bf16 v[160:163], a[96:99], a[80:83], v[160:163]
  ds_read_b128 a[28:31], v14 offset:14336
  v_mfma_f32_16x16x32_bf16 v[164:167], a[100:103], a[80:83], v[164:167]
  v_mfma_f32_16x16x32_bf16 v[168:171], a[104:107], a[80:83], v[168:171]
  s_cmp_eq_u32 s10, 5
  v_mfma_f32_16x16x32_bf16 v[172:175], a[108:111], a[80:83], v[172:175]
  v_mfma_f32_16x16x32_bf16 v[176:179], a[112:115], a[80:83], v[176:179]
  s_cselect_b32 s10, 0, s10
  v_mfma_f32_16x16x32_bf16 v[180:183], a[116:119], a[80:83], v[180:183]
  v_mfma_f32_16x16x32_bf16 v[184:187], a[120:123], a[80:83], v[184:187]
  s_add_u32 s71, s10, s11
  v_mfma_f32_16x16x32_bf16 v[188:191], a[124:127], a[80:83], v[188:191]
  v_mfma_f32_16x16x32_bf16 v[220:223], a[124:127], a[84:87], v[220:223]
  s_mul_i32 s70, s71, 196608
  v_mfma_f32_16x16x32_bf16 v[216:219], a[120:123], a[84:87], v[216:219]
  v_mfma_f32_16x16x32_bf16 v[212:215], a[116:119], a[84:87], v[212:215]
  v_mfma_f32_16x16x32_bf16 v[208:211], a[112:115], a[84:87], v[208:211]
  s_lshl_b32 s71, s71, 7
  v_mfma_f32_16x16x32_bf16 v[204:207], a[108:111], a[84:87], v[204:207]
  v_mfma_f32_16x16x32_bf16 v[200:203], a[104:107], a[84:87], v[200:203]
  s_add_u32 m0, s68, 32768
  v_mfma_f32_16x16x32_bf16 v[196:199], a[100:103], a[84:87], v[196:199]
  v_mfma_f32_16x16x32_bf16 v[192:195], a[96:99], a[84:87], v[192:195]
  buffer_load_dwordx4 v2, s[40:43], s69 offen lds
  v_mfma_f32_16x16x32_bf16 v[224:227], a[96:99], a[88:91], v[224:227]
  v_mfma_f32_16x16x32_bf16 v[228:231], a[100:103], a[88:91], v[228:231]
  v_mfma_f32_16x16x32_bf16 v[232:235], a[104:107], a[88:91], v[232:235]
  s_add_u32 m0, s68, 36864
  v_mfma_f32_16x16x32_bf16 v[236:239], a[108:111], a[88:91], v[236:239]
  v_mfma_f32_16x16x32_bf16 a[128:131], a[112:115], a[88:91], a[128:131]
  buffer_load_dwordx4 v3, s[40:43], s69 offen lds
  v_mfma_f32_16x16x32_bf16 a[132:135], a[116:119], a[88:91], a[132:135]
  v_mfma_f32_16x16x32_bf16 a[136:139], a[120:123], a[88:91], a[136:139]
  s_add_u32 m0, s68, 40960
  v_mfma_f32_16x16x32_bf16 a[140:143], a[124:127], a[88:91], a[140:143]
  v_mfma_f32_16x16x32_bf16 a[156:159], a[124:127], a[92:95], a[156:159]
  v_mfma_f32_16x16x32_bf16 a[152:155], a[120:123], a[92:95], a[152:155]
  buffer_load_dwordx4 v4, s[40:43], s69 offen lds
  v_mfma_f32_16x16x32_bf16 a[148:151], a[116:119], a[92:95], a[148:151]
  v_mfma_f32_16x16x32_bf16 a[144:147], a[112:115], a[92:95], a[144:147]
  s_add_u32 m0, s68, 45056
  v_mfma_f32_16x16x32_bf16 v[252:255], a[108:111], a[92:95], v[252:255]
  v_mfma_f32_16x16x32_bf16 v[248:251], a[104:107], a[92:95], v[248:251]
  buffer_load_dwordx4 v5, s[40:43], s69 offen lds
  v_mfma_f32_16x16x32_bf16 v[244:247], a[100:103], a[92:95], v[244:247]
  v_mfma_f32_16x16x32_bf16 v[240:243], a[96:99], a[92:95], v[240:243]
  v_mfma_f32_16x16x32_bf16 a[160:163], a[176:179], a[64:67], a[160:163]
  s_waitcnt lgkmcnt(0)
  v_mfma_f32_16x16x32_bf16 v[32:35], a[32:35], a[0:3], v[32:35]
  v_mfma_f32_16x16x32_bf16 v[36:39], a[36:39], a[0:3], v[36:39]
  v_mfma_f32_16x16x32_bf16 v[40:43], a[40:43], a[0:3], v[40:43]
  v_mfma_f32_16x16x32_bf16 v[44:47], a[44:47], a[0:3], v[44:47]
  s_waitcnt vmcnt(22)
  s_barrier
  ds_read_b64_tr_b16 a[96:97], v16 offset:49152
  v_mfma_f32_16x16x32_bf16 v[48:51], a[48:51], a[0:3], v[48:51]
  ds_read_b64_tr_b16 a[98:99], v16 offset:50176
  v_mfma_f32_16x16x32_bf16 v[52:55], a[52:55], a[0:3], v[52:55]
  ds_read_b128 a[64:67], v15 offset:0
  v_mfma_f32_16x16x32_bf16 v[56:59], a[56:59], a[0:3], v[56:59]
  ds_read_b64_tr_b16 a[100:101], v17 offset:49152
  v_mfma_f32_16x16x32_bf16 v[60:63], a[60:63], a[0:3], v[60:63]
  v_mfma_f32_16x16x32_bf16 v[92:95], a[60:63], a[4:7], v[92:95]
  ds_read_b64_tr_b16 a[102:103], v17 offset:50176
  v_mfma_f32_16x16x32_bf16 v[88:91], a[56:59], a[4:7], v[88:91]
  ds_read_b128 a[68:71], v15 offset:2048
  v_mfma_f32_16x16x32_bf16 v[84:87], a[52:55], a[4:7], v[84:87]
  ds_read_b64_tr_b16 a[104:105], v18 offset:49152
  v_mfma_f32_16x16x32_bf16 v[80:83], a[48:51], a[4:7], v[80:83]
  s_add_u32 m0, s68, 131072
  v_mfma_f32_16x16x32_bf16 v[76:79], a[44:47], a[4:7], v[76:79]
  ds_read_b64_tr_b16 a[106:107], v18 offset:50176
  buffer_load_dwordx4 v10, s[48:51], s70 offen lds
  v_mfma_f32_16x16x32_bf16 v[72:75], a[40:43], a[4:7], v[72:75]
  ds_read_b128 a[72:75], v15 offset:4096
  v_mfma_f32_16x16x32_bf16 v[68:71], a[36:39], a[4:7], v[68:71]
  ds_read_b64_tr_b16 a[108:109], v19 offset:49152
  s_add_u32 m0, s68, 135168
  v_mfma_f32_16x16x32_bf16 v[64:67], a[32:35], a[4:7], v[64:67]
  ds_read_b64_tr_b16 a[110:111], v19 offset:50176
  v_mfma_f32_16x16x32_bf16 v[96:99], a[32:35], a[8:11], v[96:99]
  buffer_load_dwordx4 v11, s[48:51], s70 offen lds
  v_mfma_f32_16x16x32_bf16 v[100:103], a[36:39], a[8:11], v[100:103]
  ds_read_b128 a[76:79], v15 offset:6144
  v_mfma_f32_16x16x32_bf16 v[104:107], a[40:43], a[8:11], v[104:107]
  ds_read_b64_tr_b16 a[112:113], v16 offset:57344
  s_add_u32 m0, s68, 139264
  v_mfma_f32_16x16x32_bf16 v[108:111], a[44:47], a[8:11], v[108:111]
  ds_read_b64_tr_b16 a[114:115], v16 offset:58368
  v_mfma_f32_16x16x32_bf16 v[112:115], a[48:51], a[8:11], v[112:115]
  buffer_load_dwordx4 v10, s[52:55], s70 offen lds
  v_mfma_f32_16x16x32_bf16 v[116:119], a[52:55], a[8:11], v[116:119]
  ds_read_b128 a[80:83], v15 offset:8192
  s_add_u32 m0, s68, 143360
  v_mfma_f32_16x16x32_bf16 v[120:123], a[56:59], a[8:11], v[120:123]
  ds_read_b64_tr_b16 a[116:117], v17 offset:57344
  v_mfma_f32_16x16x32_bf16 v[124:127], a[60:63], a[8:11], v[124:127]
  ds_read_b64_tr_b16 a[118:119], v17 offset:58368
  buffer_load_dwordx4 v11, s[52:55], s70 offen lds
  v_mfma_f32_16x16x32_bf16 v[156:159], a[60:63], a[12:15], v[156:159]
  ds_read_b128 a[84:87], v15 offset:10240
  v_mfma_f32_16x16x32_bf16 v[152:155], a[56:59], a[12:15], v[152:155]
  buffer_load_dwordx4 a[172:175], v24, s[64:67], s71 offen offset:0
  v_mfma_f32_16x16x32_bf16 v[148:151], a[52:55], a[12:15], v[148:151]
  ds_read_b64_tr_b16 a[120:121], v18 offset:57344
  v_mfma_f32_16x16x32_bf16 v[144:147], a[48:51], a[12:15], v[144:147]
  ds_read_b64_tr_b16 a[122:123], v18 offset:58368
  s_add_u32 s70, s70, 98304
  v_mfma_f32_16x16x32_bf16 v[140:143], a[44:47], a[12:15], v[140:143]
  ds_read_b128 a[88:91], v15 offset:12288
  v_mfma_f32_16x16x32_bf16 v[136:139], a[40:43], a[12:15], v[136:139]
  s_add_u32 m0, s68, 49152
L_pad70:
  s_cbranch_execz L_warm_ret
  v_mfma_f32_16x16x32_bf16 v[132:135], a[36:39], a[12:15], v[132:135]
  ds_read_b64_tr_b16 a[124:125], v19 offset:57344
  v_mfma_f32_16x16x32_bf16 v[128:131], a[32:35], a[12:15], v[128:131]
  ds_read_b64_tr_b16 a[126:127], v19 offset:58368
  buffer_load_dwordx4 v6, s[40:43], s69 offen lds
  v_mfma_f32_16x16x32_bf16 v[160:163], a[32:35], a[16:19], v[160:163]
  ds_read_b128 a[92:95], v15 offset:14336
  s_add_u32 m0, s68, 53248
  v_mfma_f32_16x16x32_bf16 v[164:167], a[36:39], a[16:19], v[164:167]
  v_mfma_f32_16x16x32_bf16 v[168:171], a[40:43], a[16:19], v[168:171]
  buffer_load_dwordx4 v7, s[40:43], s69 offen lds
  v_mfma_f32_16x16x32_bf16 v[172:175], a[44:47], a[16:19], v[172:175]
  v_mfma_f32_16x16x32_bf16 v[176:179], a[48:51], a[16:19], v[176:179]
  s_add_u32 m0, s68, 57344
  v_mfma_f32_16x16x32_bf16 v[180:183], a[52:55], a[16:19], v[180:183]
  v_mfma_f32_16x16x32_bf16 v[184:187], a[56:59], a[16:19], v[184:187]
  buffer_load_dwordx4 v8, s[40:43], s69 offen lds
  v_mfma_f32_16x16x32_bf16 v[188:191], a[60:63], a[16:19], v[188:191]
  v_mfma_f32_16x16x32_bf16 v[220:223], a[60:63], a[20:23], v[220:223]
  s_add_u32 m0, s68, 61440
  v_mfma_f32_16x16x32_bf16 v[216:219], a[56:59], a[20:23], v[216:219]
  v_mfma_f32_16x16x32_bf16 v[212:215], a[52:55], a[20:23], v[212:215]
  buffer_load_dwordx4 v9, s[40:43], s69 offen lds
  v_mfma_f32_16x16x32_bf16 v[208:211], a[48:51], a[20:23], v[208:211]
  s_add_u32 s8, s8, 1
  v_mfma_f32_16x16x32_bf16 v[204:207], a[44:47], a[20:23], v[204:207]
  v_mfma_f32_16x16x32_bf16 v[200:203], a[40:43], a[20:23], v[200:203]
  s_cmp_eq_u32 s8, 5
  v_mfma_f32_16x16x32_bf16 v[196:199], a[36:39], a[20:23], v[196:199]
  v_mfma_f32_16x16x32_bf16 v[192:195], a[32:35], a[20:23], v[192:195]
  s_cselect_b32 s8, 0, s8
  v_mfma_f32_16x16x32_bf16 v[224:227], a[32:35], a[24:27], v[224:227]
  v_mfma_f32_16x16x32_bf16 v[228:231], a[36:39], a[24:27], v[228:231]
  s_add_u32 s69, s8, s9
  v_mfma_f32_16x16x32_bf16 v[232:235], a[40:43], a[24:27], v[232:235]
  v_mfma_f32_16x16x32_bf16 v[236:239], a[44:47], a[24:27], v[236:239]
  s_lshl_b32 s69, s69, 7
  v_mfma_f32_16x16x32_bf16 a[128:131], a[48:51], a[24:27], a[128:131]
  v_mfma_f32_16x16x32_bf16 a[132:135], a[52:55], a[24:27], a[132:135]
  buffer_load_dwordx4 a[228:231], v20, s[60:63], s79 offen offset:0
  v_mfma_f32_16x16x32_bf16 a[136:139], a[56:59], a[24:27], a[136:139]
  buffer_load_dwordx4 a[232:235], v20, s[60:63], s79 offen offset:1024
  v_mfma_f32_16x16x32_bf16 a[140:143], a[60:63], a[24:27], a[140:143]
  v_mfma_f32_16x16x32_bf16 a[156:159], a[60:63], a[28:31], a[156:159]
  buffer_load_dwordx4 a[236:239], v20, s[60:63], s79 offen offset:2048
  v_mfma_f32_16x16x32_bf16 a[152:155], a[56:59], a[28:31], a[152:155]
  v_mfma_f32_16x16x32_bf16 a[148:151], a[52:55], a[28:31], a[148:151]
  buffer_load_dwordx4 a[240:243], v20, s[60:63], s79 offen offset:3072
  v_mfma_f32_16x16x32_bf16 a[144:147], a[48:51], a[28:31], a[144:147]
  v_mfma_f32_16x16x32_bf16 v[252:255], a[44:47], a[28:31], v[252:255]
  s_add_u32 s79, s79, 4096
  v_mfma_f32_16x16x32_bf16 v[248:251], a[40:43], a[28:31], v[248:251]
  v_mfma_f32_16x16x32_bf16 v[244:247], a[36:39], a[28:31], v[244:247]
  buffer_load_dwordx4 a[228:231], v20, s[60:63], s79 offen offset:0
  v_mfma_f32_16x16x32_bf16 v[240:243], a[32:35], a[28:31], v[240:243]
  v_mfma_f32_16x16x32_bf16 a[160:163], a[180:183], a[0:3], a[160:163]
  s_waitcnt lgkmcnt(0)
  v_mfma_f32_16x16x32_bf16 v[32:35], a[96:99], a[64:67], v[32:35]
  v_mfma_f32_16x16x32_bf16 v[36:39], a[100:103], a[64:67], v[36:39]
  v_mfma_f32_16x16x32_bf16 v[40:43], a[104:107], a[64:67], v[40:43]
  v_mfma_f32_16x16x32_bf16 v[44:47], a[108:111], a[64:67], v[44:47]
  s_waitcnt vmcnt(23)
  s_barrier
  ds_read_b64_tr_b16 a[32:33], v16 offset:0
  v_mfma_f32_16x16x32_bf16 v[48:51], a[112:115], a[64:67], v[48:51]
  ds_read_b64_tr_b16 a[34:35], v16 offset:1024
  v_mfma_f32_16x16x32_bf16 v[52:55], a[116:119], a[64:67], v[52:55]
  ds_read_b128 a[0:3], v12 offset:0
  v_mfma_f32_16x16x32_bf16 v[56:59], a[120:123], a[64:67], v[56:59]
  ds_read_b64_tr_b16 a[36:37], v17 offset:0
  v_mfma_f32_16x16x32_bf16 v[60:63], a[124:127], a[64:67], v[60:63]
  v_mfma_f32_16x16x32_bf16 v[92:95], a[124:127], a[68:71], v[92:95]
  ds_read_b64_tr_b16 a[38:39], v17 offset:1024
  v_mfma_f32_16x16x32_bf16 v[88:91], a[120:123], a[68:71], v[88:91]
  ds_read_b128 a[4:7], v12 offset:2048
  v_mfma_f32_16x16x32_bf16 v[84:87], a[116:119], a[68:71], v[84:87]
  ds_read_b64_tr_b16 a[40:41], v18 offset:0
  v_mfma_f32_16x16x32_bf16 v[80:83], a[112:115], a[68:71], v[80:83]
  s_add_u32 m0, s68, 147456
  v_mfma_f32_16x16x32_bf16 v[76:79], a[108:111], a[68:71], v[76:79]
  ds_read_b64_tr_b16 a[42:43], v18 offset:1024
  buffer_load_dwordx4 v10, s[48:51], s70 offen lds
  v_mfma_f32_16x16x32_bf16 v[72:75], a[104:107], a[68:71], v[72:75]
  ds_read_b128 a[8:11], v12 offset:4096
  v_mfma_f32_16x16x32_bf16 v[68:71], a[100:103], a[68:71], v[68:71]
  ds_read_b64_tr_b16 a[44:45], v19 offset:0
  s_add_u32 m0, s68, 151552
  v_mfma_f32_16x16x32_bf16 v[64:67], a[96:99], a[68:71], v[64:67]
  ds_read_b64_tr_b16 a[46:47], v19 offset:1024
  v_mfma_f32_16x16x32_bf16 v[96:99], a[96:99], a[72:75], v[96:99]
  buffer_load_dwordx4 v11, s[48:51], s70 offen lds
  v_mfma_f32_16x16x32_bf16 v[100:103], a[100:103], a[72:75], v[100:103]
  ds_read_b128 a[12:15], v12 offset:6144
  v_mfma_f32_16x16x32_bf16 v[104:107], a[104:107], a[72:75], v[104:107]
  ds_read_b64_tr_b16 a[48:49], v16 offset:8192
  s_add_u32 m0, s68, 155648
  v_mfma_f32_16x16x32_bf16 v[108:111], a[108:111], a[72:75], v[108:111]
  ds_read_b64_tr_b16 a[50:51], v16 offset:9216
  v_mfma_f32_16x16x32_bf16 v[112:115], a[112:115], a[72:75], v[112:115]
  buffer_load_dwordx4 v10, s[52:55], s70 offen lds
  v_mfma_f32_16x16x32_bf16 v[116:119], a[116:119], a[72:75], v[116:119]
  ds_read_b128 a[16:19], v12 offset:8192
  s_add_u32 m0, s68, 159744
  v_mfma_f32_16x16x32_bf16 v[120:123], a[120:123], a[72:75], v[120:123]
  ds_read_b64_tr_b16 a[52:53], v17 offset:8192
  v_mfma_f32_16x16x32_bf16 v[124:127], a[124:127], a[72:75], v[124:127]
  ds_read_b64_tr_b16 a[54:55], v17 offset:9216
  buffer_load_dwordx4 v11, s[52:55], s70 offen lds
  v_mfma_f32_16x16x32_bf16 v[156:159], a[124:127], a[76:79], v[156:159]
  ds_read_b128 a[20:23], v12 offset:10240
  v_mfma_f32_16x16x32_bf16 v[152:155], a[120:123], a[76:79], v[152:155]
  buffer_load_dwordx4 a[176:179], v24, s[64:67], s71 offen offset:64
  v_mfma_f32_16x16x32_bf16 v[148:151], a[116:119], a[76:79], v[148:151]
  ds_read_b64_tr_b16 a[56:57], v18 offset:8192
  v_mfma_f32_16x16x32_bf16 v[144:147], a[112:115], a[76:79], v[144:147]
  ds_read_b64_tr_b16 a[58:59], v18 offset:9216
  s_add_u32 s10, s10, 1
  v_mfma_f32_16x16x32_bf16 v[140:143], a[108:111], a[76:79], v[140:143]
  ds_read_b128 a[24:27], v12 offset:12288
  v_mfma_f32_16x16x32_bf16 v[136:139], a[104:107], a[76:79], v[136:139]
  s_cmp_eq_u32 s10, 5
  v_mfma_f32_16x16x32_bf16 v[132:135], a[100:103], a[76:79], v[132:135]
  ds_read_b64_tr_b16 a[60:61], v19 offset:8192
  v_mfma_f32_16x16x32_bf16 v[128:131], a[96:99], a[76:79], v[128:131]
  ds_read_b64_tr_b16 a[62:63], v19 offset:9216
  s_cselect_b32 s10, 0, s10
  v_mfma_f32_16x16x32_bf16 v[160:163], a[96:99], a[80:83], v[160:163]
  ds_read_b128 a[28:31], v12 offset:14336
  s_add_u32 s71, s10, s11
  v_mfma_f32_16x16x32_bf16 v[164:167], a[100:103], a[80:83], v[164:167]
  v_mfma_f32_16x16x32_bf16 v[168:171], a[104:107], a[80:83], v[168:171]
  s_mul_i32 s70, s71, 196608
  v_mfma_f32_16x16x32_bf16 v[172:175], a[108:111], a[80:83], v[172:175]
  v_mfma_f32_16x16x32_bf16 v[176:179], a[112:115], a[80:83], v[176:179]
  s_lshl_b32 s71, s71, 7
  v_mfma_f32_16x16x32_bf16 v[180:183], a[116:119], a[80:83], v[180:183]
  v_mfma_f32_16x16x32_bf16 v[184:187], a[120:123], a[80:83], v[184:187]
  s_add_u32 m0, s68, 65536
  v_mfma_f32_16x16x32_bf16 v[188:191], a[124:127], a[80:83], v[188:191]
  v_mfma_f32_16x16x32_bf16 v[220:223], a[124:127], a[84:87], v[220:223]
  buffer_load_dwordx4 v2, s[40:43], s69 offen lds
  v_mfma_f32_16x16x32_bf16 v[216:219], a[120:123], a[84:87], v[216:219]
  v_mfma_f32_16x16x32_bf16 v[212:215], a[116:119], a[84:87], v[212:215]
  s_add_u32 m0, s68, 69632
  v_mfma_f32_16x16x32_bf16 v[208:211], a[112:115], a[84:87], v[208:211]
  buffer_load_dwordx4 v3, s[40:43], s69 offen lds
  v_mfma_f32_16x16x32_bf16 v[204:207], a[108:111], a[84:87], v[204:207]
  v_mfma_f32_16x16x32_bf16 v[200:203], a[104:107], a[84:87], v[200:203]
  s_add_u32 m0, s68, 73728
  v_mfma_f32_16x16x32_bf16 v[196:199], a[100:103], a[84:87], v[196:199]
  v_mfma_f32_16x16x32_bf16 v[192:195], a[96:99], a[84:87], v[192:195]
  buffer_load_dwordx4 v4, s[40:43], s69 offen lds
  v_mfma_f32_16x16x32_bf16 v[224:227], a[96:99], a[88:91], v[224:227]
  v_mfma_f32_16x16x32_bf16 v[228:231], a[100:103], a[88:91], v[228:231]
  s_add_u32 m0, s68, 77824
  v_mfma_f32_16x16x32_bf16 v[232:235], a[104:107], a[88:91], v[232:235]
  v_mfma_f32_16x16x32_bf16 v[236:239], a[108:111], a[88:91], v[236:239]
  buffer_load_dwordx4 v5, s[40:43], s69 offen lds
  v_mfma_f32_16x16x32_bf16 a[128:131], a[112:115], a[88:91], a[128:131]
  v_mfma_f32_16x16x32_bf16 a[132:135], a[116:119], a[88:91], a[132:135]
  buffer_load_dwordx4 a[232:235], v20, s[60:63], s79 offen offset:1024
  v_mfma_f32_16x16x32_bf16 a[136:139], a[120:123], a[88:91], a[136:139]
  buffer_load_dwordx4 a[236:239], v20, s[60:63], s79 offen offset:2048
  v_mfma_f32_16x16x32_bf16 a[140:143], a[124:127], a[88:91], a[140:143]
  v_mfma_f32_16x16x32_bf16 a[156:159], a[124:127], a[92:95], a[156:159]
  buffer_load_dwordx4 a[240:243], v20, s[60:63], s79 offen offset:3072
  v_mfma_f32_16x16x32_bf16 a[152:155], a[120:123], a[92:95], a[152:155]
  v_mfma_f32_16x16x32_bf16 a[148:151], a[116:119], a[92:95], a[148:151]
  s_add_u32 s79, s79, 4096
  v_mfma_f32_16x16x32_bf16 a[144:147], a[112:115], a[92:95], a[144:147]
  v_mfma_f32_16x16x32_bf16 v[252:255], a[108:111], a[92:95], v[252:255]
  buffer_load_dwordx4 a[228:231], v20, s[60:63], s79 offen offset:0
  v_mfma_f32_16x16x32_bf16 v[248:251], a[104:107], a[92:95], v[248:251]
  v_mfma_f32_16x16x32_bf16 v[244:247], a[100:103], a[92:95], v[244:247]
  buffer_load_dwordx4 a[232:235], v20, s[60:63], s79 offen offset:1024
  v_mfma_f32_16x16x32_bf16 v[240:243], a[96:99], a[92:95], v[240:243]
  v_mfma_f32_16x16x32_bf16 a[160:163], a[184:187], a[64:67], a[160:163]
  s_waitcnt lgkmcnt(0)
  v_mfma_f32_16x16x32_bf16 v[32:35], a[32:35], a[0:3], v[32:35]
  v_mfma_f32_16x16x32_bf16 v[36:39], a[36:39], a[0:3], v[36:39]
  v_mfma_f32_16x16x32_bf16 v[40:43], a[40:43], a[0:3], v[40:43]
  v_mfma_f32_16x16x32_bf16 v[44:47], a[44:47], a[0:3], v[44:47]
  s_waitcnt vmcnt(32)
  s_barrier
  ds_read_b64_tr_b16 a[96:97], v16 offset:16384
  v_mfma_f32_16x16x32_bf16 v[48:51], a[48:51], a[0:3], v[48:51]
  ds_read_b64_tr_b16 a[98:99], v16 offset:17408
  v_mfma_f32_16x16x32_bf16 v[52:55], a[52:55], a[0:3], v[52:55]
  ds_read_b128 a[64:67], v13 offset:0
  v_mfma_f32_16x16x32_bf16 v[56:59], a[56:59], a[0:3], v[56:59]
  ds_read_b64_tr_b16 a[100:101], v17 offset:16384
  v_mfma_f32_16x16x32_bf16 v[60:63], a[60:63], a[0:3], v[60:63]
  v_mfma_f32_16x16x32_bf16 v[92:95], a[60:63], a[4:7], v[92:95]
  ds_read_b64_tr_b16 a[102:103], v17 offset:17408
  v_mfma_f32_16x16x32_bf16 v[88:91], a[56:59], a[4:7], v[88:91]
  ds_read_b128 a[68:71], v13 offset:2048
  v_mfma_f32_16x16x32_bf16 v[84:87], a[52:55], a[4:7], v[84:87]
  ds_read_b64_tr_b16 a[104:105], v18 offset:16384
  v_mfma_f32_16x16x32_bf16 v[80:83], a[48:51], a[4:7], v[80:83]
  s_add_u32 m0, s68, 98304
  v_mfma_f32_16x16x32_bf16 v[76:79], a[44:47], a[4:7], v[76:79]
  ds_read_b64_tr_b16 a[106:107], v18 offset:17408
  buffer_load_dwordx4 v10, s[48:51], s70 offen lds
  v_mfma_f32_16x16x32_bf16 v[72:75], a[40:43], a[4:7], v[72:75]
  ds_read_b128 a[72:75], v13 offset:4096
  v_mfma_f32_16x16x32_bf16 v[68:71], a[36:39], a[4:7], v[68:71]
  ds_read_b64_tr_b16 a[108:109], v19 offset:16384
  s_add_u32 m0, s68, 102400
  v_mfma_f32_16x16x32_bf16 v[64:67], a[32:35], a[4:7], v[64:67]
  ds_read_b64_tr_b16 a[110:111], v19 offset:17408
  v_mfma_f32_16x16x32_bf16 v[96:99], a[32:35], a[8:11], v[96:99]
  buffer_load_dwordx4 v11, s[48:51], s70 offen lds
  v_mfma_f32_16x16x32_bf16 v[100:103], a[36:39], a[8:11], v[100:103]
  ds_read_b128 a[76:79], v13 offset:6144
  v_mfma_f32_16x16x32_bf16 v[104:107], a[40:43], a[8:11], v[104:107]
  ds_read_b64_tr_b16 a[112:113], v16 offset:24576
  s_add_u32 m0, s68, 106496
  v_mfma_f32_16x16x32_bf16 v[108:111], a[44:47], a[8:11], v[108:111]
  ds_read_b64_tr_b16 a[114:115], v16 offset:25600
  v_mfma_f32_16x16x32_bf16 v[112:115], a[48:51], a[8:11], v[112:115]
  buffer_load_dwordx4 v10, s[52:55], s70 offen lds
  v_mfma_f32_16x16x32_bf16 v[116:119], a[52:55], a[8:11], v[116:119]
  ds_read_b128 a[80:83], v13 offset:8192
  s_add_u32 m0, s68, 110592
  v_mfma_f32_16x16x32_bf16 v[120:123], a[56:59], a[8:11], v[120:123]
  ds_read_b64_tr_b16 a[116:117], v17 offset:24576
  v_mfma_f32_16x16x32_bf16 v[124:127], a[60:63], a[8:11], v[124:127]
  ds_read_b64_tr_b16 a[118:119], v17 offset:25600
  buffer_load_dwordx4 v11, s[52:55], s70 offen lds
  v_mfma_f32_16x16x32_bf16 v[156:159], a[60:63], a[12:15], v[156:159]
  ds_read_b128 a[84:87], v13 offset:10240
  v_mfma_f32_16x16x32_bf16 v[152:155], a[56:59], a[12:15], v[152:155]
  buffer_load_dwordx4 a[180:183], v24, s[64:67], s71 offen offset:0
  v_mfma_f32_16x16x32_bf16 v[148:151], a[52:55], a[12:15], v[148:151]
  ds_read_b64_tr_b16 a[120:121], v18 offset:24576
  v_mfma_f32_16x16x32_bf16 v[144:147], a[48:51], a[12:15], v[144:147]
  ds_read_b64_tr_b16 a[122:123], v18 offset:25600
  s_add_u32 s70, s70, 98304
  v_mfma_f32_16x16x32_bf16 v[140:143], a[44:47], a[12:15], v[140:143]
  ds_read_b128 a[88:91], v13 offset:12288
  v_mfma_f32_16x16x32_bf16 v[136:139], a[40:43], a[12:15], v[136:139]
  s_add_u32 m0, s68, 81920
  v_mfma_f32_16x16x32_bf16 v[132:135], a[36:39], a[12:15], v[132:135]
  ds_read_b64_tr_b16 a[124:125], v19 offset:24576
  v_mfma_f32_16x16x32_bf16 v[128:131], a[32:35], a[12:15], v[128:131]
  ds_read_b64_tr_b16 a[126:127], v19 offset:25600
  buffer_load_dwordx4 v6, s[40:43], s69 offen lds
  v_mfma_f32_16x16x32_bf16 v[160:163], a[32:35], a[16:19], v[160:163]
  ds_read_b128 a[92:95], v13 offset:14336
  s_add_u32 m0, s68, 86016
  v_mfma_f32_16x16x32_bf16 v[164:167], a[36:39], a[16:19], v[164:167]
  v_mfma_f32_16x16x32_bf16 v[168:171], a[40:43], a[16:19], v[168:171]
  buffer_load_dwordx4 v7, s[40:43], s69 offen lds
  v_mfma_f32_16x16x32_bf16 v[172:175], a[44:47], a[16:19], v[172:175]
  v_mfma_f32_16x16x32_bf16 v[176:179], a[48:51], a[16:19], v[176:179]
  s_add_u32 m0, s68, 90112
  v_mfma_f32_16x16x32_bf16 v[180:183], a[52:55], a[16:19], v[180:183]
  v_mfma_f32_16x16x32_bf16 v[184:187], a[56:59], a[16:19], v[184:187]
  buffer_load_dwordx4 v8, s[40:43], s69 offen lds
  v_mfma_f32_16x16x32_bf16 v[188:191], a[60:63], a[16:19], v[188:191]
  v_mfma_f32_16x16x32_bf16 v[220:223], a[60:63], a[20:23], v[220:223]
  s_add_u32 m0, s68, 94208
  v_mfma_f32_16x16x32_bf16 v[216:219], a[56:59], a[20:23], v[216:219]
  v_mfma_f32_16x16x32_bf16 v[212:215], a[52:55], a[20:23], v[212:215]
L_pad71:
  s_cbranch_execz L_warm_ret
  buffer_load_dwordx4 v9, s[40:43], s69 offen lds
  v_mfma_f32_16x16x32_bf16 v[208:211], a[48:51], a[20:23], v[208:211]
  s_add_u32 s8, s8, 1
  v_mfma_f32_16x16x32_bf16 v[204:207], a[44:47], a[20:23], v[204:207]
  v_mfma_f32_16x16x32_bf16 v[200:203], a[40:43], a[20:23], v[200:203]
  s_cmp_eq_u32 s8, 5
  v_mfma_f32_16x16x32_bf16 v[196:199], a[36:39], a[20:23], v[196:199]
  v_mfma_f32_16x16x32_bf16 v[192:195], a[32:35], a[20:23], v[192:195]
  s_cselect_b32 s8, 0, s8
  v_mfma_f32_16x16x32_bf16 v[224:227], a[32:35], a[24:27], v[224:227]
  v_mfma_f32_16x16x32_bf16 v[228:231], a[36:39], a[24:27], v[228:231]
  s_add_u32 s69, s8, s9
  v_mfma_f32_16x16x32_bf16 v[232:235], a[40:43], a[24:27], v[232:235]
  v_mfma_f32_16x16x32_bf16 v[236:239], a[44:47], a[24:27], v[236:239]
  s_lshl_b32 s69, s69, 7
  v_mfma_f32_16x16x32_bf16 a[128:131], a[48:51], a[24:27], a[128:131]
  v_mfma_f32_16x16x32_bf16 a[132:135], a[52:55], a[24:27], a[132:135]
  buffer_load_dwordx4 a[236:239], v20, s[60:63], s79 offen offset:2048
  v_mfma_f32_16x16x32_bf16 a[136:139], a[56:59], a[24:27], a[136:139]
  buffer_load_dwordx4 a[240:243], v20, s[60:63], s79 offen offset:3072
  v_mfma_f32_16x16x32_bf16 a[140:143], a[60:63], a[24:27], a[140:143]
  v_mfma_f32_16x16x32_bf16 a[156:159], a[60:63], a[28:31], a[156:159]
  s_add_u32 s79, s79, 4096
  v_mfma_f32_16x16x32_bf16 a[152:155], a[56:59], a[28:31], a[152:155]
  v_mfma_f32_16x16x32_bf16 a[148:151], a[52:55], a[28:31], a[148:151]
  buffer_load_dwordx4 a[228:231], v20, s[60:63], s79 offen offset:0
  v_mfma_f32_16x16x32_bf16 a[144:147], a[48:51], a[28:31], a[144:147]
  v_mfma_f32_16x16x32_bf16 v[252:255], a[44:47], a[28:31], v[252:255]
  buffer_load_dwordx4 a[232:235], v20, s[60:63], s79 offen offset:1024
  v_mfma_f32_16x16x32_bf16 v[248:251], a[40:43], a[28:31], v[248:251]
  v_mfma_f32_16x16x32_bf16 v[244:247], a[36:39], a[28:31], v[244:247]
  buffer_load_dwordx4 a[236:239], v20, s[60:63], s79 offen offset:2048
  v_mfma_f32_16x16x32_bf16 v[240:243], a[32:35], a[28:31], v[240:243]
  v_mfma_f32_16x16x32_bf16 a[160:163], a[164:167], a[0:3], a[160:163]
  s_waitcnt lgkmcnt(0)
  v_mfma_f32_16x16x32_bf16 v[32:35], a[96:99], a[64:67], v[32:35]
  v_mfma_f32_16x16x32_bf16 v[36:39], a[100:103], a[64:67], v[36:39]
  v_mfma_f32_16x16x32_bf16 v[40:43], a[104:107], a[64:67], v[40:43]
  v_mfma_f32_16x16x32_bf16 v[44:47], a[108:111], a[64:67], v[44:47]
  s_waitcnt vmcnt(33)
  s_barrier
  ds_read_b64_tr_b16 a[32:33], v16 offset:32768
  v_mfma_f32_16x16x32_bf16 v[48:51], a[112:115], a[64:67], v[48:51]
  ds_read_b64_tr_b16 a[34:35], v16 offset:33792
  v_mfma_f32_16x16x32_bf16 v[52:55], a[116:119], a[64:67], v[52:55]
  ds_read_b128 a[0:3], v12 offset:32768
  v_mfma_f32_16x16x32_bf16 v[56:59], a[120:123], a[64:67], v[56:59]
  ds_read_b64_tr_b16 a[36:37], v17 offset:32768
  v_mfma_f32_16x16x32_bf16 v[60:63], a[124:127], a[64:67], v[60:63]
  v_mfma_f32_16x16x32_bf16 v[92:95], a[124:127], a[68:71], v[92:95]
  ds_read_b64_tr_b16 a[38:39], v17 offset:33792
  v_mfma_f32_16x16x32_bf16 v[88:91], a[120:123], a[68:71], v[88:91]
  ds_read_b128 a[4:7], v12 offset:34816
  v_mfma_f32_16x16x32_bf16 v[84:87], a[116:119], a[68:71], v[84:87]
  ds_read_b64_tr_b16 a[40:41], v18 offset:32768
  v_mfma_f32_16x16x32_bf16 v[80:83], a[112:115], a[68:71], v[80:83]
  s_add_u32 m0, s68, 114688
  v_mfma_f32_16x16x32_bf16 v[76:79], a[108:111], a[68:71], v[76:79]
  ds_read_b64_tr_b16 a[42:43], v18 offset:33792
  buffer_load_dwordx4 v10, s[48:51], s70 offen lds
  v_mfma_f32_16x16x32_bf16 v[72:75], a[104:107], a[68:71], v[72:75]
  ds_read_b128 a[8:11], v12 offset:36864
  v_mfma_f32_16x16x32_bf16 v[68:71], a[100:103], a[68:71], v[68:71]
  ds_read_b64_tr_b16 a[44:45], v19 offset:32768
  s_add_u32 m0, s68, 118784
  v_mfma_f32_16x16x32_bf16 v[64:67], a[96:99], a[68:71], v[64:67]
  ds_read_b64_tr_b16 a[46:47], v19 offset:33792
  v_mfma_f32_16x16x32_bf16 v[96:99], a[96:99], a[72:75], v[96:99]
  buffer_load_dwordx4 v11, s[48:51], s70 offen lds
  v_mfma_f32_16x16x32_bf16 v[100:103], a[100:103], a[72:75], v[100:103]
  ds_read_b128 a[12:15], v12 offset:38912
  s_add_u32 m0, s68, 122880
  v_mfma_f32_16x16x32_bf16 v[104:107], a[104:107], a[72:75], v[104:107]
  ds_read_b64_tr_b16 a[48:49], v16 offset:40960
  v_mfma_f32_16x16x32_bf16 v[108:111], a[108:111], a[72:75], v[108:111]
  ds_read_b64_tr_b16 a[50:51], v16 offset:41984
  buffer_load_dwordx4 v10, s[52:55], s70 offen lds
  v_mfma_f32_16x16x32_bf16 v[112:115], a[112:115], a[72:75], v[112:115]
  v_mfma_f32_16x16x32_bf16 v[116:119], a[116:119], a[72:75], v[116:119]
  ds_read_b128 a[16:19], v12 offset:40960
  s_add_u32 m0, s68, 126976
  v_mfma_f32_16x16x32_bf16 v[120:123], a[120:123], a[72:75], v[120:123]
  ds_read_b64_tr_b16 a[52:53], v17 offset:40960
  buffer_load_dwordx4 v11, s[52:55], s70 offen lds
  v_mfma_f32_16x16x32_bf16 v[124:127], a[124:127], a[72:75], v[124:127]
  ds_read_b64_tr_b16 a[54:55], v17 offset:41984
  v_mfma_f32_16x16x32_bf16 v[156:159], a[124:127], a[76:79], v[156:159]
  ds_read_b128 a[20:23], v12 offset:43008
  buffer_load_dwordx4 a[184:187], v24, s[64:67], s71 offen offset:64
  v_mfma_f32_16x16x32_bf16 v[152:155], a[120:123], a[76:79], v[152:155]
  v_mfma_f32_16x16x32_bf16 v[148:151], a[116:119], a[76:79], v[148:151]
  ds_read_b64_tr_b16 a[56:57], v18 offset:40960
  s_add_u32 s10, s10, 1
  v_mfma_f32_16x16x32_bf16 v[144:147], a[112:115], a[76:79], v[144:147]
  ds_read_b64_tr_b16 a[58:59], v18 offset:41984
  v_mfma_f32_16x16x32_bf16 v[140:143], a[108:111], a[76:79], v[140:143]
  ds_read_b128 a[24:27], v12 offset:45056
  s_cmp_eq_u32 s10, 5
  v_mfma_f32_16x16x32_bf16 v[136:139], a[104:107], a[76:79], v[136:139]
  s_cselect_b32 s10, 0, s10
  v_mfma_f32_16x16x32_bf16 v[132:135], a[100:103], a[76:79], v[132:135]
  ds_read_b64_tr_b16 a[60:61], v19 offset:40960
  v_mfma_f32_16x16x32_bf16 v[128:131], a[96:99], a[76:79], v[128:131]
  ds_read_b64_tr_b16 a[62:63], v19 offset:41984
  s_add_u32 s71, s10, s11
  v_mfma_f32_16x16x32_bf16 v[160:163], a[96:99], a[80:83], v[160:163]
  ds_read_b128 a[28:31], v12 offset:47104
  v_mfma_f32_16x16x32_bf16 v[164:167], a[100:103], a[80:83], v[164:167]
  s_mul_i32 s70, s71, 196608
  v_mfma_f32_16x16x32_bf16 v[168:171], a[104:107], a[80:83], v[168:171]
  s_lshl_b32 s71, s71, 7
  v_mfma_f32_16x16x32_bf16 v[172:175], a[108:111], a[80:83], v[172:175]
  v_mfma_f32_16x16x32_bf16 v[176:179], a[112:115], a[80:83], v[176:179]
  s_add_u32 m0, s68, 0
  v_mfma_f32_16x16x32_bf16 v[180:183], a[116:119], a[80:83], v[180:183]
  v_mfma_f32_16x16x32_bf16 v[184:187], a[120:123], a[80:83], v[184:187]
  buffer_load_dwordx4 v2, s[40:43], s69 offen lds
  v_mfma_f32_16x16x32_bf16 v[188:191], a[124:127], a[80:83], v[188:191]
  v_mfma_f32_16x16x32_bf16 v[220:223], a[124:127], a[84:87], v[220:223]
  s_add_u32 m0, s68, 4096
  v_mfma_f32_16x16x32_bf16 v[216:219], a[120:123], a[84:87], v[216:219]
  buffer_load_dwordx4 v3, s[40:43], s69 offen lds
  v_mfma_f32_16x16x32_bf16 v[212:215], a[116:119], a[84:87], v[212:215]
  v_mfma_f32_16x16x32_bf16 v[208:211], a[112:115], a[84:87], v[208:211]
  s_add_u32 m0, s68, 8192
  v_mfma_f32_16x16x32_bf16 v[204:207], a[108:111], a[84:87], v[204:207]
  v_mfma_f32_16x16x32_bf16 v[200:203], a[104:107], a[84:87], v[200:203]
  buffer_load_dwordx4 v4, s[40:43], s69 offen lds
  v_mfma_f32_16x16x32_bf16 v[196:199], a[100:103], a[84:87], v[196:199]
  s_add_u32 m0, s68, 12288
  v_mfma_f32_16x16x32_bf16 v[192:195], a[96:99], a[84:87], v[192:195]
  v_mfma_f32_16x16x32_bf16 v[224:227], a[96:99], a[88:91], v[224:227]
  buffer_load_dwordx4 v5, s[40:43], s69 offen lds
  v_mfma_f32_16x16x32_bf16 v[228:231], a[100:103], a[88:91], v[228:231]
  v_mfma_f32_16x16x32_bf16 v[232:235], a[104:107], a[88:91], v[232:235]
  buffer_load_dwordx2 a[252:253], off, s[96:99], 0
  v_mfma_f32_16x16x32_bf16 v[236:239], a[108:111], a[88:91], v[236:239]
  v_mfma_f32_16x16x32_bf16 a[128:131], a[112:115], a[88:91], a[128:131]
  buffer_load_dwordx4 a[240:243], v20, s[60:63], s79 offen offset:3072
  v_mfma_f32_16x16x32_bf16 a[132:135], a[116:119], a[88:91], a[132:135]
  s_add_u32 s79, s79, 4096
  v_mfma_f32_16x16x32_bf16 a[136:139], a[120:123], a[88:91], a[136:139]
  v_mfma_f32_16x16x32_bf16 a[140:143], a[124:127], a[88:91], a[140:143]
  buffer_load_dwordx4 a[228:231], v20, s[60:63], s79 offen offset:0
  v_mfma_f32_16x16x32_bf16 a[156:159], a[124:127], a[92:95], a[156:159]
  v_mfma_f32_16x16x32_bf16 a[152:155], a[120:123], a[92:95], a[152:155]
  buffer_load_dwordx4 a[232:235], v20, s[60:63], s79 offen offset:1024
  v_mfma_f32_16x16x32_bf16 a[148:151], a[116:119], a[92:95], a[148:151]
  buffer_load_dwordx4 a[236:239], v20, s[60:63], s79 offen offset:2048
  v_mfma_f32_16x16x32_bf16 a[144:147], a[112:115], a[92:95], a[144:147]
  v_mfma_f32_16x16x32_bf16 v[252:255], a[108:111], a[92:95], v[252:255]
  buffer_load_dwordx4 a[240:243], v20, s[60:63], s79 offen offset:3072
  v_mfma_f32_16x16x32_bf16 v[248:251], a[104:107], a[92:95], v[248:251]
  v_mfma_f32_16x16x32_bf16 v[244:247], a[100:103], a[92:95], v[244:247]
  s_add_u32 s79, s79, 4096
  v_mfma_f32_16x16x32_bf16 v[240:243], a[96:99], a[92:95], v[240:243]
  v_mfma_f32_16x16x32_bf16 a[160:163], a[168:171], a[64:67], a[160:163]
  s_waitcnt lgkmcnt(0)
  v_mfma_f32_16x16x32_bf16 v[32:35], a[32:35], a[0:3], v[32:35]
  v_mfma_f32_16x16x32_bf16 v[36:39], a[36:39], a[0:3], v[36:39]
  v_mfma_f32_16x16x32_bf16 v[40:43], a[40:43], a[0:3], v[40:43]
  v_mfma_f32_16x16x32_bf16 v[44:47], a[44:47], a[0:3], v[44:47]
  s_waitcnt vmcnt(38)
  s_barrier
  ds_read_b64_tr_b16 a[96:97], v16 offset:49152
  v_mfma_f32_16x16x32_bf16 v[48:51], a[48:51], a[0:3], v[48:51]
  ds_read_b64_tr_b16 a[98:99], v16 offset:50176
  v_mfma_f32_16x16x32_bf16 v[52:55], a[52:55], a[0:3], v[52:55]
  ds_read_b128 a[64:67], v13 offset:32768
  v_mfma_f32_16x16x32_bf16 v[56:59], a[56:59], a[0:3], v[56:59]
  ds_read_b64_tr_b16 a[100:101], v17 offset:49152
  v_mfma_f32_16x16x32_bf16 v[60:63], a[60:63], a[0:3], v[60:63]
  v_mfma_f32_16x16x32_bf16 v[92:95], a[60:63], a[4:7], v[92:95]
  ds_read_b64_tr_b16 a[102:103], v17 offset:50176
  v_mfma_f32_16x16x32_bf16 v[88:91], a[56:59], a[4:7], v[88:91]
  ds_read_b128 a[68:71], v13 offset:34816
  v_mfma_f32_16x16x32_bf16 v[84:87], a[52:55], a[4:7], v[84:87]
  ds_read_b64_tr_b16 a[104:105], v18 offset:49152
  v_mfma_f32_16x16x32_bf16 v[80:83], a[48:51], a[4:7], v[80:83]
  s_add_u32 m0, s68, 131072
  v_mfma_f32_16x16x32_bf16 v[76:79], a[44:47], a[4:7], v[76:79]
  ds_read_b64_tr_b16 a[106:107], v18 offset:50176
  buffer_load_dwordx4 v10, s[48:51], s70 offen lds
  v_mfma_f32_16x16x32_bf16 v[72:75], a[40:43], a[4:7], v[72:75]
  ds_read_b128 a[72:75], v13 offset:36864
  v_mfma_f32_16x16x32_bf16 v[68:71], a[36:39], a[4:7], v[68:71]
  ds_read_b64_tr_b16 a[108:109], v19 offset:49152
  s_add_u32 m0, s68, 135168
  v_mfma_f32_16x16x32_bf16 v[64:67], a[32:35], a[4:7], v[64:67]
  ds_read_b64_tr_b16 a[110:111], v19 offset:50176
  buffer_load_dwordx4 v11, s[48:51], s70 offen lds
  v_mfma_f32_16x16x32_bf16 v[96:99], a[32:35], a[8:11], v[96:99]
  v_mfma_f32_16x16x32_bf16 v[100:103], a[36:39], a[8:11], v[100:103]
  ds_read_b128 a[76:79], v13 offset:38912
  s_add_u32 m0, s68, 139264
  v_mfma_f32_16x16x32_bf16 v[104:107], a[40:43], a[8:11], v[104:107]
  ds_read_b64_tr_b16 a[112:113], v16 offset:57344
  v_mfma_f32_16x16x32_bf16 v[108:111], a[44:47], a[8:11], v[108:111]
  ds_read_b64_tr_b16 a[114:115], v16 offset:58368
  buffer_load_dwordx4 v10, s[52:55], s70 offen lds
  v_mfma_f32_16x16x32_bf16 v[112:115], a[48:51], a[8:11], v[112:115]
  s_add_u32 m0, s68, 143360
  v_mfma_f32_16x16x32_bf16 v[116:119], a[52:55], a[8:11], v[116:119]
  ds_read_b128 a[80:83], v13 offset:40960
  v_mfma_f32_16x16x32_bf16 v[120:123], a[56:59], a[8:11], v[120:123]
  ds_read_b64_tr_b16 a[116:117], v17 offset:57344
  buffer_load_dwordx4 v11, s[52:55], s70 offen lds
  v_mfma_f32_16x16x32_bf16 v[124:127], a[60:63], a[8:11], v[124:127]
  ds_read_b64_tr_b16 a[118:119], v17 offset:58368
  v_mfma_f32_16x16x32_bf16 v[156:159], a[60:63], a[12:15], v[156:159]
  ds_read_b128 a[84:87], v13 offset:43008
  buffer_load_dwordx4 a[164:167], v24, s[64:67], s71 offen offset:0
  v_mfma_f32_16x16x32_bf16 v[152:155], a[56:59], a[12:15], v[152:155]
  s_add_u32 s70, s70, 98304
  v_mfma_f32_16x16x32_bf16 v[148:151], a[52:55], a[12:15], v[148:151]
  ds_read_b64_tr_b16 a[120:121], v18 offset:57344
  v_mfma_f32_16x16x32_bf16 v[144:147], a[48:51], a[12:15], v[144:147]
  ds_read_b64_tr_b16 a[122:123], v18 offset:58368
  s_add_u32 m0, s68, 16384
  v_mfma_f32_16x16x32_bf16 v[140:143], a[44:47], a[12:15], v[140:143]
  ds_read_b128 a[88:91], v13 offset:45056
  v_mfma_f32_16x16x32_bf16 v[136:139], a[40:43], a[12:15], v[136:139]
  buffer_load_dwordx4 v6, s[40:43], s69 offen lds
  v_mfma_f32_16x16x32_bf16 v[132:135], a[36:39], a[12:15], v[132:135]
  ds_read_b64_tr_b16 a[124:125], v19 offset:57344
  s_add_u32 m0, s68, 20480
  v_mfma_f32_16x16x32_bf16 v[128:131], a[32:35], a[12:15], v[128:131]
  ds_read_b64_tr_b16 a[126:127], v19 offset:58368
  v_mfma_f32_16x16x32_bf16 v[160:163], a[32:35], a[16:19], v[160:163]
  ds_read_b128 a[92:95], v13 offset:47104
  buffer_load_dwordx4 v7, s[40:43], s69 offen lds
  v_mfma_f32_16x16x32_bf16 v[164:167], a[36:39], a[16:19], v[164:167]
  v_mfma_f32_16x16x32_bf16 v[168:171], a[40:43], a[16:19], v[168:171]
  s_add_u32 m0, s68, 24576
  v_mfma_f32_16x16x32_bf16 v[172:175], a[44:47], a[16:19], v[172:175]
  buffer_load_dwordx4 v8, s[40:43], s69 offen lds
  v_mfma_f32_16x16x32_bf16 v[176:179], a[48:51], a[16:19], v[176:179]
  v_mfma_f32_16x16x32_bf16 v[180:183], a[52:55], a[16:19], v[180:183]
  s_add_u32 m0, s68, 28672
  v_mfma_f32_16x16x32_bf16 v[184:187], a[56:59], a[16:19], v[184:187]
  v_mfma_f32_16x16x32_bf16 v[188:191], a[60:63], a[16:19], v[188:191]
  buffer_load_dwordx4 v9, s[40:43], s69 offen lds
  v_mfma_f32_16x16x32_bf16 v[220:223], a[60:63], a[20:23], v[220:223]
  s_add_u32 s8, s8, 1
  v_mfma_f32_16x16x32_bf16 v[216:219], a[56:59], a[20:23], v[216:219]
  v_mfma_f32_16x16x32_bf16 v[212:215], a[52:55], a[20:23], v[212:215]
  s_cmp_eq_u32 s8, 5
  v_mfma_f32_16x16x32_bf16 v[208:211], a[48:51], a[20:23], v[208:211]
  v_mfma_f32_16x16x32_bf16 v[204:207], a[44:47], a[20:23], v[204:207]
  s_cselect_b32 s8, 0, s8
  v_mfma_f32_16x16x32_bf16 v[200:203], a[40:43], a[20:23], v[200:203]
  s_add_u32 s9, s9, 5
  v_mfma_f32_16x16x32_bf16 v[196:199], a[36:39], a[20:23], v[196:199]
  v_mfma_f32_16x16x32_bf16 v[192:195], a[32:35], a[20:23], v[192:195]
  s_cmp_eq_u32 s9, 10
  v_mfma_f32_16x16x32_bf16 v[224:227], a[32:35], a[24:27], v[224:227]
  v_mfma_f32_16x16x32_bf16 v[228:231], a[36:39], a[24:27], v[228:231]
  s_cselect_b32 s9, 0, s9
  v_mfma_f32_16x16x32_bf16 v[232:235], a[40:43], a[24:27], v[232:235]
  s_add_u32 s69, s8, s9
  v_mfma_f32_16x16x32_bf16 v[236:239], a[44:47], a[24:27], v[236:239]
  v_mfma_f32_16x16x32_bf16 a[128:131], a[48:51], a[24:27], a[128:131]
  s_lshl_b32 s69, s69, 7
  v_mfma_f32_16x16x32_bf16 a[132:135], a[52:55], a[24:27], a[132:135]
  v_mfma_f32_16x16x32_bf16 a[136:139], a[56:59], a[24:27], a[136:139]
  buffer_load_dwordx4 a[228:231], v20, s[60:63], s79 offen offset:0
  v_mfma_f32_16x16x32_bf16 a[140:143], a[60:63], a[24:27], a[140:143]
  buffer_load_dwordx4 a[232:235], v20, s[60:63], s79 offen offset:1024
L_pad72:
  s_cbranch_execz L_warm_ret
  v_mfma_f32_16x16x32_bf16 a[156:159], a[60:63], a[28:31], a[156:159]
  v_mfma_f32_16x16x32_bf16 a[152:155], a[56:59], a[28:31], a[152:155]
  buffer_load_dwordx4 a[236:239], v20, s[60:63], s79 offen offset:2048
  v_mfma_f32_16x16x32_bf16 a[148:151], a[52:55], a[28:31], a[148:151]
  v_mfma_f32_16x16x32_bf16 a[144:147], a[48:51], a[28:31], a[144:147]
  buffer_load_dwordx4 a[240:243], v20, s[60:63], s79 offen offset:3072
  v_mfma_f32_16x16x32_bf16 v[252:255], a[44:47], a[28:31], v[252:255]
  s_add_u32 s79, s79, 4096
  v_mfma_f32_16x16x32_bf16 v[248:251], a[40:43], a[28:31], v[248:251]
  v_mfma_f32_16x16x32_bf16 v[244:247], a[36:39], a[28:31], v[244:247]
  buffer_load_dwordx4 a[228:231], v20, s[60:63], s79 offen offset:0
  v_mfma_f32_16x16x32_bf16 v[240:243], a[32:35], a[28:31], v[240:243]
  v_mfma_f32_16x16x32_bf16 a[160:163], a[172:175], a[0:3], a[160:163]
  s_waitcnt lgkmcnt(0)
  v_mfma_f32_16x16x32_bf16 v[32:35], a[96:99], a[64:67], v[32:35]
  v_mfma_f32_16x16x32_bf16 v[36:39], a[100:103], a[64:67], v[36:39]
  v_mfma_f32_16x16x32_bf16 v[40:43], a[104:107], a[64:67], v[40:43]
  v_mfma_f32_16x16x32_bf16 v[44:47], a[108:111], a[64:67], v[44:47]
  s_waitcnt vmcnt(34)
  s_barrier
  ds_read_b64_tr_b16 a[32:33], v16 offset:0
  v_mfma_f32_16x16x32_bf16 v[48:51], a[112:115], a[64:67], v[48:51]
  ds_read_b64_tr_b16 a[34:35], v16 offset:1024
  v_mfma_f32_16x16x32_bf16 v[52:55], a[116:119], a[64:67], v[52:55]
  ds_read_b128 a[0:3], v14 offset:0
  v_mfma_f32_16x16x32_bf16 v[56:59], a[120:123], a[64:67], v[56:59]
  ds_read_b64_tr_b16 a[36:37], v17 offset:0
  v_mfma_f32_16x16x32_bf16 v[60:63], a[124:127], a[64:67], v[60:63]
  v_mfma_f32_16x16x32_bf16 v[92:95], a[124:127], a[68:71], v[92:95]
  ds_read_b64_tr_b16 a[38:39], v17 offset:1024
  v_mfma_f32_16x16x32_bf16 v[88:91], a[120:123], a[68:71], v[88:91]
  ds_read_b128 a[4:7], v14 offset:2048
  v_mfma_f32_16x16x32_bf16 v[84:87], a[116:119], a[68:71], v[84:87]
  ds_read_b64_tr_b16 a[40:41], v18 offset:0
  v_mfma_f32_16x16x32_bf16 v[80:83], a[112:115], a[68:71], v[80:83]
  s_add_u32 m0, s68, 147456
  v_mfma_f32_16x16x32_bf16 v[76:79], a[108:111], a[68:71], v[76:79]
  ds_read_b64_tr_b16 a[42:43], v18 offset:1024
  v_mfma_f32_16x16x32_bf16 v[72:75], a[104:107], a[68:71], v[72:75]
  ds_read_b128 a[8:11], v14 offset:4096
  buffer_load_dwordx4 v10, s[48:51], s70 offen lds
  v_mfma_f32_16x16x32_bf16 v[68:71], a[100:103], a[68:71], v[68:71]
  ds_read_b64_tr_b16 a[44:45], v19 offset:0
  v_mfma_f32_16x16x32_bf16 v[64:67], a[96:99], a[68:71], v[64:67]
  ds_read_b64_tr_b16 a[46:47], v19 offset:1024
  s_add_u32 m0, s68, 151552
  v_mfma_f32_16x16x32_bf16 v[96:99], a[96:99], a[72:75], v[96:99]
  v_mfma_f32_16x16x32_bf16 v[100:103], a[100:103], a[72:75], v[100:103]
  ds_read_b128 a[12:15], v14 offset:6144
  buffer_load_dwordx4 v11, s[48:51], s70 offen lds
  v_mfma_f32_16x16x32_bf16 v[104:107], a[104:107], a[72:75], v[104:107]
  ds_read_b64_tr_b16 a[48:49], v16 offset:8192
  v_mfma_f32_16x16x32_bf16 v[108:111], a[108:111], a[72:75], v[108:111]
  ds_read_b64_tr_b16 a[50:51], v16 offset:9216
  s_add_u32 m0, s68, 155648
  v_mfma_f32_16x16x32_bf16 v[112:115], a[112:115], a[72:75], v[112:115]
  v_mfma_f32_16x16x32_bf16 v[116:119], a[116:119], a[72:75], v[116:119]
  ds_read_b128 a[16:19], v14 offset:8192
  v_mfma_f32_16x16x32_bf16 v[120:123], a[120:123], a[72:75], v[120:123]
  ds_read_b64_tr_b16 a[52:53], v17 offset:8192
  buffer_load_dwordx4 v10, s[52:55], s70 offen lds
  v_mfma_f32_16x16x32_bf16 v[124:127], a[124:127], a[72:75], v[124:127]
  ds_read_b64_tr_b16 a[54:55], v17 offset:9216
  v_mfma_f32_16x16x32_bf16 v[156:159], a[124:127], a[76:79], v[156:159]
  ds_read_b128 a[20:23], v14 offset:10240
  s_add_u32 m0, s68, 159744
  v_mfma_f32_16x16x32_bf16 v[152:155], a[120:123], a[76:79], v[152:155]
  v_mfma_f32_16x16x32_bf16 v[148:151], a[116:119], a[76:79], v[148:151]
  ds_read_b64_tr_b16 a[56:57], v18 offset:8192
  buffer_load_dwordx4 v11, s[52:55], s70 offen lds
  v_mfma_f32_16x16x32_bf16 v[144:147], a[112:115], a[76:79], v[144:147]
  ds_read_b64_tr_b16 a[58:59], v18 offset:9216
  v_mfma_f32_16x16x32_bf16 v[140:143], a[108:111], a[76:79], v[140:143]
  ds_read_b128 a[24:27], v14 offset:12288
  buffer_load_dwordx4 a[168:171], v24, s[64:67], s71 offen offset:64
  v_mfma_f32_16x16x32_bf16 v[136:139], a[104:107], a[76:79], v[136:139]
  v_mfma_f32_16x16x32_bf16 v[132:135], a[100:103], a[76:79], v[132:135]
  ds_read_b64_tr_b16 a[60:61], v19 offset:8192
  s_add_u32 s10, s10, 1
  v_mfma_f32_16x16x32_bf16 v[128:131], a[96:99], a[76:79], v[128:131]
  ds_read_b64_tr_b16 a[62:63], v19 offset:9216
  v_mfma_f32_16x16x32_bf16 v[160:163], a[96:99], a[80:83], v[160:163]
  ds_read_b128 a[28:31], v14 offset:14336
  v_mfma_f32_16x16x32_bf16 v[164:167], a[100:103], a[80:83], v[164:167]
  s_cmp_eq_u32 s10, 5
  v_mfma_f32_16x16x32_bf16 v[168:171], a[104:107], a[80:83], v[168:171]
  v_mfma_f32_16x16x32_bf16 v[172:175], a[108:111], a[80:83], v[172:175]
  s_cselect_b32 s10, 0, s10
  v_mfma_f32_16x16x32_bf16 v[176:179], a[112:115], a[80:83], v[176:179]
  v_mfma_f32_16x16x32_bf16 v[180:183], a[116:119], a[80:83], v[180:183]
  s_add_u32 s11, s11, 5
  v_mfma_f32_16x16x32_bf16 v[184:187], a[120:123], a[80:83], v[184:187]
  v_mfma_f32_16x16x32_bf16 v[188:191], a[124:127], a[80:83], v[188:191]
  s_cmp_eq_u32 s11, 10
  v_mfma_f32_16x16x32_bf16 v[220:223], a[124:127], a[84:87], v[220:223]
  v_mfma_f32_16x16x32_bf16 v[216:219], a[120:123], a[84:87], v[216:219]
  s_cselect_b32 s11, 0, s11
  v_mfma_f32_16x16x32_bf16 v[212:215], a[116:119], a[84:87], v[212:215]
  v_mfma_f32_16x16x32_bf16 v[208:211], a[112:115], a[84:87], v[208:211]
  v_mfma_f32_16x16x32_bf16 v[204:207], a[108:111], a[84:87], v[204:207]
  s_add_u32 s71, s10, s11
  v_mfma_f32_16x16x32_bf16 v[200:203], a[104:107], a[84:87], v[200:203]
  v_mfma_f32_16x16x32_bf16 v[196:199], a[100:103], a[84:87], v[196:199]
  s_mul_i32 s70, s71, 196608
  v_mfma_f32_16x16x32_bf16 v[192:195], a[96:99], a[84:87], v[192:195]
  v_mfma_f32_16x16x32_bf16 v[224:227], a[96:99], a[88:91], v[224:227]
  s_lshl_b32 s71, s71, 7
  v_mfma_f32_16x16x32_bf16 v[228:231], a[100:103], a[88:91], v[228:231]
  v_mfma_f32_16x16x32_bf16 v[232:235], a[104:107], a[88:91], v[232:235]
  buffer_load_dwordx4 a[232:235], v20, s[60:63], s79 offen offset:1024
  v_mfma_f32_16x16x32_bf16 v[236:239], a[108:111], a[88:91], v[236:239]
  v_mfma_f32_16x16x32_bf16 a[128:131], a[112:115], a[88:91], a[128:131]
  buffer_load_dwordx4 a[236:239], v20, s[60:63], s79 offen offset:2048
  v_mfma_f32_16x16x32_bf16 a[132:135], a[116:119], a[88:91], a[132:135]
  v_mfma_f32_16x16x32_bf16 a[136:139], a[120:123], a[88:91], a[136:139]
  v_mfma_f32_16x16x32_bf16 a[140:143], a[124:127], a[88:91], a[140:143]
  buffer_load_dwordx4 a[240:243], v20, s[60:63], s79 offen offset:3072
  v_mfma_f32_16x16x32_bf16 a[156:159], a[124:127], a[92:95], a[156:159]
  v_mfma_f32_16x16x32_bf16 a[152:155], a[120:123], a[92:95], a[152:155]
  s_add_u32 s79, s79, 4096
  v_mfma_f32_16x16x32_bf16 a[148:151], a[116:119], a[92:95], a[148:151]
  v_mfma_f32_16x16x32_bf16 a[144:147], a[112:115], a[92:95], a[144:147]
  buffer_load_dwordx4 a[228:231], v20, s[60:63], s79 offen offset:0
  v_mfma_f32_16x16x32_bf16 v[252:255], a[108:111], a[92:95], v[252:255]
  v_mfma_f32_16x16x32_bf16 v[248:251], a[104:107], a[92:95], v[248:251]
  buffer_load_dwordx4 a[232:235], v20, s[60:63], s79 offen offset:1024
  v_mfma_f32_16x16x32_bf16 v[244:247], a[100:103], a[92:95], v[244:247]
  v_mfma_f32_16x16x32_bf16 v[240:243], a[96:99], a[92:95], v[240:243]
  v_mfma_f32_16x16x32_bf16 a[160:163], a[176:179], a[64:67], a[160:163]
  s_waitcnt lgkmcnt(0)
  v_mfma_f32_16x16x32_bf16 v[32:35], a[32:35], a[0:3], v[32:35]
  v_mfma_f32_16x16x32_bf16 v[36:39], a[36:39], a[0:3], v[36:39]
  v_mfma_f32_16x16x32_bf16 v[40:43], a[40:43], a[0:3], v[40:43]
  v_mfma_f32_16x16x32_bf16 v[44:47], a[44:47], a[0:3], v[44:47]
  s_waitcnt vmcnt(34)
  s_barrier
  ds_read_b64_tr_b16 a[96:97], v16 offset:16384
  v_mfma_f32_16x16x32_bf16 v[48:51], a[48:51], a[0:3], v[48:51]
  ds_read_b64_tr_b16 a[98:99], v16 offset:17408
  v_mfma_f32_16x16x32_bf16 v[52:55], a[52:55], a[0:3], v[52:55]
  ds_read_b128 a[64:67], v15 offset:0
  v_mfma_f32_16x16x32_bf16 v[56:59], a[56:59], a[0:3], v[56:59]
  ds_read_b64_tr_b16 a[100:101], v17 offset:16384
  v_mfma_f32_16x16x32_bf16 v[60:63], a[60:63], a[0:3], v[60:63]
  v_mfma_f32_16x16x32_bf16 v[92:95], a[60:63], a[4:7], v[92:95]
  ds_read_b64_tr_b16 a[102:103], v17 offset:17408
  v_mfma_f32_16x16x32_bf16 v[88:91], a[56:59], a[4:7], v[88:91]
  ds_read_b128 a[68:71], v15 offset:2048
  v_mfma_f32_16x16x32_bf16 v[84:87], a[52:55], a[4:7], v[84:87]
  ds_read_b64_tr_b16 a[104:105], v18 offset:16384
  v_mfma_f32_16x16x32_bf16 v[80:83], a[48:51], a[4:7], v[80:83]
  buffer_load_dwordx4 a[236:239], v20, s[60:63], s79 offen offset:2048
  v_mfma_f32_16x16x32_bf16 v[76:79], a[44:47], a[4:7], v[76:79]
  ds_read_b64_tr_b16 a[106:107], v18 offset:17408
  v_mfma_f32_16x16x32_bf16 v[72:75], a[40:43], a[4:7], v[72:75]
  ds_read_b128 a[72:75], v15 offset:4096
  v_mfma_f32_16x16x32_bf16 v[68:71], a[36:39], a[4:7], v[68:71]
  ds_read_b64_tr_b16 a[108:109], v19 offset:16384
  v_mfma_f32_16x16x32_bf16 v[64:67], a[32:35], a[4:7], v[64:67]
  ds_read_b64_tr_b16 a[110:111], v19 offset:17408
  v_mfma_f32_16x16x32_bf16 v[96:99], a[32:35], a[8:11], v[96:99]
  v_mfma_f32_16x16x32_bf16 v[100:103], a[36:39], a[8:11], v[100:103]
  ds_read_b128 a[76:79], v15 offset:6144
  v_mfma_f32_16x16x32_bf16 v[104:107], a[40:43], a[8:11], v[104:107]
  ds_read_b64_tr_b16 a[112:113], v16 offset:24576
  v_mfma_f32_16x16x32_bf16 v[108:111], a[44:47], a[8:11], v[108:111]
  ds_read_b64_tr_b16 a[114:115], v16 offset:25600
  buffer_load_dwordx4 a[240:243], v20, s[60:63], s79 offen offset:3072
  v_mfma_f32_16x16x32_bf16 v[112:115], a[48:51], a[8:11], v[112:115]
  v_mfma_f32_16x16x32_bf16 v[116:119], a[52:55], a[8:11], v[116:119]
  ds_read_b128 a[80:83], v15 offset:8192
  v_mfma_f32_16x16x32_bf16 v[120:123], a[56:59], a[8:11], v[120:123]
  ds_read_b64_tr_b16 a[116:117], v17 offset:24576
  v_mfma_f32_16x16x32_bf16 v[124:127], a[60:63], a[8:11], v[124:127]
  ds_read_b64_tr_b16 a[118:119], v17 offset:25600
  v_mfma_f32_16x16x32_bf16 v[156:159], a[60:63], a[12:15], v[156:159]
  ds_read_b128 a[84:87], v15 offset:10240
  v_mfma_f32_16x16x32_bf16 v[152:155], a[56:59], a[12:15], v[152:155]
  v_mfma_f32_16x16x32_bf16 v[148:151], a[52:55], a[12:15], v[148:151]
  ds_read_b64_tr_b16 a[120:121], v18 offset:24576
  v_mfma_f32_16x16x32_bf16 v[144:147], a[48:51], a[12:15], v[144:147]
  ds_read_b64_tr_b16 a[122:123], v18 offset:25600
  v_mfma_f32_16x16x32_bf16 v[140:143], a[44:47], a[12:15], v[140:143]
  ds_read_b128 a[88:91], v15 offset:12288
  s_add_u32 s79, s79, 4096
  v_mfma_f32_16x16x32_bf16 v[136:139], a[40:43], a[12:15], v[136:139]
  v_mfma_f32_16x16x32_bf16 v[132:135], a[36:39], a[12:15], v[132:135]
  ds_read_b64_tr_b16 a[124:125], v19 offset:24576
  v_mfma_f32_16x16x32_bf16 v[128:131], a[32:35], a[12:15], v[128:131]
  ds_read_b64_tr_b16 a[126:127], v19 offset:25600
  v_mfma_f32_16x16x32_bf16 v[160:163], a[32:35], a[16:19], v[160:163]
  ds_read_b128 a[92:95], v15 offset:14336
  v_mfma_f32_16x16x32_bf16 v[164:167], a[36:39], a[16:19], v[164:167]
  v_mfma_f32_16x16x32_bf16 v[168:171], a[40:43], a[16:19], v[168:171]
  v_mfma_f32_16x16x32_bf16 v[172:175], a[44:47], a[16:19], v[172:175]
  v_mfma_f32_16x16x32_bf16 v[176:179], a[48:51], a[16:19], v[176:179]
  v_mfma_f32_16x16x32_bf16 v[180:183], a[52:55], a[16:19], v[180:183]
  buffer_load_dwordx4 a[228:231], v20, s[60:63], s79 offen offset:0
  v_mfma_f32_16x16x32_bf16 v[184:187], a[56:59], a[16:19], v[184:187]
  v_mfma_f32_16x16x32_bf16 v[188:191], a[60:63], a[16:19], v[188:191]
  v_mfma_f32_16x16x32_bf16 v[220:223], a[60:63], a[20:23], v[220:223]
  v_mfma_f32_16x16x32_bf16 v[216:219], a[56:59], a[20:23], v[216:219]
  v_mfma_f32_16x16x32_bf16 v[212:215], a[52:55], a[20:23], v[212:215]
  v_mfma_f32_16x16x32_bf16 v[208:211], a[48:51], a[20:23], v[208:211]
  v_mfma_f32_16x16x32_bf16 v[204:207], a[44:47], a[20:23], v[204:207]
  v_mfma_f32_16x16x32_bf16 v[200:203], a[40:43], a[20:23], v[200:203]
  v_mfma_f32_16x16x32_bf16 v[196:199], a[36:39], a[20:23], v[196:199]
  buffer_load_dwordx4 a[232:235], v20, s[60:63], s79 offen offset:1024
  v_mfma_f32_16x16x32_bf16 v[192:195], a[32:35], a[20:23], v[192:195]
  v_mfma_f32_16x16x32_bf16 v[224:227], a[32:35], a[24:27], v[224:227]
  v_mfma_f32_16x16x32_bf16 v[228:231], a[36:39], a[24:27], v[228:231]
  v_mfma_f32_16x16x32_bf16 v[232:235], a[40:43], a[24:27], v[232:235]
  v_mfma_f32_16x16x32_bf16 v[236:239], a[44:47], a[24:27], v[236:239]
  v_mfma_f32_16x16x32_bf16 a[128:131], a[48:51], a[24:27], a[128:131]
  v_mfma_f32_16x16x32_bf16 a[132:135], a[52:55], a[24:27], a[132:135]
  v_mfma_f32_16x16x32_bf16 a[136:139], a[56:59], a[24:27], a[136:139]
  v_mfma_f32_16x16x32_bf16 a[140:143], a[60:63], a[24:27], a[140:143]
  buffer_load_dwordx4 a[228:231], v20, s[44:47], s80 offen offset:0
  v_mfma_f32_16x16x32_bf16 a[156:159], a[60:63], a[28:31], a[156:159]
  v_mfma_f32_16x16x32_bf16 a[152:155], a[56:59], a[28:31], a[152:155]
  v_mfma_f32_16x16x32_bf16 a[148:151], a[52:55], a[28:31], a[148:151]
  v_mfma_f32_16x16x32_bf16 a[144:147], a[48:51], a[28:31], a[144:147]
  v_mfma_f32_16x16x32_bf16 v[252:255], a[44:47], a[28:31], v[252:255]
  v_mfma_f32_16x16x32_bf16 v[248:251], a[40:43], a[28:31], v[248:251]
  v_mfma_f32_16x16x32_bf16 v[244:247], a[36:39], a[28:31], v[244:247]
  v_mfma_f32_16x16x32_bf16 v[240:243], a[32:35], a[28:31], v[240:243]
  v_mfma_f32_16x16x32_bf16 a[160:163], a[180:183], a[0:3], a[160:163]
  s_waitcnt lgkmcnt(0)
  v_mfma_f32_16x16x32_bf16 v[32:35], a[96:99], a[64:67], v[32:35]
  v_mfma_f32_16x16x32_bf16 v[36:39], a[100:103], a[64:67], v[36:39]
  v_mfma_f32_16x16x32_bf16 v[40:43], a[104:107], a[64:67], v[40:43]
  v_mfma_f32_16x16x32_bf16 v[44:47], a[108:111], a[64:67], v[44:47]
  s_waitcnt vmcnt(20)
  s_barrier
  ds_read_b64_tr_b16 a[32:33], v16 offset:32768
  v_mfma_f32_16x16x32_bf16 v[48:51], a[112:115], a[64:67], v[48:51]
  ds_read_b64_tr_b16 a[34:35], v16 offset:33792
  v_mfma_f32_16x16x32_bf16 v[52:55], a[116:119], a[64:67], v[52:55]
  ds_read_b128 a[0:3], v12 offset:0
  v_mfma_f32_16x16x32_bf16 v[56:59], a[120:123], a[64:67], v[56:59]
  ds_read_b64_tr_b16 a[36:37], v17 offset:32768
  v_mfma_f32_16x16x32_bf16 v[60:63], a[124:127], a[64:67], v[60:63]
  v_mfma_f32_16x16x32_bf16 v[92:95], a[124:127], a[68:71], v[92:95]
  ds_read_b64_tr_b16 a[38:39], v17 offset:33792
  v_mfma_f32_16x16x32_bf16 v[88:91], a[120:123], a[68:71], v[88:91]
  ds_read_b128 a[4:7], v12 offset:2048
  v_mfma_f32_16x16x32_bf16 v[84:87], a[116:119], a[68:71], v[84:87]
  ds_read_b64_tr_b16 a[40:41], v18 offset:32768
  v_mfma_f32_16x16x32_bf16 v[80:83], a[112:115], a[68:71], v[80:83]
  buffer_load_dwordx4 a[232:235], v20, s[44:47], s80 offen offset:1024
  v_mfma_f32_16x16x32_bf16 v[76:79], a[108:111], a[68:71], v[76:79]
  ds_read_b64_tr_b16 a[42:43], v18 offset:33792
  v_mfma_f32_16x16x32_bf16 v[72:75], a[104:107], a[68:71], v[72:75]
  ds_read_b128 a[8:11], v12 offset:4096
  v_mfma_f32_16x16x32_bf16 v[68:71], a[100:103], a[68:71], v[68:71]
  ds_read_b64_tr_b16 a[44:45], v19 offset:32768
  v_mfma_f32_16x16x32_bf16 v[64:67], a[96:99], a[68:71], v[64:67]
  ds_read_b64_tr_b16 a[46:47], v19 offset:33792
  v_mfma_f32_16x16x32_bf16 v[96:99], a[96:99], a[72:75], v[96:99]
  v_mfma_f32_16x16x32_bf16 v[100:103], a[100:103], a[72:75], v[100:103]
  ds_read_b128 a[12:15], v12 offset:6144
  v_mfma_f32_16x16x32_bf16 v[104:107], a[104:107], a[72:75], v[104:107]
  ds_read_b64_tr_b16 a[48:49], v16 offset:40960
  v_mfma_f32_16x16x32_bf16 v[108:111], a[108:111], a[72:75], v[108:111]
L_pad73:
  s_cbranch_execz L_warm_ret
  ds_read_b64_tr_b16 a[50:51], v16 offset:41984
  buffer_load_dwordx4 a[236:239], v20, s[44:47], s80 offen offset:2048
  v_mfma_f32_16x16x32_bf16 v[112:115], a[112:115], a[72:75], v[112:115]
  v_mfma_f32_16x16x32_bf16 v[116:119], a[116:119], a[72:75], v[116:119]
  ds_read_b128 a[16:19], v12 offset:8192
  v_mfma_f32_16x16x32_bf16 v[120:123], a[120:123], a[72:75], v[120:123]
  ds_read_b64_tr_b16 a[52:53], v17 offset:40960
  v_mfma_f32_16x16x32_bf16 v[124:127], a[124:127], a[72:75], v[124:127]
  ds_read_b64_tr_b16 a[54:55], v17 offset:41984
  v_mfma_f32_16x16x32_bf16 v[156:159], a[124:127], a[76:79], v[156:159]
  ds_read_b128 a[20:23], v12 offset:10240
  v_mfma_f32_16x16x32_bf16 v[152:155], a[120:123], a[76:79], v[152:155]
  v_mfma_f32_16x16x32_bf16 v[148:151], a[116:119], a[76:79], v[148:151]
  ds_read_b64_tr_b16 a[56:57], v18 offset:40960
  v_mfma_f32_16x16x32_bf16 v[144:147], a[112:115], a[76:79], v[144:147]
  ds_read_b64_tr_b16 a[58:59], v18 offset:41984
  v_mfma_f32_16x16x32_bf16 v[140:143], a[108:111], a[76:79], v[140:143]
  ds_read_b128 a[24:27], v12 offset:12288
  buffer_load_dwordx4 a[240:243], v20, s[44:47], s80 offen offset:3072
  v_mfma_f32_16x16x32_bf16 v[136:139], a[104:107], a[76:79], v[136:139]
  v_mfma_f32_16x16x32_bf16 v[132:135], a[100:103], a[76:79], v[132:135]
  ds_read_b64_tr_b16 a[60:61], v19 offset:40960
  v_mfma_f32_16x16x32_bf16 v[128:131], a[96:99], a[76:79], v[128:131]
  ds_read_b64_tr_b16 a[62:63], v19 offset:41984
  v_mfma_f32_16x16x32_bf16 v[160:163], a[96:99], a[80:83], v[160:163]
  ds_read_b128 a[28:31], v12 offset:14336
  v_mfma_f32_16x16x32_bf16 v[164:167], a[100:103], a[80:83], v[164:167]
  v_mfma_f32_16x16x32_bf16 v[168:171], a[104:107], a[80:83], v[168:171]
  v_mfma_f32_16x16x32_bf16 v[172:175], a[108:111], a[80:83], v[172:175]
  v_mfma_f32_16x16x32_bf16 v[176:179], a[112:115], a[80:83], v[176:179]
  v_mfma_f32_16x16x32_bf16 v[180:183], a[116:119], a[80:83], v[180:183]
  s_add_u32 s80, s80, 4096
  v_mfma_f32_16x16x32_bf16 v[184:187], a[120:123], a[80:83], v[184:187]
  v_mfma_f32_16x16x32_bf16 v[188:191], a[124:127], a[80:83], v[188:191]
  v_mfma_f32_16x16x32_bf16 v[220:223], a[124:127], a[84:87], v[220:223]
  v_mfma_f32_16x16x32_bf16 v[216:219], a[120:123], a[84:87], v[216:219]
  v_mfma_f32_16x16x32_bf16 v[212:215], a[116:119], a[84:87], v[212:215]
  v_mfma_f32_16x16x32_bf16 v[208:211], a[112:115], a[84:87], v[208:211]
  v_mfma_f32_16x16x32_bf16 v[204:207], a[108:111], a[84:87], v[204:207]
  v_mfma_f32_16x16x32_bf16 v[200:203], a[104:107], a[84:87], v[200:203]
  v_mfma_f32_16x16x32_bf16 v[196:199], a[100:103], a[84:87], v[196:199]
  buffer_load_dwordx4 a[228:231], v20, s[44:47], s80 offen offset:0
  v_mfma_f32_16x16x32_bf16 v[192:195], a[96:99], a[84:87], v[192:195]
  v_mfma_f32_16x16x32_bf16 v[224:227], a[96:99], a[88:91], v[224:227]
  v_mfma_f32_16x16x32_bf16 v[228:231], a[100:103], a[88:91], v[228:231]
  v_mfma_f32_16x16x32_bf16 v[232:235], a[104:107], a[88:91], v[232:235]
  v_mfma_f32_16x16x32_bf16 v[236:239], a[108:111], a[88:91], v[236:239]
  v_mfma_f32_16x16x32_bf16 a[128:131], a[112:115], a[88:91], a[128:131]
  v_mfma_f32_16x16x32_bf16 a[132:135], a[116:119], a[88:91], a[132:135]
  v_mfma_f32_16x16x32_bf16 a[136:139], a[120:123], a[88:91], a[136:139]
  v_mfma_f32_16x16x32_bf16 a[140:143], a[124:127], a[88:91], a[140:143]
  buffer_load_dwordx4 a[232:235], v20, s[44:47], s80 offen offset:1024
  v_mfma_f32_16x16x32_bf16 a[156:159], a[124:127], a[92:95], a[156:159]
  v_mfma_f32_16x16x32_bf16 a[152:155], a[120:123], a[92:95], a[152:155]
  v_mfma_f32_16x16x32_bf16 a[148:151], a[116:119], a[92:95], a[148:151]
  v_mfma_f32_16x16x32_bf16 a[144:147], a[112:115], a[92:95], a[144:147]
  v_mfma_f32_16x16x32_bf16 v[252:255], a[108:111], a[92:95], v[252:255]
  v_mfma_f32_16x16x32_bf16 v[248:251], a[104:107], a[92:95], v[248:251]
  v_mfma_f32_16x16x32_bf16 v[244:247], a[100:103], a[92:95], v[244:247]
  v_mfma_f32_16x16x32_bf16 v[240:243], a[96:99], a[92:95], v[240:243]
  v_mfma_f32_16x16x32_bf16 a[160:163], a[184:187], a[64:67], a[160:163]
  s_waitcnt lgkmcnt(0)
  v_mfma_f32_16x16x32_bf16 v[32:35], a[32:35], a[0:3], v[32:35]
  v_mfma_f32_16x16x32_bf16 v[36:39], a[36:39], a[0:3], v[36:39]
  s_waitcnt vmcnt(15)
  s_barrier
  ds_read_b64_tr_b16 a[96:97], v16 offset:49152
  ds_read_b64_tr_b16 a[98:99], v16 offset:50176
  v_mfma_f32_16x16x32_bf16 v[40:43], a[40:43], a[0:3], v[40:43]
  ds_read_b128 a[64:67], v13 offset:0
  v_mfma_f32_16x16x32_bf16 v[44:47], a[44:47], a[0:3], v[44:47]
  ds_read_b64_tr_b16 a[100:101], v17 offset:49152
  ds_read_b64_tr_b16 a[102:103], v17 offset:50176
  v_mfma_f32_16x16x32_bf16 v[48:51], a[48:51], a[0:3], v[48:51]
  ds_read_b128 a[68:71], v13 offset:2048
  v_mfma_f32_16x16x32_bf16 v[52:55], a[52:55], a[0:3], v[52:55]
  ds_read_b64_tr_b16 a[104:105], v18 offset:49152
  ds_read_b64_tr_b16 a[106:107], v18 offset:50176
  v_mfma_f32_16x16x32_bf16 v[56:59], a[56:59], a[0:3], v[56:59]
  ds_read_b128 a[72:75], v13 offset:4096
  v_mfma_f32_16x16x32_bf16 v[60:63], a[60:63], a[0:3], v[60:63]
  ds_read_b64_tr_b16 a[108:109], v19 offset:49152
  v_mfma_f32_16x16x32_bf16 a[160:163], a[164:167], a[0:3], a[160:163]
  ds_read_b64_tr_b16 a[110:111], v19 offset:50176
  ds_read_b128 a[76:79], v13 offset:6144
  v_mfma_f32_16x16x32_bf16 v[64:67], a[32:35], a[4:7], v[64:67]
  ds_read_b64_tr_b16 a[112:113], v16 offset:57344
  v_mfma_f32_16x16x32_bf16 v[68:71], a[36:39], a[4:7], v[68:71]
  ds_read_b64_tr_b16 a[114:115], v16 offset:58368
  ds_read_b128 a[80:83], v13 offset:8192
  v_mfma_f32_16x16x32_bf16 v[72:75], a[40:43], a[4:7], v[72:75]
  ds_read_b64_tr_b16 a[116:117], v17 offset:57344
  v_mfma_f32_16x16x32_bf16 v[76:79], a[44:47], a[4:7], v[76:79]
  ds_read_b64_tr_b16 a[118:119], v17 offset:58368
  v_mfma_f32_16x16x32_bf16 v[80:83], a[48:51], a[4:7], v[80:83]
  ds_read_b128 a[84:87], v13 offset:10240
  ds_read_b64_tr_b16 a[120:121], v18 offset:57344
  v_mfma_f32_16x16x32_bf16 v[84:87], a[52:55], a[4:7], v[84:87]
  ds_read_b64_tr_b16 a[122:123], v18 offset:58368
  v_mfma_f32_16x16x32_bf16 v[88:91], a[56:59], a[4:7], v[88:91]
  ds_read_b128 a[88:91], v13 offset:12288
  ds_read_b64_tr_b16 a[124:125], v19 offset:57344
  v_mfma_f32_16x16x32_bf16 v[92:95], a[60:63], a[4:7], v[92:95]
  ds_read_b64_tr_b16 a[126:127], v19 offset:58368
  v_mfma_f32_16x16x32_bf16 v[96:99], a[32:35], a[8:11], v[96:99]
  ds_read_b128 a[92:95], v13 offset:14336
  v_mfma_f32_16x16x32_bf16 v[100:103], a[36:39], a[8:11], v[100:103]
  v_mfma_f32_16x16x32_bf16 v[104:107], a[40:43], a[8:11], v[104:107]
  v_mfma_f32_16x16x32_bf16 v[108:111], a[44:47], a[8:11], v[108:111]
  v_mfma_f32_16x16x32_bf16 v[112:115], a[48:51], a[8:11], v[112:115]
  v_mfma_f32_16x16x32_bf16 v[116:119], a[52:55], a[8:11], v[116:119]
  v_mfma_f32_16x16x32_bf16 v[120:123], a[56:59], a[8:11], v[120:123]
  v_mfma_f32_16x16x32_bf16 v[124:127], a[60:63], a[8:11], v[124:127]
  s_waitcnt lgkmcnt(0)
L_pad74:
  s_cbranch_execz L_warm_ret
  v_mfma_f32_16x16x32_bf16 v[32:35], a[96:99], a[64:67], v[32:35]
  v_mfma_f32_16x16x32_bf16 v[36:39], a[100:103], a[64:67], v[36:39]
  v_mfma_f32_16x16x32_bf16 v[40:43], a[104:107], a[64:67], v[40:43]
  v_mfma_f32_16x16x32_bf16 v[44:47], a[108:111], a[64:67], v[44:47]
  v_mfma_f32_16x16x32_bf16 v[48:51], a[112:115], a[64:67], v[48:51]
  v_mfma_f32_16x16x32_bf16 v[52:55], a[116:119], a[64:67], v[52:55]
  v_mfma_f32_16x16x32_bf16 v[56:59], a[120:123], a[64:67], v[56:59]
  v_mfma_f32_16x16x32_bf16 v[60:63], a[124:127], a[64:67], v[60:63]
  v_mfma_f32_16x16x32_bf16 a[160:163], a[168:171], a[64:67], a[160:163]
  v_mfma_f32_16x16x32_bf16 v[64:67], a[96:99], a[68:71], v[64:67]
  v_mfma_f32_16x16x32_bf16 v[68:71], a[100:103], a[68:71], v[68:71]
  v_mfma_f32_16x16x32_bf16 v[72:75], a[104:107], a[68:71], v[72:75]
  v_mfma_f32_16x16x32_bf16 v[76:79], a[108:111], a[68:71], v[76:79]
  v_mfma_f32_16x16x32_bf16 v[80:83], a[112:115], a[68:71], v[80:83]
  v_mfma_f32_16x16x32_bf16 v[84:87], a[116:119], a[68:71], v[84:87]
  v_mfma_f32_16x16x32_bf16 v[88:91], a[120:123], a[68:71], v[88:91]
  v_mfma_f32_16x16x32_bf16 v[92:95], a[124:127], a[68:71], v[92:95]
  v_mul_f32 v32, s72, v32
  v_mul_f32 v33, s72, v33
  v_mfma_f32_16x16x32_bf16 v[96:99], a[96:99], a[72:75], v[96:99]
  v_mul_f32 v34, s72, v34
  v_mul_f32 v35, s72, v35
  v_mfma_f32_16x16x32_bf16 v[100:103], a[100:103], a[72:75], v[100:103]
  v_mul_f32 v36, s72, v36
  v_mul_f32 v37, s72, v37
  v_mfma_f32_16x16x32_bf16 v[104:107], a[104:107], a[72:75], v[104:107]
  v_mul_f32 v38, s72, v38
  v_mul_f32 v39, s72, v39
  v_mfma_f32_16x16x32_bf16 v[108:111], a[108:111], a[72:75], v[108:111]
  v_exp_f32 v32, v32
  v_exp_f32 v33, v33
  v_mfma_f32_16x16x32_bf16 v[112:115], a[112:115], a[72:75], v[112:115]
  v_exp_f32 v34, v34
  v_exp_f32 v35, v35
  v_mfma_f32_16x16x32_bf16 v[116:119], a[116:119], a[72:75], v[116:119]
  v_exp_f32 v36, v36
  v_exp_f32 v37, v37
  v_mfma_f32_16x16x32_bf16 v[120:123], a[120:123], a[72:75], v[120:123]
  v_exp_f32 v38, v38
L_pad75:
  s_cbranch_execz L_warm_ret
  v_exp_f32 v39, v39
  v_mfma_f32_16x16x32_bf16 v[124:127], a[124:127], a[72:75], v[124:127]
  v_add_f32 v32, 1.0, v32
  v_add_f32 v33, 1.0, v33
  v_mfma_f32_16x16x32_bf16 v[128:131], a[32:35], a[12:15], v[128:131]
  v_add_f32 v34, 1.0, v34
  v_add_f32 v35, 1.0, v35
  v_mfma_f32_16x16x32_bf16 v[132:135], a[36:39], a[12:15], v[132:135]
  v_add_f32 v36, 1.0, v36
  v_add_f32 v37, 1.0, v37
  v_mfma_f32_16x16x32_bf16 v[136:139], a[40:43], a[12:15], v[136:139]
  v_add_f32 v38, 1.0, v38
  v_add_f32 v39, 1.0, v39
  v_mfma_f32_16x16x32_bf16 v[140:143], a[44:47], a[12:15], v[140:143]
  v_rcp_f32 v32, v32
  v_rcp_f32 v33, v33
  v_mfma_f32_16x16x32_bf16 v[144:147], a[48:51], a[12:15], v[144:147]
  v_rcp_f32 v34, v34
  v_rcp_f32 v35, v35
  v_mfma_f32_16x16x32_bf16 v[148:151], a[52:55], a[12:15], v[148:151]
  v_rcp_f32 v36, v36
  v_rcp_f32 v37, v37
  v_mfma_f32_16x16x32_bf16 v[152:155], a[56:59], a[12:15], v[152:155]
  v_rcp_f32 v38, v38
  v_rcp_f32 v39, v39
  v_mfma_f32_16x16x32_bf16 v[156:159], a[60:63], a[12:15], v[156:159]
  s_xor_b32 s74, s7, 0
  s_mul_i32 s74, s74, 90112
  v_mfma_f32_16x16x32_bf16 v[128:131], a[96:99], a[76:79], v[128:131]
  s_add_u32 s82, s81, s74
  v_mul_f32 v32, v32, v48
  v_mfma_f32_16x16x32_bf16 v[132:135], a[100:103], a[76:79], v[132:135]
  v_mul_f32 v33, v33, v49
  v_mul_f32 v34, v34, v50
  v_mfma_f32_16x16x32_bf16 v[136:139], a[104:107], a[76:79], v[136:139]
  v_mul_f32 v35, v35, v51
  v_mul_f32 v36, v36, v52
  v_mfma_f32_16x16x32_bf16 v[140:143], a[108:111], a[76:79], v[140:143]
  v_mul_f32 v37, v37, v53
  v_mul_f32 v38, v38, v54
  v_mfma_f32_16x16x32_bf16 v[144:147], a[112:115], a[76:79], v[144:147]
  v_mul_f32 v39, v39, v55
  v_cvt_pk_bf16_f32 v32, v32, v33
  v_mfma_f32_16x16x32_bf16 v[148:151], a[116:119], a[76:79], v[148:151]
  v_cvt_pk_bf16_f32 v33, v34, v35
L_pad76:
  s_cbranch_execz L_warm_ret
  v_cvt_pk_bf16_f32 v34, v36, v37
  v_mfma_f32_16x16x32_bf16 v[152:155], a[120:123], a[76:79], v[152:155]
  v_cvt_pk_bf16_f32 v35, v38, v39
  buffer_store_dwordx4 v[32:35], v20, s[56:59], s82 offen offset:0 sc1
  v_mfma_f32_16x16x32_bf16 v[156:159], a[124:127], a[76:79], v[156:159]
  v_mul_f32 v40, s72, v40
  v_mul_f32 v41, s72, v41
  v_mfma_f32_16x16x32_bf16 v[160:163], a[32:35], a[16:19], v[160:163]
  v_mul_f32 v42, s72, v42
  v_mul_f32 v43, s72, v43
  v_mfma_f32_16x16x32_bf16 v[164:167], a[36:39], a[16:19], v[164:167]
  v_mul_f32 v44, s72, v44
  v_mul_f32 v45, s72, v45
  v_mfma_f32_16x16x32_bf16 v[168:171], a[40:43], a[16:19], v[168:171]
  v_mul_f32 v46, s72, v46
  v_mul_f32 v47, s72, v47
  v_mfma_f32_16x16x32_bf16 v[172:175], a[44:47], a[16:19], v[172:175]
  v_exp_f32 v40, v40
  v_exp_f32 v41, v41
  v_mfma_f32_16x16x32_bf16 v[176:179], a[48:51], a[16:19], v[176:179]
  v_exp_f32 v42, v42
  v_exp_f32 v43, v43
  v_mfma_f32_16x16x32_bf16 v[180:183], a[52:55], a[16:19], v[180:183]
  v_exp_f32 v44, v44
  v_exp_f32 v45, v45
  v_mfma_f32_16x16x32_bf16 v[184:187], a[56:59], a[16:19], v[184:187]
  v_exp_f32 v46, v46
  v_exp_f32 v47, v47
  v_mfma_f32_16x16x32_bf16 v[188:191], a[60:63], a[16:19], v[188:191]
  v_add_f32 v40, 1.0, v40
  v_add_f32 v41, 1.0, v41
  v_mfma_f32_16x16x32_bf16 v[160:163], a[96:99], a[80:83], v[160:163]
  v_add_f32 v42, 1.0, v42
  v_add_f32 v43, 1.0, v43
  v_mfma_f32_16x16x32_bf16 v[164:167], a[100:103], a[80:83], v[164:167]
  v_add_f32 v44, 1.0, v44
  v_add_f32 v45, 1.0, v45
  v_mfma_f32_16x16x32_bf16 v[168:171], a[104:107], a[80:83], v[168:171]
  v_add_f32 v46, 1.0, v46
  v_add_f32 v47, 1.0, v47
  v_mfma_f32_16x16x32_bf16 v[172:175], a[108:111], a[80:83], v[172:175]
  v_rcp_f32 v40, v40
  v_rcp_f32 v41, v41
  v_mfma_f32_16x16x32_bf16 v[176:179], a[112:115], a[80:83], v[176:179]
  v_rcp_f32 v42, v42
L_pad77:
  s_cbranch_execz L_warm_ret
  v_rcp_f32 v43, v43
  v_mfma_f32_16x16x32_bf16 v[180:183], a[116:119], a[80:83], v[180:183]
  v_rcp_f32 v44, v44
  v_rcp_f32 v45, v45
  v_mfma_f32_16x16x32_bf16 v[184:187], a[120:123], a[80:83], v[184:187]
  v_rcp_f32 v46, v46
  v_rcp_f32 v47, v47
  v_mfma_f32_16x16x32_bf16 v[188:191], a[124:127], a[80:83], v[188:191]
  v_mul_f32 v40, v40, v56
  v_mul_f32 v41, v41, v57
  v_mfma_f32_16x16x32_bf16 v[192:195], a[32:35], a[20:23], v[192:195]
  v_mul_f32 v42, v42, v58
  v_mul_f32 v43, v43, v59
  v_mfma_f32_16x16x32_bf16 v[196:199], a[36:39], a[20:23], v[196:199]
  v_mul_f32 v44, v44, v60
  v_mul_f32 v45, v45, v61
  v_mfma_f32_16x16x32_bf16 v[200:203], a[40:43], a[20:23], v[200:203]
  v_mul_f32 v46, v46, v62
  v_mul_f32 v47, v47, v63
  v_mfma_f32_16x16x32_bf16 v[204:207], a[44:47], a[20:23], v[204:207]
  v_cvt_pk_bf16_f32 v40, v40, v41
  v_cvt_pk_bf16_f32 v41, v42, v43
  v_mfma_f32_16x16x32_bf16 v[208:211], a[48:51], a[20:23], v[208:211]
  v_cvt_pk_bf16_f32 v42, v44, v45
  v_cvt_pk_bf16_f32 v43, v46, v47
  v_mfma_f32_16x16x32_bf16 v[212:215], a[52:55], a[20:23], v[212:215]
  buffer_store_dwordx4 v[40:43], v20, s[56:59], s82 offen offset:1024 sc1
  v_accvgpr_read_b32 v2, a160
  v_mfma_f32_16x16x32_bf16 v[216:219], a[56:59], a[20:23], v[216:219]
  v_lshlrev_b32 v6, 3, v1
  v_cvt_pk_bf16_f32 v2, v2, v2
  v_mfma_f32_16x16x32_bf16 v[220:223], a[60:63], a[20:23], v[220:223]
  v_and_b32 v2, 0xffff0000, v2
  v_mul_f32 v2, s72, v2
  v_mfma_f32_16x16x32_bf16 v[192:195], a[96:99], a[84:87], v[192:195]
  v_exp_f32 v2, v2
  v_cmp_gt_u32 vcc, 16, v1
  v_mfma_f32_16x16x32_bf16 v[196:199], a[100:103], a[84:87], v[196:199]
  v_add_f32 v2, 1.0, v2
  v_rcp_f32 v2, v2
L_pad78:
  s_cbranch_execz L_warm_ret
  v_mfma_f32_16x16x32_bf16 v[200:203], a[104:107], a[84:87], v[200:203]
  v_mov_b32 v7, 2147483632
  v_cvt_pk_bf16_f32 v2, v2, v2
  v_mfma_f32_16x16x32_bf16 v[204:207], a[108:111], a[84:87], v[204:207]
  v_and_b32 v4, 0xffff0000, v2
  v_sub_f32 v2, 1.0, v4
  v_mfma_f32_16x16x32_bf16 v[208:211], a[112:115], a[84:87], v[208:211]
  v_cvt_pk_bf16_f32 v2, v2, v2
  v_and_b32 v5, 0xffff0000, v2
  v_mfma_f32_16x16x32_bf16 v[212:215], a[116:119], a[84:87], v[212:215]
  v_cndmask_b32 v6, v7, v6, vcc
  buffer_store_dwordx2 v[4:5], v6, s[56:59], s78 offen sc1
  v_mfma_f32_16x16x32_bf16 v[216:219], a[120:123], a[84:87], v[216:219]
  v_mul_f32 v64, s72, v64
  v_mul_f32 v65, s72, v65
  v_mfma_f32_16x16x32_bf16 v[220:223], a[124:127], a[84:87], v[220:223]
  v_mul_f32 v66, s72, v66
  v_mul_f32 v67, s72, v67
  v_mfma_f32_16x16x32_bf16 v[224:227], a[32:35], a[24:27], v[224:227]
  v_mul_f32 v68, s72, v68
  v_mul_f32 v69, s72, v69
  v_mfma_f32_16x16x32_bf16 v[228:231], a[36:39], a[24:27], v[228:231]
  v_mul_f32 v70, s72, v70
  v_mul_f32 v71, s72, v71
  v_mfma_f32_16x16x32_bf16 v[232:235], a[40:43], a[24:27], v[232:235]
  v_exp_f32 v64, v64
  v_exp_f32 v65, v65
  v_mfma_f32_16x16x32_bf16 v[236:239], a[44:47], a[24:27], v[236:239]
  v_exp_f32 v66, v66
  v_exp_f32 v67, v67
  v_mfma_f32_16x16x32_bf16 a[128:131], a[48:51], a[24:27], a[128:131]
  v_exp_f32 v68, v68
  v_exp_f32 v69, v69
  v_mfma_f32_16x16x32_bf16 a[132:135], a[52:55], a[24:27], a[132:135]
  v_exp_f32 v70, v70
  v_exp_f32 v71, v71
  v_mfma_f32_16x16x32_bf16 a[136:139], a[56:59], a[24:27], a[136:139]
  v_add_f32 v64, 1.0, v64
  v_add_f32 v65, 1.0, v65
  v_mfma_f32_16x16x32_bf16 a[140:143], a[60:63], a[24:27], a[140:143]
  v_add_f32 v66, 1.0, v66
L_pad79:
  s_cbranch_execz L_warm_ret
  v_add_f32 v67, 1.0, v67
  v_mfma_f32_16x16x32_bf16 v[224:227], a[96:99], a[88:91], v[224:227]
  v_add_f32 v68, 1.0, v68
  v_add_f32 v69, 1.0, v69
  v_mfma_f32_16x16x32_bf16 v[228:231], a[100:103], a[88:91], v[228:231]
  v_add_f32 v70, 1.0, v70
  v_add_f32 v71, 1.0, v71
  v_mfma_f32_16x16x32_bf16 v[232:235], a[104:107], a[88:91], v[232:235]
  v_rcp_f32 v64, v64
  v_rcp_f32 v65, v65
  v_mfma_f32_16x16x32_bf16 v[236:239], a[108:111], a[88:91], v[236:239]
  v_rcp_f32 v66, v66
  v_rcp_f32 v67, v67
  v_mfma_f32_16x16x32_bf16 a[128:131], a[112:115], a[88:91], a[128:131]
  v_rcp_f32 v68, v68
  v_rcp_f32 v69, v69
  v_mfma_f32_16x16x32_bf16 a[132:135], a[116:119], a[88:91], a[132:135]
  v_rcp_f32 v70, v70
  v_rcp_f32 v71, v71
  v_mfma_f32_16x16x32_bf16 a[136:139], a[120:123], a[88:91], a[136:139]
  s_xor_b32 s74, s7, 1
  s_mul_i32 s74, s74, 90112
  v_mfma_f32_16x16x32_bf16 a[140:143], a[124:127], a[88:91], a[140:143]
  s_add_u32 s82, s81, s74
  v_mul_f32 v64, v64, v80
  v_mfma_f32_16x16x32_bf16 v[240:243], a[32:35], a[28:31], v[240:243]
  v_mul_f32 v65, v65, v81
  v_mul_f32 v66, v66, v82
  v_mfma_f32_16x16x32_bf16 v[244:247], a[36:39], a[28:31], v[244:247]
  v_mul_f32 v67, v67, v83
  v_mul_f32 v68, v68, v84
  v_mfma_f32_16x16x32_bf16 v[248:251], a[40:43], a[28:31], v[248:251]
  v_mul_f32 v69, v69, v85
  v_mul_f32 v70, v70, v86
  v_mfma_f32_16x16x32_bf16 v[252:255], a[44:47], a[28:31], v[252:255]
  v_mul_f32 v71, v71, v87
  v_cvt_pk_bf16_f32 v64, v64, v65
  v_mfma_f32_16x16x32_bf16 a[144:147], a[48:51], a[28:31], a[144:147]
  v_cvt_pk_bf16_f32 v65, v66, v67
  v_cvt_pk_bf16_f32 v66, v68, v69
  v_mfma_f32_16x16x32_bf16 a[148:151], a[52:55], a[28:31], a[148:151]
  v_cvt_pk_bf16_f32 v67, v70, v71
  buffer_store_dwordx4 v[64:67], v20, s[56:59], s82 offen offset:0 sc1
L_pad80:
  s_cbranch_execz L_warm_ret
  v_mfma_f32_16x16x32_bf16 a[152:155], a[56:59], a[28:31], a[152:155]
  v_mul_f32 v72, s72, v72
  v_mul_f32 v73, s72, v73
  v_mfma_f32_16x16x32_bf16 a[156:159], a[60:63], a[28:31], a[156:159]
  v_mul_f32 v74, s72, v74
  v_mul_f32 v75, s72, v75
  v_mfma_f32_16x16x32_bf16 v[240:243], a[96:99], a[92:95], v[240:243]
  v_mul_f32 v76, s72, v76
  v_mul_f32 v77, s72, v77
  v_mfma_f32_16x16x32_bf16 v[244:247], a[100:103], a[92:95], v[244:247]
  v_mul_f32 v78, s72, v78
  v_mul_f32 v79, s72, v79
  v_mfma_f32_16x16x32_bf16 v[248:251], a[104:107], a[92:95], v[248:251]
  v_exp_f32 v72, v72
  v_exp_f32 v73, v73
  v_mfma_f32_16x16x32_bf16 v[252:255], a[108:111], a[92:95], v[252:255]
  v_exp_f32 v74, v74
  v_exp_f32 v75, v75
  v_mfma_f32_16x16x32_bf16 a[144:147], a[112:115], a[92:95], a[144:147]
  v_exp_f32 v76, v76
  v_exp_f32 v77, v77
  v_mfma_f32_16x16x32_bf16 a[148:151], a[116:119], a[92:95], a[148:151]
  v_exp_f32 v78, v78
  v_exp_f32 v79, v79
  v_mfma_f32_16x16x32_bf16 a[152:155], a[120:123], a[92:95], a[152:155]
  v_add_f32 v72, 1.0, v72
  v_add_f32 v73, 1.0, v73
  v_mfma_f32_16x16x32_bf16 a[156:159], a[124:127], a[92:95], a[156:159]
  v_add_f32 v74, 1.0, v74
  v_add_f32 v75, 1.0, v75
  s_nop 7
  v_add_f32 v76, 1.0, v76
  v_add_f32 v77, 1.0, v77
  v_add_f32 v78, 1.0, v78
  v_add_f32 v79, 1.0, v79
  v_rcp_f32 v72, v72
  v_rcp_f32 v73, v73
  v_rcp_f32 v74, v74
  v_rcp_f32 v75, v75
  v_rcp_f32 v76, v76
  v_rcp_f32 v77, v77
  v_rcp_f32 v78, v78
  v_rcp_f32 v79, v79
  v_mul_f32 v72, v72, v88
  v_mul_f32 v73, v73, v89
  v_mul_f32 v74, v74, v90
  v_mul_f32 v75, v75, v91
  v_mul_f32 v76, v76, v92
  v_mul_f32 v77, v77, v93
  v_mul_f32 v78, v78, v94
  v_mul_f32 v79, v79, v95
  v_cvt_pk_bf16_f32 v72, v72, v73
L_pad81:
  s_cbranch_execz L_warm_ret
  v_cvt_pk_bf16_f32 v73, v74, v75
  v_cvt_pk_bf16_f32 v74, v76, v77
  v_cvt_pk_bf16_f32 v75, v78, v79
  buffer_store_dwordx4 v[72:75], v20, s[56:59], s82 offen offset:1024 sc1
  v_pk_mul_f32 v[96:97], v[96:97], s[72:73]
  v_pk_mul_f32 v[98:99], v[98:99], s[72:73]
  v_pk_mul_f32 v[100:101], v[100:101], s[72:73]
  v_pk_mul_f32 v[102:103], v[102:103], s[72:73]
  v_exp_f32 v96, v96
  v_exp_f32 v97, v97
  v_exp_f32 v98, v98
  v_exp_f32 v99, v99
  v_exp_f32 v100, v100
  v_exp_f32 v101, v101
  v_exp_f32 v102, v102
  v_exp_f32 v103, v103
  v_pk_add_f32 v[96:97], v[96:97], 1.0 op_sel_hi:[1,0]
  v_pk_add_f32 v[98:99], v[98:99], 1.0 op_sel_hi:[1,0]
  v_pk_add_f32 v[100:101], v[100:101], 1.0 op_sel_hi:[1,0]
  v_pk_add_f32 v[102:103], v[102:103], 1.0 op_sel_hi:[1,0]
  v_rcp_f32 v96, v96
  v_rcp_f32 v97, v97
  v_rcp_f32 v98, v98
  v_rcp_f32 v99, v99
  v_rcp_f32 v100, v100
  v_rcp_f32 v101, v101
  v_rcp_f32 v102, v102
  v_rcp_f32 v103, v103
  s_xor_b32 s74, s7, 2
  s_mul_i32 s74, s74, 90112
  s_add_u32 s82, s81, s74
  v_pk_mul_f32 v[96:97], v[96:97], v[112:113]
  v_pk_mul_f32 v[98:99], v[98:99], v[114:115]
  v_pk_mul_f32 v[100:101], v[100:101], v[116:117]
  v_pk_mul_f32 v[102:103], v[102:103], v[118:119]
  v_cvt_pk_bf16_f32 v96, v96, v97
  v_cvt_pk_bf16_f32 v97, v98, v99
  v_cvt_pk_bf16_f32 v98, v100, v101
  v_cvt_pk_bf16_f32 v99, v102, v103
  buffer_store_dwordx4 v[96:99], v20, s[56:59], s82 offen offset:0 sc1
  v_pk_mul_f32 v[104:105], v[104:105], s[72:73]
L_pad82:
  s_cbranch_execz L_warm_ret
  v_pk_mul_f32 v[106:107], v[106:107], s[72:73]
  v_pk_mul_f32 v[108:109], v[108:109], s[72:73]
  v_pk_mul_f32 v[110:111], v[110:111], s[72:73]
  v_exp_f32 v104, v104
  v_exp_f32 v105, v105
  v_exp_f32 v106, v106
  v_exp_f32 v107, v107
  v_exp_f32 v108, v108
  v_exp_f32 v109, v109
  v_exp_f32 v110, v110
  v_exp_f32 v111, v111
  v_pk_add_f32 v[104:105], v[104:105], 1.0 op_sel_hi:[1,0]
  v_pk_add_f32 v[106:107], v[106:107], 1.0 op_sel_hi:[1,0]
  v_pk_add_f32 v[108:109], v[108:109], 1.0 op_sel_hi:[1,0]
  v_pk_add_f32 v[110:111], v[110:111], 1.0 op_sel_hi:[1,0]
  v_rcp_f32 v104, v104
  v_rcp_f32 v105, v105
  v_rcp_f32 v106, v106
  v_rcp_f32 v107, v107
  v_rcp_f32 v108, v108
  v_rcp_f32 v109, v109
  v_rcp_f32 v110, v110
  v_rcp_f32 v111, v111
  v_pk_mul_f32 v[104:105], v[104:105], v[120:121]
  v_pk_mul_f32 v[106:107], v[106:107], v[122:123]
  v_pk_mul_f32 v[108:109], v[108:109], v[124:125]
  v_pk_mul_f32 v[110:111], v[110:111], v[126:127]
  v_cvt_pk_bf16_f32 v104, v104, v105
  v_cvt_pk_bf16_f32 v105, v106, v107
  v_cvt_pk_bf16_f32 v106, v108, v109
  v_cvt_pk_bf16_f32 v107, v110, v111
  buffer_store_dwordx4 v[104:107], v20, s[56:59], s82 offen offset:1024 sc1
  v_pk_mul_f32 v[128:129], v[128:129], s[72:73]
  v_pk_mul_f32 v[130:131], v[130:131], s[72:73]
  v_pk_mul_f32 v[132:133], v[132:133], s[72:73]
  v_pk_mul_f32 v[134:135], v[134:135], s[72:73]
  v_exp_f32 v128, v128
  v_exp_f32 v129, v129
  v_exp_f32 v130, v130
  v_exp_f32 v131, v131
  v_exp_f32 v132, v132
  v_exp_f32 v133, v133
  v_exp_f32 v134, v134
L_pad83:
  s_cbranch_execz L_warm_ret
  v_exp_f32 v135, v135
  v_pk_add_f32 v[128:129], v[128:129], 1.0 op_sel_hi:[1,0]
  v_pk_add_f32 v[130:131], v[130:131], 1.0 op_sel_hi:[1,0]
  v_pk_add_f32 v[132:133], v[132:133], 1.0 op_sel_hi:[1,0]
  v_pk_add_f32 v[134:135], v[134:135], 1.0 op_sel_hi:[1,0]
  v_rcp_f32 v128, v128
  v_rcp_f32 v129, v129
  v_rcp_f32 v130, v130
  v_rcp_f32 v131, v131
  v_rcp_f32 v132, v132
  v_rcp_f32 v133, v133
  v_rcp_f32 v134, v134
  v_rcp_f32 v135, v135
  s_xor_b32 s74, s7, 3
  s_mul_i32 s74, s74, 90112
  s_add_u32 s82, s81, s74
  v_pk_mul_f32 v[128:129], v[128:129], v[144:145]
  v_pk_mul_f32 v[130:131], v[130:131], v[146:147]
  v_pk_mul_f32 v[132:133], v[132:133], v[148:149]
  v_pk_mul_f32 v[134:135], v[134:135], v[150:151]
  v_cvt_pk_bf16_f32 v128, v128, v129
  v_cvt_pk_bf16_f32 v129, v130, v131
  v_cvt_pk_bf16_f32 v130, v132, v133
  v_cvt_pk_bf16_f32 v131, v134, v135
  buffer_store_dwordx4 v[128:131], v20, s[56:59], s82 offen offset:0 sc1
  v_pk_mul_f32 v[136:137], v[136:137], s[72:73]
  v_pk_mul_f32 v[138:139], v[138:139], s[72:73]
  v_pk_mul_f32 v[140:141], v[140:141], s[72:73]
  v_pk_mul_f32 v[142:143], v[142:143], s[72:73]
  v_exp_f32 v136, v136
  v_exp_f32 v137, v137
  v_exp_f32 v138, v138
  v_exp_f32 v139, v139
  v_exp_f32 v140, v140
  v_exp_f32 v141, v141
  v_exp_f32 v142, v142
  v_exp_f32 v143, v143
  v_pk_add_f32 v[136:137], v[136:137], 1.0 op_sel_hi:[1,0]
  v_pk_add_f32 v[138:139], v[138:139], 1.0 op_sel_hi:[1,0]
  v_pk_add_f32 v[140:141], v[140:141], 1.0 op_sel_hi:[1,0]
  v_pk_add_f32 v[142:143], v[142:143], 1.0 op_sel_hi:[1,0]
L_pad84:
  s_cbranch_execz L_warm_ret
  v_rcp_f32 v136, v136
  v_rcp_f32 v137, v137
  v_rcp_f32 v138, v138
  v_rcp_f32 v139, v139
  v_rcp_f32 v140, v140
  v_rcp_f32 v141, v141
  v_rcp_f32 v142, v142
  v_rcp_f32 v143, v143
  v_pk_mul_f32 v[136:137], v[136:137], v[152:153]
  v_pk_mul_f32 v[138:139], v[138:139], v[154:155]
  v_pk_mul_f32 v[140:141], v[140:141], v[156:157]
  v_pk_mul_f32 v[142:143], v[142:143], v[158:159]
  v_cvt_pk_bf16_f32 v136, v136, v137
  v_cvt_pk_bf16_f32 v137, v138, v139
  v_cvt_pk_bf16_f32 v138, v140, v141
  v_cvt_pk_bf16_f32 v139, v142, v143
  buffer_store_dwordx4 v[136:139], v20, s[56:59], s82 offen offset:1024 sc1
  v_pk_mul_f32 v[160:161], v[160:161], s[72:73]
  v_pk_mul_f32 v[162:163], v[162:163], s[72:73]
  v_pk_mul_f32 v[164:165], v[164:165], s[72:73]
  v_pk_mul_f32 v[166:167], v[166:167], s[72:73]
  v_exp_f32 v160, v160
  v_exp_f32 v161, v161
  v_exp_f32 v162, v162
  v_exp_f32 v163, v163
  v_exp_f32 v164, v164
  v_exp_f32 v165, v165
  v_exp_f32 v166, v166
  v_exp_f32 v167, v167
  v_pk_add_f32 v[160:161], v[160:161], 1.0 op_sel_hi:[1,0]
  v_pk_add_f32 v[162:163], v[162:163], 1.0 op_sel_hi:[1,0]
  v_pk_add_f32 v[164:165], v[164:165], 1.0 op_sel_hi:[1,0]
  v_pk_add_f32 v[166:167], v[166:167], 1.0 op_sel_hi:[1,0]
  v_rcp_f32 v160, v160
  v_rcp_f32 v161, v161
  v_rcp_f32 v162, v162
  v_rcp_f32 v163, v163
  v_rcp_f32 v164, v164
  v_rcp_f32 v165, v165
  v_rcp_f32 v166, v166
  v_rcp_f32 v167, v167
  s_xor_b32 s74, s7, 4
  s_mul_i32 s74, s74, 90112
  s_add_u32 s82, s81, s74
  v_pk_mul_f32 v[160:161], v[160:161], v[176:177]
L_pad85:
  s_cbranch_execz L_warm_ret
  v_pk_mul_f32 v[162:163], v[162:163], v[178:179]
  v_pk_mul_f32 v[164:165], v[164:165], v[180:181]
  v_pk_mul_f32 v[166:167], v[166:167], v[182:183]
  v_cvt_pk_bf16_f32 v160, v160, v161
  v_cvt_pk_bf16_f32 v161, v162, v163
  v_cvt_pk_bf16_f32 v162, v164, v165
  v_cvt_pk_bf16_f32 v163, v166, v167
  buffer_store_dwordx4 v[160:163], v20, s[56:59], s82 offen offset:0 sc1
  v_pk_mul_f32 v[168:169], v[168:169], s[72:73]
  v_pk_mul_f32 v[170:171], v[170:171], s[72:73]
  v_pk_mul_f32 v[172:173], v[172:173], s[72:73]
  v_pk_mul_f32 v[174:175], v[174:175], s[72:73]
  v_exp_f32 v168, v168
  v_exp_f32 v169, v169
  v_exp_f32 v170, v170
  v_exp_f32 v171, v171
  v_exp_f32 v172, v172
  v_exp_f32 v173, v173
  v_exp_f32 v174, v174
  v_exp_f32 v175, v175
  v_pk_add_f32 v[168:169], v[168:169], 1.0 op_sel_hi:[1,0]
  v_pk_add_f32 v[170:171], v[170:171], 1.0 op_sel_hi:[1,0]
  v_pk_add_f32 v[172:173], v[172:173], 1.0 op_sel_hi:[1,0]
  v_pk_add_f32 v[174:175], v[174:175], 1.0 op_sel_hi:[1,0]
  v_rcp_f32 v168, v168
  v_rcp_f32 v169, v169
  v_rcp_f32 v170, v170
  v_rcp_f32 v171, v171
  v_rcp_f32 v172, v172
  v_rcp_f32 v173, v173
  v_rcp_f32 v174, v174
  v_rcp_f32 v175, v175
  v_pk_mul_f32 v[168:169], v[168:169], v[184:185]
  v_pk_mul_f32 v[170:171], v[170:171], v[186:187]
  v_pk_mul_f32 v[172:173], v[172:173], v[188:189]
  v_pk_mul_f32 v[174:175], v[174:175], v[190:191]
  v_cvt_pk_bf16_f32 v168, v168, v169
  v_cvt_pk_bf16_f32 v169, v170, v171
  v_cvt_pk_bf16_f32 v170, v172, v173
  v_cvt_pk_bf16_f32 v171, v174, v175
L_pad86:
  s_cbranch_execz L_warm_ret
  buffer_store_dwordx4 v[168:171], v20, s[56:59], s82 offen offset:1024 sc1
  v_pk_mul_f32 v[192:193], v[192:193], s[72:73]
  v_pk_mul_f32 v[194:195], v[194:195], s[72:73]
  v_pk_mul_f32 v[196:197], v[196:197], s[72:73]
  v_pk_mul_f32 v[198:199], v[198:199], s[72:73]
  v_exp_f32 v192, v192
  v_exp_f32 v193, v193
  v_exp_f32 v194, v194
  v_exp_f32 v195, v195
  v_exp_f32 v196, v196
  v_exp_f32 v197, v197
  v_exp_f32 v198, v198
  v_exp_f32 v199, v199
  v_pk_add_f32 v[192:193], v[192:193], 1.0 op_sel_hi:[1,0]
  v_pk_add_f32 v[194:195], v[194:195], 1.0 op_sel_hi:[1,0]
  v_pk_add_f32 v[196:197], v[196:197], 1.0 op_sel_hi:[1,0]
  v_pk_add_f32 v[198:199], v[198:199], 1.0 op_sel_hi:[1,0]
  v_rcp_f32 v192, v192
  v_rcp_f32 v193, v193
  v_rcp_f32 v194, v194
  v_rcp_f32 v195, v195
  v_rcp_f32 v196, v196
  v_rcp_f32 v197, v197
  v_rcp_f32 v198, v198
  v_rcp_f32 v199, v199
  s_xor_b32 s74, s7, 5
  s_mul_i32 s74, s74, 90112
  s_add_u32 s82, s81, s74
  v_pk_mul_f32 v[192:193], v[192:193], v[208:209]
  v_pk_mul_f32 v[194:195], v[194:195], v[210:211]
  v_pk_mul_f32 v[196:197], v[196:197], v[212:213]
  v_pk_mul_f32 v[198:199], v[198:199], v[214:215]
  v_cvt_pk_bf16_f32 v192, v192, v193
  v_cvt_pk_bf16_f32 v193, v194, v195
  v_cvt_pk_bf16_f32 v194, v196, v197
  v_cvt_pk_bf16_f32 v195, v198, v199
  buffer_store_dwordx4 v[192:195], v20, s[56:59], s82 offen offset:0 sc1
  v_pk_mul_f32 v[200:201], v[200:201], s[72:73]
  v_pk_mul_f32 v[202:203], v[202:203], s[72:73]
  v_pk_mul_f32 v[204:205], v[204:205], s[72:73]
  v_pk_mul_f32 v[206:207], v[206:207], s[72:73]
L_pad87:
  s_cbranch_execz L_warm_ret
  v_exp_f32 v200, v200
  v_exp_f32 v201, v201
  v_exp_f32 v202, v202
  v_exp_f32 v203, v203
  v_exp_f32 v204, v204
  v_exp_f32 v205, v205
  v_exp_f32 v206, v206
  v_exp_f32 v207, v207
  v_pk_add_f32 v[200:201], v[200:201], 1.0 op_sel_hi:[1,0]
  v_pk_add_f32 v[202:203], v[202:203], 1.0 op_sel_hi:[1,0]
  v_pk_add_f32 v[204:205], v[204:205], 1.0 op_sel_hi:[1,0]
  v_pk_add_f32 v[206:207], v[206:207], 1.0 op_sel_hi:[1,0]
  v_rcp_f32 v200, v200
  v_rcp_f32 v201, v201
  v_rcp_f32 v202, v202
  v_rcp_f32 v203, v203
  v_rcp_f32 v204, v204
  v_rcp_f32 v205, v205
  v_rcp_f32 v206, v206
  v_rcp_f32 v207, v207
  v_pk_mul_f32 v[200:201], v[200:201], v[216:217]
  v_pk_mul_f32 v[202:203], v[202:203], v[218:219]
  v_pk_mul_f32 v[204:205], v[204:205], v[220:221]
  v_pk_mul_f32 v[206:207], v[206:207], v[222:223]
  v_cvt_pk_bf16_f32 v200, v200, v201
  v_cvt_pk_bf16_f32 v201, v202, v203
  v_cvt_pk_bf16_f32 v202, v204, v205
  v_cvt_pk_bf16_f32 v203, v206, v207
  buffer_store_dwordx4 v[200:203], v20, s[56:59], s82 offen offset:1024 sc1
  v_accvgpr_read_b32 v24, a128
  v_accvgpr_read_b32 v25, a129
  v_accvgpr_read_b32 v26, a130
  v_accvgpr_read_b32 v27, a131
  v_accvgpr_read_b32 v28, a132
  v_accvgpr_read_b32 v29, a133
  v_accvgpr_read_b32 v30, a134
  v_accvgpr_read_b32 v31, a135
  v_pk_mul_f32 v[224:225], v[224:225], s[72:73]
  v_pk_mul_f32 v[226:227], v[226:227], s[72:73]
  v_pk_mul_f32 v[228:229], v[228:229], s[72:73]
L_pad88:
  s_cbranch_execz L_warm_ret
  v_pk_mul_f32 v[230:231], v[230:231], s[72:73]
  v_exp_f32 v224, v224
  v_exp_f32 v225, v225
  v_exp_f32 v226, v226
  v_exp_f32 v227, v227
  v_exp_f32 v228, v228
  v_exp_f32 v229, v229
  v_exp_f32 v230, v230
  v_exp_f32 v231, v231
  v_pk_add_f32 v[224:225], v[224:225], 1.0 op_sel_hi:[1,0]
  v_pk_add_f32 v[226:227], v[226:227], 1.0 op_sel_hi:[1,0]
  v_pk_add_f32 v[228:229], v[228:229], 1.0 op_sel_hi:[1,0]
  v_pk_add_f32 v[230:231], v[230:231], 1.0 op_sel_hi:[1,0]
  v_rcp_f32 v224, v224
  v_rcp_f32 v225, v225
  v_rcp_f32 v226, v226
  v_rcp_f32 v227, v227
  v_rcp_f32 v228, v228
  v_rcp_f32 v229, v229
  v_rcp_f32 v230, v230
  v_rcp_f32 v231, v231
  s_xor_b32 s74, s7, 6
  s_mul_i32 s74, s74, 90112
  s_add_u32 s82, s81, s74
  v_pk_mul_f32 v[224:225], v[224:225], v[24:25]
  v_pk_mul_f32 v[226:227], v[226:227], v[26:27]
  v_pk_mul_f32 v[228:229], v[228:229], v[28:29]
  v_pk_mul_f32 v[230:231], v[230:231], v[30:31]
  v_cvt_pk_bf16_f32 v224, v224, v225
  v_cvt_pk_bf16_f32 v225, v226, v227
  v_cvt_pk_bf16_f32 v226, v228, v229
  v_cvt_pk_bf16_f32 v227, v230, v231
  buffer_store_dwordx4 v[224:227], v20, s[56:59], s82 offen offset:0 sc1
  v_accvgpr_read_b32 v24, a136
  v_accvgpr_read_b32 v25, a137
  v_accvgpr_read_b32 v26, a138
  v_accvgpr_read_b32 v27, a139
  v_accvgpr_read_b32 v28, a140
  v_accvgpr_read_b32 v29, a141
  v_accvgpr_read_b32 v30, a142
  v_accvgpr_read_b32 v31, a143
L_pad89:
  s_cbranch_execz L_warm_ret
  v_pk_mul_f32 v[232:233], v[232:233], s[72:73]
  v_pk_mul_f32 v[234:235], v[234:235], s[72:73]
  v_pk_mul_f32 v[236:237], v[236:237], s[72:73]
  v_pk_mul_f32 v[238:239], v[238:239], s[72:73]
  v_exp_f32 v232, v232
  v_exp_f32 v233, v233
  v_exp_f32 v234, v234
  v_exp_f32 v235, v235
  v_exp_f32 v236, v236
  v_exp_f32 v237, v237
  v_exp_f32 v238, v238
  v_exp_f32 v239, v239
  v_pk_add_f32 v[232:233], v[232:233], 1.0 op_sel_hi:[1,0]
  v_pk_add_f32 v[234:235], v[234:235], 1.0 op_sel_hi:[1,0]
  v_pk_add_f32 v[236:237], v[236:237], 1.0 op_sel_hi:[1,0]
  v_pk_add_f32 v[238:239], v[238:239], 1.0 op_sel_hi:[1,0]
  v_rcp_f32 v232, v232
  v_rcp_f32 v233, v233
  v_rcp_f32 v234, v234
  v_rcp_f32 v235, v235
  v_rcp_f32 v236, v236
  v_rcp_f32 v237, v237
  v_rcp_f32 v238, v238
  v_rcp_f32 v239, v239
  v_pk_mul_f32 v[232:233], v[232:233], v[24:25]
  v_pk_mul_f32 v[234:235], v[234:235], v[26:27]
  v_pk_mul_f32 v[236:237], v[236:237], v[28:29]
  v_pk_mul_f32 v[238:239], v[238:239], v[30:31]
  v_cvt_pk_bf16_f32 v232, v232, v233
  v_cvt_pk_bf16_f32 v233, v234, v235
  v_cvt_pk_bf16_f32 v234, v236, v237
  v_cvt_pk_bf16_f32 v235, v238, v239
  buffer_store_dwordx4 v[232:235], v20, s[56:59], s82 offen offset:1024 sc1
  v_accvgpr_read_b32 v24, a144
  v_accvgpr_read_b32 v25, a145
  v_accvgpr_read_b32 v26, a146
  v_accvgpr_read_b32 v27, a147
  v_accvgpr_read_b32 v28, a148
  v_accvgpr_read_b32 v29, a149
  v_accvgpr_read_b32 v30, a150
L_pad90:
  s_cbranch_execz L_warm_ret
  v_accvgpr_read_b32 v31, a151
  v_pk_mul_f32 v[240:241], v[240:241], s[72:73]
  v_pk_mul_f32 v[242:243], v[242:243], s[72:73]
  v_pk_mul_f32 v[244:245], v[244:245], s[72:73]
  v_pk_mul_f32 v[246:247], v[246:247], s[72:73]
  v_exp_f32 v240, v240
  v_exp_f32 v241, v241
  v_exp_f32 v242, v242
  v_exp_f32 v243, v243
  v_exp_f32 v244, v244
  v_exp_f32 v245, v245
  v_exp_f32 v246, v246
  v_exp_f32 v247, v247
  v_pk_add_f32 v[240:241], v[240:241], 1.0 op_sel_hi:[1,0]
  v_pk_add_f32 v[242:243], v[242:243], 1.0 op_sel_hi:[1,0]
  v_pk_add_f32 v[244:245], v[244:245], 1.0 op_sel_hi:[1,0]
  v_pk_add_f32 v[246:247], v[246:247], 1.0 op_sel_hi:[1,0]
  v_rcp_f32 v240, v240
  v_rcp_f32 v241, v241
  v_rcp_f32 v242, v242
  v_rcp_f32 v243, v243
  v_rcp_f32 v244, v244
  v_rcp_f32 v245, v245
  v_rcp_f32 v246, v246
  v_rcp_f32 v247, v247
  s_xor_b32 s74, s7, 7
  s_mul_i32 s74, s74, 90112
  s_add_u32 s82, s81, s74
  v_pk_mul_f32 v[240:241], v[240:241], v[24:25]
  v_pk_mul_f32 v[242:243], v[242:243], v[26:27]
  v_pk_mul_f32 v[244:245], v[244:245], v[28:29]
  v_pk_mul_f32 v[246:247], v[246:247], v[30:31]
  v_cvt_pk_bf16_f32 v240, v240, v241
  v_cvt_pk_bf16_f32 v241, v242, v243
  v_cvt_pk_bf16_f32 v242, v244, v245
  v_cvt_pk_bf16_f32 v243, v246, v247
  buffer_store_dwordx4 v[240:243], v20, s[56:59], s82 offen offset:0 sc1
  v_accvgpr_read_b32 v24, a152
  v_accvgpr_read_b32 v25, a153
  v_accvgpr_read_b32 v26, a154
  v_accvgpr_read_b32 v27, a155
L_pad91:
  s_cbranch_execz L_warm_ret
  v_accvgpr_read_b32 v28, a156
  v_accvgpr_read_b32 v29, a157
  v_accvgpr_read_b32 v30, a158
  v_accvgpr_read_b32 v31, a159
  v_pk_mul_f32 v[248:249], v[248:249], s[72:73]
  v_pk_mul_f32 v[250:251], v[250:251], s[72:73]
  v_pk_mul_f32 v[252:253], v[252:253], s[72:73]
  v_pk_mul_f32 v[254:255], v[254:255], s[72:73]
  v_exp_f32 v248, v248
  v_exp_f32 v249, v249
  v_exp_f32 v250, v250
  v_exp_f32 v251, v251
  v_exp_f32 v252, v252
  v_exp_f32 v253, v253
  v_exp_f32 v254, v254
  v_exp_f32 v255, v255
  v_pk_add_f32 v[248:249], v[248:249], 1.0 op_sel_hi:[1,0]
  v_pk_add_f32 v[250:251], v[250:251], 1.0 op_sel_hi:[1,0]
  v_pk_add_f32 v[252:253], v[252:253], 1.0 op_sel_hi:[1,0]
  v_pk_add_f32 v[254:255], v[254:255], 1.0 op_sel_hi:[1,0]
  v_rcp_f32 v248, v248
  v_rcp_f32 v249, v249
  v_rcp_f32 v250, v250
  v_rcp_f32 v251, v251
  v_rcp_f32 v252, v252
  v_rcp_f32 v253, v253
  v_rcp_f32 v254, v254
  v_rcp_f32 v255, v255
  v_pk_mul_f32 v[248:249], v[248:249], v[24:25]
  v_pk_mul_f32 v[250:251], v[250:251], v[26:27]
  v_pk_mul_f32 v[252:253], v[252:253], v[28:29]
  v_pk_mul_f32 v[254:255], v[254:255], v[30:31]
  v_cvt_pk_bf16_f32 v248, v248, v249
  v_cvt_pk_bf16_f32 v249, v250, v251
  v_cvt_pk_bf16_f32 v250, v252, v253
  v_cvt_pk_bf16_f32 v251, v254, v255
  buffer_store_dwordx4 v[248:251], v20, s[56:59], s82 offen offset:1024 sc1
  s_waitcnt vmcnt(0)
  v_accvgpr_read_b32 v16, a252
  v_accvgpr_read_b32 v17, a253
L_pad92:
  s_cbranch_execz L_warm_ret
  s_barrier
  s_mov_b32 s83, 100000
L_sig_chk_gu:
  v_readfirstlane_b32 s72, v16
  s_nop 3
  s_cmp_lg_u32 s72, 0
  s_cbranch_scc1 L_sig_go_gu
  s_sub_u32 s83, s83, 1
  s_cmp_eq_u32 s83, 0
  s_cbranch_scc1 L_sig_go_gu
  s_sleep 8
  buffer_load_dwordx2 v[16:17], off, s[96:99], 0 sc1
  s_waitcnt vmcnt(0)
  s_branch L_sig_chk_gu
L_sig_go_gu:
  s_mul_i32 s77, s4, 0x10000000
  buffer_store_dwordx2 v[16:17], v0, s[56:59], s77 offen sc1
  buffer_load_dwordx4 a[236:239], v20, s[44:47], s80 offen offset:2048
  buffer_load_dwordx4 a[240:243], v20, s[44:47], s80 offen offset:3072
  s_add_u32 s80, s80, 4096
  buffer_load_dwordx4 a[228:231], v20, s[44:47], s80 offen offset:0
  buffer_load_dwordx4 a[232:235], v20, s[44:47], s80 offen offset:1024
  buffer_load_dwordx4 a[236:239], v20, s[44:47], s80 offen offset:2048
  buffer_load_dwordx4 a[240:243], v20, s[44:47], s80 offen offset:3072
  s_add_u32 s80, s80, 4096
  buffer_load_dwordx4 a[228:231], v20, s[44:47], s80 offen offset:0
  buffer_load_dwordx4 a[232:235], v20, s[44:47], s80 offen offset:1024
  buffer_load_dwordx4 a[236:239], v20, s[44:47], s80 offen offset:2048
  buffer_load_dwordx4 a[240:243], v20, s[44:47], s80 offen offset:3072
  s_add_u32 s80, s80, 4096
  buffer_load_dwordx4 a[228:231], v20, s[44:47], s80 offen offset:0
  buffer_load_dwordx4 a[232:235], v20, s[44:47], s80 offen offset:1024
  buffer_load_dwordx4 a[236:239], v20, s[44:47], s80 offen offset:2048
  buffer_load_dwordx4 a[240:243], v20, s[44:47], s80 offen offset:3072
  s_add_u32 s80, s80, 4096
  buffer_load_dwordx4 a[228:231], v20, s[44:47], s80 offen offset:0
  buffer_load_dwordx4 a[232:235], v20, s[44:47], s80 offen offset:1024
  buffer_load_dwordx4 a[236:239], v20, s[44:47], s80 offen offset:2048
  buffer_load_dwordx4 a[240:243], v20, s[44:47], s80 offen offset:3072
L_pad93:
  s_cbranch_execz L_warm_ret
  s_add_u32 s80, s80, 4096
  buffer_load_dwordx4 a[228:231], v20, s[44:47], s80 offen offset:0
  buffer_load_dwordx4 a[232:235], v20, s[44:47], s80 offen offset:1024
  buffer_load_dwordx4 a[236:239], v20, s[44:47], s80 offen offset:2048
  buffer_load_dwordx4 a[240:243], v20, s[44:47], s80 offen offset:3072
  s_add_u32 s80, s80, 4096
  buffer_load_dwordx4 a[228:231], v20, s[44:47], s80 offen offset:0
  buffer_load_dwordx4 a[232:235], v20, s[44:47], s80 offen offset:1024
  buffer_load_dwordx4 a[236:239], v20, s[44:47], s80 offen offset:2048
  buffer_load_dwordx4 a[240:243], v20, s[44:47], s80 offen offset:3072
  s_add_u32 s80, s80, 4096
  buffer_load_dwordx4 a[228:231], v20, s[44:47], s80 offen offset:0
  buffer_load_dwordx4 a[232:235], v20, s[44:47], s80 offen offset:1024
  buffer_load_dwordx4 a[236:239], v20, s[44:47], s80 offen offset:2048
  buffer_load_dwordx4 a[240:243], v20, s[44:47], s80 offen offset:3072
  s_add_u32 s80, s80, 4096
  buffer_load_dwordx4 a[228:231], v20, s[44:47], s80 offen offset:0
  buffer_load_dwordx4 a[232:235], v20, s[44:47], s80 offen offset:1024
  buffer_load_dwordx4 a[236:239], v20, s[44:47], s80 offen offset:2048
  buffer_load_dwordx4 a[240:243], v20, s[44:47], s80 offen offset:3072
  s_add_u32 s80, s80, 4096
  s_add_u32 s75, s5, 16
  s_mul_i32 s75, s75, 4
  s_and_b32 s74, s6, 3
  s_add_u32 s75, s75, s74
  s_lshl_b32 s75, s75, 7
  s_add_u32 s75, s75, 15745024
  v_min_u32 v4, 11, v1
  v_lshl_add_u32 v4, v4, 3, s75
  s_lshl_b32 s74, s6, 2
  s_add_u32 s74, s74, s4
  s_mul_i32 s75, s74, 171
  s_lshr_b32 s75, s75, 9
  s_mul_i32 s76, s75, 3
  s_sub_u32 s74, s74, s76
  s_lshl_b32 s76, s5, 4
  s_add_u32 s75, s75, s76
  s_mul_i32 s75, s75, 90112
L_pad94:
  s_cbranch_execz L_warm_ret
  s_lshl_b32 s74, s74, 14
  s_add_u32 s75, s75, s74
  s_add_u32 s79, s75, 40960
  s_cmp_lg_u32 s4, 0
  s_cbranch_scc1 L_hp_done
  s_mov_b32 s83, 100000
L_hp:
  buffer_load_dwordx2 v[18:19], v4, s[56:59], 0 offen sc1
  s_waitcnt vmcnt(0)
  v_cmp_ne_u64 vcc, v[18:19], v[16:17]
  s_nop 4
  s_cbranch_vccz L_hp_done
  s_sub_u32 s83, s83, 1
  s_cmp_eq_u32 s83, 0
  s_cbranch_scc1 L_hp_done
  s_sleep 6
  s_branch L_hp
L_hp_done:
  s_barrier
  buffer_load_dwordx4 a[228:231], v20, s[56:59], s79 offen offset:0 sc1
  buffer_load_dwordx4 a[232:235], v20, s[56:59], s79 offen offset:1024 sc1
  buffer_load_dwordx4 a[236:239], v20, s[56:59], s79 offen offset:2048 sc1
  buffer_load_dwordx4 a[240:243], v20, s[56:59], s79 offen offset:3072 sc1
  s_add_u32 s79, s79, 4096
  buffer_load_dwordx4 a[228:231], v20, s[56:59], s79 offen offset:0 sc1
  buffer_load_dwordx4 a[232:235], v20, s[56:59], s79 offen offset:1024 sc1
  buffer_load_dwordx4 a[236:239], v20, s[56:59], s79 offen offset:2048 sc1
  buffer_load_dwordx4 a[240:243], v20, s[56:59], s79 offen offset:3072 sc1
  s_add_u32 s79, s79, 4096
  buffer_load_dwordx4 a[228:231], v20, s[56:59], s79 offen offset:0 sc1
  buffer_load_dwordx4 a[232:235], v20, s[56:59], s79 offen offset:1024 sc1
  buffer_load_dwordx4 a[236:239], v20, s[56:59], s79 offen offset:2048 sc1
  buffer_load_dwordx4 a[240:243], v20, s[56:59], s79 offen offset:3072 sc1
  s_add_u32 s79, s79, 4096
  buffer_load_dwordx4 a[228:231], v20, s[56:59], s79 offen offset:0 sc1
  buffer_load_dwordx4 a[232:235], v20, s[56:59], s79 offen offset:1024 sc1
  buffer_load_dwordx4 a[236:239], v20, s[56:59], s79 offen offset:2048 sc1
  buffer_load_dwordx4 a[240:243], v20, s[56:59], s79 offen offset:3072 sc1
  s_add_u32 s79, s79, 4096
L_end:
  s_endpgm
.section .rodata,"a"
.p2align 6
.amdhsa_kernel gated_mix__spectral_fnet__glu_gated_glu__prompt_kernel
  .amdhsa_next_free_vgpr 512
  .amdhsa_next_free_sgpr 102
  .amdhsa_accum_offset 256
  .amdhsa_group_segment_fixed_size 0
  .amdhsa_kernarg_size 104
  .amdhsa_user_sgpr_count 2
  .amdhsa_user_sgpr_kernarg_segment_ptr 1
  .amdhsa_system_sgpr_workgroup_id_x 1
.end_amdhsa_kernel
```
